```python
import torch

def _softmax(x, axis=-1):
    return torch.softmax(x, dim=axis)

def _gelu(x):
    return torch.nn.functional.gelu(x, approximate='tanh')

def _silu(x):
    return torch.nn.functional.silu(x)

def _sigmoid(x):
    return torch.sigmoid(x)

def _layernorm(x, axis=-1, eps=1e-05):
    m = x.mean(dim=axis, keepdim=True)
    v = x.var(dim=axis, keepdim=True, unbiased=False)
    return (x - m) / torch.sqrt(v + eps)

def _scatter_add(tgt, idx, src, axis=0):
    return tgt.clone().index_add_(axis, idx, src)

def _segment_sum(src, seg, n):
    out = torch.zeros((n,) + src.shape[1:], dtype=src.dtype)
    return out.index_add_(0, seg, src)

def _pad(x, pw):
    flat = tuple((v for pair in reversed(pw) for v in pair))
    return torch.nn.functional.pad(x, flat)
kernel_name = 'gated_mix__mha_block__memory_aug_recurrent_mem_tr__prompt'

def setup_inputs():

    _w = lambda a: (lambda t: t.to(torch.bfloat16) if t.is_floating_point() else t)(torch.as_tensor(a))

    def _A_setup():
        B, S, D, H = (1, 2048, 512, 32)
        return {'x': _w((lambda *s: torch.randn(*s, dtype=torch.bfloat16) * 0.05)(B, S, D)), 'wqkv': _w((lambda *s: torch.randn(*s, dtype=torch.bfloat16) * 0.8)(D, 3 * D)), 'wo': _w((lambda *s: torch.randn(*s, dtype=torch.bfloat16) * 0.05)(D, D))}
    _A_in = _A_setup()

    def _B_setup():
        B, S, Dm = (1, 2048, 512)
        H, Dh = (32, 128)
        M, seg = (8, 32)
        seg = min(seg, S)
        S = S // seg * seg
        return {'x': _w((lambda *s: torch.randn(*s, dtype=torch.bfloat16) * 0.05)(B, S, Dm)), 'mem0': _w((lambda *s: torch.randn(*s, dtype=torch.bfloat16) * 0.8)(B, M, Dm)), 'Wq': _w((lambda *s: torch.randn(*s, dtype=torch.bfloat16) * 1.6)(Dm, H, Dh) * Dm ** (-0.5)), 'Wk': _w((lambda *s: torch.randn(*s, dtype=torch.bfloat16) * 1.6)(Dm, H, Dh) * Dm ** (-0.5)), 'Wv': _w((lambda *s: torch.randn(*s, dtype=torch.bfloat16) * 0.8)(Dm, H, Dh) * Dm ** (-0.5)), 'Wo': _w((lambda *s: torch.randn(*s, dtype=torch.bfloat16) * 0.8)(H, Dh, Dm) * (H * Dh) ** (-0.5)), 'seg_len': seg}
    _B_in = _B_setup()
    return {'A_x': _A_in['x'], 'A_wqkv': _A_in['wqkv'], 'A_wo': _A_in['wo'], 'B_x': _B_in['x'], 'B_mem0': _B_in['mem0'], 'B_Wq': _B_in['Wq'], 'B_Wk': _B_in['Wk'], 'B_Wv': _B_in['Wv'], 'B_Wo': _B_in['Wo'], 'B_seg_len': _B_in['seg_len'], 'gate_w': _w((lambda *s: torch.randn(*s, dtype=torch.bfloat16) * 0.05)(512) * 16.0)}

def reference(A_x, A_wqkv, A_wo, B_x, B_mem0, B_Wq, B_Wk, B_Wv, B_Wo, B_seg_len, gate_w):

    def _A_ref(x, wqkv, wo):
        B, S, D = x.shape
        H = 32
        Dh = D // H
        qkv = (lambda x, *d: x.permute(*d))((x @ wqkv).reshape(B, S, 3, H, Dh), 2, 0, 3, 1, 4)
        q, k, v = (qkv[0], qkv[1], qkv[2])
        scores = torch.einsum('bhqd,bhkd->bhqk', q, k) * Dh ** (-0.5)
        p = _softmax(scores, axis=-1)
        o = torch.einsum('bhqk,bhkd->bhqd', p, v)
        return (lambda x, *d: x.permute(*d))(o, 0, 2, 1, 3).reshape(B, S, D) @ wo

    def _B_ref(x, mem0, Wq, Wk, Wv, Wo, seg_len):
        B, S, Dm = x.shape
        H, Dh = (Wq.shape[1], Wq.shape[2])
        M = mem0.shape[1]
        scale = Dh ** (-0.5)
        n_seg = S // seg_len
        L = M + seg_len
        idx = torch.arange(L)
        mask = (idx[:, None] < M) | (idx[:, None] >= idx[None, :])
        mem = mem0
        outs = []
        for s in range(n_seg):
            xs = x[:, s * seg_len:(s + 1) * seg_len, :].clone()
            h = torch.concatenate([mem, xs], axis=1)
            q = torch.einsum('btd,dhe->bhte', h, Wq)
            k = torch.einsum('btd,dhe->bhte', h, Wk)
            v = torch.einsum('btd,dhe->bhte', h, Wv)
            scores = torch.einsum('bhqe,bhke->bhqk', q, k) * scale
            scores = torch.where(mask[None, None], scores, -1000000000.0)
            p = _softmax(scores, axis=-1)
            o = torch.einsum('bhqk,bhke->bhqe', p, v)
            o = torch.einsum('bhte,hed->btd', o, Wo)
            mem = o[:, :M, :].clone()
            outs.append(o[:, M:, :])
        return torch.concatenate(outs, axis=1)
    x = A_x
    g = _sigmoid((x * gate_w).sum(-1, keepdims=True))
    a = _A_ref(x, A_wqkv, A_wo)
    b = _B_ref(x, B_mem0, B_Wq, B_Wk, B_Wv, B_Wo, B_seg_len)
    return g * a + (1 - g) * b
```

```asm
; @launch grid=(256,1,1) block=(256,1,1) lds=163840
.amdgcn_target "amdgcn-amd-amdhsa--gfx950"
.text
.globl gated_mix__mha_block__memory_aug_recurrent_mem_tr__prompt_kernel
.p2align 8
.type gated_mix__mha_block__memory_aug_recurrent_mem_tr__prompt_kernel,@function
gated_mix__mha_block__memory_aug_recurrent_mem_tr__prompt_kernel:
  s_cmp_ge_u32 s2, 256
  s_cbranch_scc1 k_end
  s_load_dwordx4 s[4:7], s[0:1], 0
  s_load_dwordx2 s[8:9], s[0:1], 16
  s_load_dwordx2 s[10:11], s[0:1], 32
  s_load_dwordx8 s[12:19], s[0:1], 40
  s_load_dwordx8 s[20:27], s[0:1], 80
  v_lshrrev_b32 v1, 6, v0
  s_nop 1
  v_readfirstlane_b32 s28, v1
  v_and_b32 v1, 63, v0
  v_and_b32 v2, 15, v1
  v_lshrrev_b32 v3, 4, v1
  s_waitcnt lgkmcnt(0)
  s_mov_b32 s100, 0
  s_getreg_b32 s3, hwreg(HW_REG_XCC_ID, 0, 3)
  s_cmp_lg_u32 s3, 0
  s_cbranch_scc1 k_worker
  v_mov_b32 v6, 163824
  s_cmp_lg_u32 s28, 0
  s_cbranch_scc1 bc_1
  s_mov_b64 exec, 1
  v_mov_b32 v7, 0
  v_mov_b32 v5, 1
  global_atomic_add v4, v7, v5, s[24:25] sc0 sc1
  s_waitcnt vmcnt(0)
  v_and_b32 v4, 0xffff, v4
  ds_write_b64 v6, v[4:5]
  s_mov_b64 exec, -1
  s_waitcnt lgkmcnt(0)
bc_1:
  s_barrier
  ds_read_b64 v[4:5], v6
  s_waitcnt lgkmcnt(0)
  v_readfirstlane_b32 s29, v4
  v_readfirstlane_b32 s62, v5
  s_barrier
  s_mov_b32 s99, 0xffff
  s_cmp_ge_u32 s29, 32
  s_cbranch_scc1 k_worker
k_team:
  v_mbcnt_lo_u32_b32 v1, -1, 0
  v_mbcnt_hi_u32_b32 v1, -1, v1
  v_and_b32 v2, 15, v1
  v_lshrrev_b32 v3, 4, v1
  v_lshrrev_b32 v20, 2, v2
  v_lshlrev_b32 v21, 16, v3
  v_lshl_add_u32 v21, v20, 11, v21
  v_and_b32 v22, 3, v2
  v_lshl_add_u32 v21, v22, 4, v21
  s_lshl_b32 s33, s28, 13
  v_lshl_add_u32 v23, v3, 2, v20
  v_lshlrev_b32 v23, 5, v23
  v_and_b32 v23, 31, v23
  v_xor_b32 v23, s29, v23
  v_lshl_add_u32 v21, v23, 6, v21
  s_add_u32 s33, s33, 87031808
  v_add_u32 v8, s33, v21
  v_add_u32 v20, 32768, v8
  s_lshl_b32 s33, s29, 2
  s_add_u32 s33, s33, s28
  s_and_b32 s34, s33, 15
  s_lshl_b32 s34, s34, 9
  s_lshr_b32 s35, s33, 5
  s_lshl_b32 s35, s35, 6
  s_add_u32 s34, s34, s35
  s_bfe_u32 s35, s33, 0x10004
  s_lshl_b32 s35, s35, 8
  s_add_u32 s34, s34, s35
  s_add_u32 s34, s34, 88080384
  v_lshrrev_b32 v21, 1, v22
  v_lshlrev_b32 v21, 5, v21
  v_lshl_add_u32 v21, v3, 4, v21
  v_and_b32 v23, 1, v22
  v_lshl_add_u32 v21, v23, 3, v21
  v_add_u32 v9, s34, v21
  v_mov_b64 v[24:25], 0
  v_mov_b64 v[26:27], 0
  global_store_dwordx4 v8, v[24:27], s[26:27] sc1
  global_store_dwordx4 v20, v[24:27], s[26:27] sc1
  s_mov_b32 exec_lo, 0x000f000f
  s_mov_b32 exec_hi, 0
  global_store_dwordx2 v9, v[24:25], s[26:27] sc1
  s_mov_b64 exec, -1
  s_lshr_b32 s30, s28, 1
  s_and_b32 s31, s28, 1
  s_lshl_b32 s32, s29, 8
  s_lshl_b32 s33, s30, 7
  s_add_u32 s32, s32, s33
  v_lshrrev_b32 v4, 1, v3
  v_lshlrev_b32 v4, 17, v4
  v_and_b32 v5, 1, v3
  v_lshl_add_u32 v4, v5, 15, v4
  v_add_u32 v4, s32, v4
  s_lshl_b32 s33, s31, 2
  v_lshl_add_u32 v5, v2, 3, v4
  v_add_u32 v5, s33, v5
  v_lshrrev_b32 v6, 2, v2
  v_lshl_add_u32 v4, v6, 5, v4
  v_and_b32 v6, 3, v2
  v_lshl_add_u32 v4, v6, 2, v4
  s_lshl_b32 s33, s31, 4
  v_add_u32 v4, s33, v4
  s_lshl_b32 s33, s29, 17
  s_lshl_b32 s34, s28, 8
  s_add_u32 s33, s33, s34
  v_lshlrev_b32 v6, 13, v3
  v_lshrrev_b32 v7, 2, v2
  v_lshl_add_u32 v6, v7, 6, v6
  v_and_b32 v7, 3, v2
  v_lshl_add_u32 v6, v7, 3, v6
  v_add_u32 v6, s33, v6
  s_lshl_b32 s34, s28, 15
  v_lshl_add_u32 v7, v1, 4, s34
  s_lshl_b32 s35, s28, 20
  s_lshl_b32 s52, s30, 16
  s_lshl_b32 s53, s31, 11
  s_or_b32 s52, s52, s53
  s_mov_b32 s56, 0x05040100
  s_mov_b32 s57, 0x07060302
  s_mov_b32 s36, s12
  s_mov_b32 s37, s13
  s_mov_b32 s38, 4194304
  s_mov_b32 s39, 0x20000
  s_mov_b32 s40, s14
  s_mov_b32 s41, s15
  s_mov_b32 s42, 4194304
  s_mov_b32 s43, 0x20000
  s_mov_b32 s44, s16
  s_mov_b32 s45, s17
  s_mov_b32 s46, 4194304
  s_mov_b32 s47, 0x20000
  s_mov_b32 s48, s18
  s_mov_b32 s49, s19
  s_mov_b32 s50, 4194304
  s_mov_b32 s51, 0x20000
  s_lshl_b32 s33, s29, 8
  s_lshl_b32 s34, s28, 20
  s_add_u32 s33, s33, s34
  v_lshlrev_b32 v10, 13, v3
  v_lshl_add_u32 v10, v2, 4, v10
  v_add_u32 v10, s33, v10
  v_xor_b32 v11, 128, v10
  v_lshrrev_b32 v12, 1, v3
  v_lshlrev_b32 v12, 12, v12
  v_and_b32 v13, 1, v3
  v_mul_u32_u24 v13, 0x480, v13
  s_lshl_b32 s53, s28, 13
  v_add3_u32 v12, v12, v13, s53
  v_and_b32 v4, 0xff, v4
  v_and_b32 v5, 0xff, v5
  v_xor_b32 v4, v4, v12
  v_xor_b32 v5, v5, v12
  s_add_u32 m0, s53, 0
  s_mov_b32 s59, 0
  buffer_load_dwordx4 v10, s[44:47], s59 offen lds
  s_add_u32 m0, s53, 1024
  s_mov_b32 s59, 32768
  buffer_load_dwordx4 v11, s[44:47], s59 offen lds
  s_add_u32 m0, s53, 2048
  s_mov_b32 s59, 65536
  buffer_load_dwordx4 v10, s[44:47], s59 offen lds
  s_add_u32 m0, s53, 3072
  s_mov_b32 s59, 98304
  buffer_load_dwordx4 v11, s[44:47], s59 offen lds
  s_add_u32 m0, s53, 4096
  s_mov_b32 s59, 131072
  buffer_load_dwordx4 v10, s[44:47], s59 offen lds
  s_add_u32 m0, s53, 5120
  s_mov_b32 s59, 163840
  buffer_load_dwordx4 v11, s[44:47], s59 offen lds
  s_add_u32 m0, s53, 6144
  s_mov_b32 s59, 196608
  buffer_load_dwordx4 v10, s[44:47], s59 offen lds
  s_add_u32 m0, s53, 7168
  s_mov_b32 s59, 229376
  buffer_load_dwordx4 v11, s[44:47], s59 offen lds
  s_add_u32 m0, s53, 32768
  s_mov_b32 s59, 262144
  buffer_load_dwordx4 v10, s[44:47], s59 offen lds
  s_add_u32 m0, s53, 33792
  s_mov_b32 s59, 294912
  buffer_load_dwordx4 v11, s[44:47], s59 offen lds
  s_add_u32 m0, s53, 34816
  s_mov_b32 s59, 327680
  buffer_load_dwordx4 v10, s[44:47], s59 offen lds
  s_add_u32 m0, s53, 35840
  s_mov_b32 s59, 360448
  buffer_load_dwordx4 v11, s[44:47], s59 offen lds
  s_add_u32 m0, s53, 36864
  s_mov_b32 s59, 393216
  buffer_load_dwordx4 v10, s[44:47], s59 offen lds
  s_add_u32 m0, s53, 37888
  s_mov_b32 s59, 425984
  buffer_load_dwordx4 v11, s[44:47], s59 offen lds
  s_add_u32 m0, s53, 38912
  s_mov_b32 s59, 458752
  buffer_load_dwordx4 v10, s[44:47], s59 offen lds
  s_add_u32 m0, s53, 39936
  s_mov_b32 s59, 491520
  buffer_load_dwordx4 v11, s[44:47], s59 offen lds
  s_add_u32 m0, s53, 65536
  s_mov_b32 s59, 524288
  buffer_load_dwordx4 v10, s[44:47], s59 offen lds
  s_add_u32 m0, s53, 66560
  s_mov_b32 s59, 557056
  buffer_load_dwordx4 v11, s[44:47], s59 offen lds
  s_add_u32 m0, s53, 67584
  s_mov_b32 s59, 589824
  buffer_load_dwordx4 v10, s[44:47], s59 offen lds
  s_add_u32 m0, s53, 68608
  s_mov_b32 s59, 622592
  buffer_load_dwordx4 v11, s[44:47], s59 offen lds
  s_add_u32 m0, s53, 69632
  s_mov_b32 s59, 655360
  buffer_load_dwordx4 v10, s[44:47], s59 offen lds
  s_add_u32 m0, s53, 70656
  s_mov_b32 s59, 688128
  buffer_load_dwordx4 v11, s[44:47], s59 offen lds
  s_add_u32 m0, s53, 71680
  s_mov_b32 s59, 720896
  buffer_load_dwordx4 v10, s[44:47], s59 offen lds
  s_add_u32 m0, s53, 72704
  s_mov_b32 s59, 753664
  buffer_load_dwordx4 v11, s[44:47], s59 offen lds
  s_add_u32 m0, s53, 98304
  s_mov_b32 s59, 786432
  buffer_load_dwordx4 v10, s[44:47], s59 offen lds
  s_add_u32 m0, s53, 99328
  s_mov_b32 s59, 819200
  buffer_load_dwordx4 v11, s[44:47], s59 offen lds
  s_add_u32 m0, s53, 100352
  s_mov_b32 s59, 851968
  buffer_load_dwordx4 v10, s[44:47], s59 offen lds
  s_add_u32 m0, s53, 101376
  s_mov_b32 s59, 884736
  buffer_load_dwordx4 v11, s[44:47], s59 offen lds
  s_add_u32 m0, s53, 102400
  s_mov_b32 s59, 917504
  buffer_load_dwordx4 v10, s[44:47], s59 offen lds
  s_add_u32 m0, s53, 103424
  s_mov_b32 s59, 950272
  buffer_load_dwordx4 v11, s[44:47], s59 offen lds
  s_add_u32 m0, s53, 104448
  s_mov_b32 s59, 983040
  buffer_load_dwordx4 v10, s[44:47], s59 offen lds
  s_add_u32 m0, s53, 105472
  s_mov_b32 s59, 1015808
  buffer_load_dwordx4 v11, s[44:47], s59 offen lds
  s_waitcnt vmcnt(24)
  s_barrier
  s_add_u32 m0, s53, 131072
  s_mov_b32 s59, 0
  buffer_load_dwordx4 v10, s[36:39], s59 offen lds
  s_add_u32 m0, s53, 132096
  s_mov_b32 s59, 32768
  buffer_load_dwordx4 v11, s[36:39], s59 offen lds
  s_add_u32 m0, s53, 133120
  s_mov_b32 s59, 65536
  buffer_load_dwordx4 v10, s[36:39], s59 offen lds
  s_add_u32 m0, s53, 134144
  s_mov_b32 s59, 98304
  buffer_load_dwordx4 v11, s[36:39], s59 offen lds
  s_add_u32 m0, s53, 135168
  s_mov_b32 s59, 131072
  buffer_load_dwordx4 v10, s[36:39], s59 offen lds
  s_add_u32 m0, s53, 136192
  s_mov_b32 s59, 163840
  buffer_load_dwordx4 v11, s[36:39], s59 offen lds
  s_add_u32 m0, s53, 137216
  s_mov_b32 s59, 196608
  buffer_load_dwordx4 v10, s[36:39], s59 offen lds
  s_add_u32 m0, s53, 138240
  s_mov_b32 s59, 229376
  buffer_load_dwordx4 v11, s[36:39], s59 offen lds
  s_cmp_lg_u32 s28, 0
  s_cbranch_scc1 k_arr
  v_mov_b32 v16, 0
  v_mov_b32 v17, 1
  s_mov_b64 exec, 1
  global_atomic_add v16, v17, s[24:25] offset:4 sc1
  s_mov_b64 exec, -1
k_arr:
  v_xor_b32 v12, 0, v5
  ds_read2st64_b32 v[96:97], v12 offset0:0 offset1:1
  ds_read2st64_b32 v[98:99], v12 offset0:8 offset1:9
  ds_read2st64_b32 v[100:101], v12 offset0:2 offset1:3
  ds_read2st64_b32 v[102:103], v12 offset0:10 offset1:11
  v_xor_b32 v13, 8192, v5
  ds_read2st64_b32 v[104:105], v13 offset0:0 offset1:1
  ds_read2st64_b32 v[106:107], v13 offset0:8 offset1:9
  ds_read2st64_b32 v[108:109], v13 offset0:2 offset1:3
  ds_read2st64_b32 v[110:111], v13 offset0:10 offset1:11
  s_waitcnt lgkmcnt(4)
  v_perm_b32 v116, v97, v96, s57
  v_perm_b32 v117, v99, v98, s57
  v_perm_b32 v118, v101, v100, s57
  v_perm_b32 v119, v103, v102, s57
  v_perm_b32 v112, v97, v96, s56
  v_perm_b32 v113, v99, v98, s56
  v_perm_b32 v114, v101, v100, s56
  v_perm_b32 v115, v103, v102, s56
  v_accvgpr_write_b32 a8, v116
  v_accvgpr_write_b32 a9, v117
  v_accvgpr_write_b32 a10, v118
  v_accvgpr_write_b32 a11, v119
  v_accvgpr_write_b32 a0, v112
  v_accvgpr_write_b32 a1, v113
  v_accvgpr_write_b32 a2, v114
  v_accvgpr_write_b32 a3, v115
  v_xor_b32 v12, 16384, v5
  ds_read2st64_b32 v[96:97], v12 offset0:0 offset1:1
  ds_read2st64_b32 v[98:99], v12 offset0:8 offset1:9
  ds_read2st64_b32 v[100:101], v12 offset0:2 offset1:3
  ds_read2st64_b32 v[102:103], v12 offset0:10 offset1:11
  s_waitcnt lgkmcnt(4)
  v_perm_b32 v116, v105, v104, s57
  v_perm_b32 v117, v107, v106, s57
  v_perm_b32 v118, v109, v108, s57
  v_perm_b32 v119, v111, v110, s57
  v_perm_b32 v112, v105, v104, s56
  v_perm_b32 v113, v107, v106, s56
  v_perm_b32 v114, v109, v108, s56
  v_perm_b32 v115, v111, v110, s56
  v_accvgpr_write_b32 a40, v116
  v_accvgpr_write_b32 a41, v117
  v_accvgpr_write_b32 a42, v118
  v_accvgpr_write_b32 a43, v119
  v_accvgpr_write_b32 a32, v112
  v_accvgpr_write_b32 a33, v113
  v_accvgpr_write_b32 a34, v114
  v_accvgpr_write_b32 a35, v115
  v_xor_b32 v13, 24576, v5
  ds_read2st64_b32 v[104:105], v13 offset0:0 offset1:1
  ds_read2st64_b32 v[106:107], v13 offset0:8 offset1:9
  ds_read2st64_b32 v[108:109], v13 offset0:2 offset1:3
  ds_read2st64_b32 v[110:111], v13 offset0:10 offset1:11
  s_waitcnt lgkmcnt(4)
  v_perm_b32 v116, v97, v96, s57
  v_perm_b32 v117, v99, v98, s57
  v_perm_b32 v118, v101, v100, s57
  v_perm_b32 v119, v103, v102, s57
  v_perm_b32 v112, v97, v96, s56
  v_perm_b32 v113, v99, v98, s56
  v_perm_b32 v114, v101, v100, s56
  v_perm_b32 v115, v103, v102, s56
  v_accvgpr_write_b32 a72, v116
  v_accvgpr_write_b32 a73, v117
  v_accvgpr_write_b32 a74, v118
  v_accvgpr_write_b32 a75, v119
  v_accvgpr_write_b32 a64, v112
  v_accvgpr_write_b32 a65, v113
  v_accvgpr_write_b32 a66, v114
  v_accvgpr_write_b32 a67, v115
  s_waitcnt lgkmcnt(0)
  v_perm_b32 v116, v105, v104, s57
  v_perm_b32 v117, v107, v106, s57
  v_perm_b32 v118, v109, v108, s57
  v_perm_b32 v119, v111, v110, s57
  v_perm_b32 v112, v105, v104, s56
  v_perm_b32 v113, v107, v106, s56
  v_perm_b32 v114, v109, v108, s56
  v_perm_b32 v115, v111, v110, s56
  v_accvgpr_write_b32 a104, v116
  v_accvgpr_write_b32 a105, v117
  v_accvgpr_write_b32 a106, v118
  v_accvgpr_write_b32 a107, v119
  v_accvgpr_write_b32 a96, v112
  v_accvgpr_write_b32 a97, v113
  v_accvgpr_write_b32 a98, v114
  v_accvgpr_write_b32 a99, v115
  s_waitcnt vmcnt(24)
  s_barrier
  s_add_u32 m0, s53, 0
  s_mov_b32 s59, 262144
  buffer_load_dwordx4 v10, s[36:39], s59 offen lds
  s_add_u32 m0, s53, 1024
  s_mov_b32 s59, 294912
  buffer_load_dwordx4 v11, s[36:39], s59 offen lds
  s_add_u32 m0, s53, 2048
  s_mov_b32 s59, 327680
  buffer_load_dwordx4 v10, s[36:39], s59 offen lds
  s_add_u32 m0, s53, 3072
  s_mov_b32 s59, 360448
  buffer_load_dwordx4 v11, s[36:39], s59 offen lds
  s_add_u32 m0, s53, 4096
  s_mov_b32 s59, 393216
  buffer_load_dwordx4 v10, s[36:39], s59 offen lds
  s_add_u32 m0, s53, 5120
  s_mov_b32 s59, 425984
  buffer_load_dwordx4 v11, s[36:39], s59 offen lds
  s_add_u32 m0, s53, 6144
  s_mov_b32 s59, 458752
  buffer_load_dwordx4 v10, s[36:39], s59 offen lds
  s_add_u32 m0, s53, 7168
  s_mov_b32 s59, 491520
  buffer_load_dwordx4 v11, s[36:39], s59 offen lds
  v_xor_b32 v12, 32768, v5
  ds_read2st64_b32 v[96:97], v12 offset0:0 offset1:1
  ds_read2st64_b32 v[98:99], v12 offset0:8 offset1:9
  ds_read2st64_b32 v[100:101], v12 offset0:2 offset1:3
  ds_read2st64_b32 v[102:103], v12 offset0:10 offset1:11
  v_xor_b32 v13, 40960, v5
  ds_read2st64_b32 v[104:105], v13 offset0:0 offset1:1
  ds_read2st64_b32 v[106:107], v13 offset0:8 offset1:9
  ds_read2st64_b32 v[108:109], v13 offset0:2 offset1:3
  ds_read2st64_b32 v[110:111], v13 offset0:10 offset1:11
  s_waitcnt lgkmcnt(4)
  v_perm_b32 v116, v97, v96, s57
  v_perm_b32 v117, v99, v98, s57
  v_perm_b32 v118, v101, v100, s57
  v_perm_b32 v119, v103, v102, s57
  v_perm_b32 v112, v97, v96, s56
  v_perm_b32 v113, v99, v98, s56
  v_perm_b32 v114, v101, v100, s56
  v_perm_b32 v115, v103, v102, s56
  v_accvgpr_write_b32 a12, v116
  v_accvgpr_write_b32 a13, v117
  v_accvgpr_write_b32 a14, v118
  v_accvgpr_write_b32 a15, v119
  v_accvgpr_write_b32 a4, v112
  v_accvgpr_write_b32 a5, v113
  v_accvgpr_write_b32 a6, v114
  v_accvgpr_write_b32 a7, v115
  v_xor_b32 v12, 49152, v5
  ds_read2st64_b32 v[96:97], v12 offset0:0 offset1:1
  ds_read2st64_b32 v[98:99], v12 offset0:8 offset1:9
  ds_read2st64_b32 v[100:101], v12 offset0:2 offset1:3
  ds_read2st64_b32 v[102:103], v12 offset0:10 offset1:11
  s_waitcnt lgkmcnt(4)
  v_perm_b32 v116, v105, v104, s57
  v_perm_b32 v117, v107, v106, s57
  v_perm_b32 v118, v109, v108, s57
  v_perm_b32 v119, v111, v110, s57
  v_perm_b32 v112, v105, v104, s56
  v_perm_b32 v113, v107, v106, s56
  v_perm_b32 v114, v109, v108, s56
  v_perm_b32 v115, v111, v110, s56
  v_accvgpr_write_b32 a44, v116
  v_accvgpr_write_b32 a45, v117
  v_accvgpr_write_b32 a46, v118
  v_accvgpr_write_b32 a47, v119
  v_accvgpr_write_b32 a36, v112
  v_accvgpr_write_b32 a37, v113
  v_accvgpr_write_b32 a38, v114
  v_accvgpr_write_b32 a39, v115
  v_xor_b32 v13, 57344, v5
  ds_read2st64_b32 v[104:105], v13 offset0:0 offset1:1
  ds_read2st64_b32 v[106:107], v13 offset0:8 offset1:9
  ds_read2st64_b32 v[108:109], v13 offset0:2 offset1:3
  ds_read2st64_b32 v[110:111], v13 offset0:10 offset1:11
  s_waitcnt lgkmcnt(4)
  v_perm_b32 v116, v97, v96, s57
  v_perm_b32 v117, v99, v98, s57
  v_perm_b32 v118, v101, v100, s57
  v_perm_b32 v119, v103, v102, s57
  v_perm_b32 v112, v97, v96, s56
  v_perm_b32 v113, v99, v98, s56
  v_perm_b32 v114, v101, v100, s56
  v_perm_b32 v115, v103, v102, s56
  v_accvgpr_write_b32 a76, v116
  v_accvgpr_write_b32 a77, v117
  v_accvgpr_write_b32 a78, v118
  v_accvgpr_write_b32 a79, v119
  v_accvgpr_write_b32 a68, v112
  v_accvgpr_write_b32 a69, v113
  v_accvgpr_write_b32 a70, v114
  v_accvgpr_write_b32 a71, v115
  s_waitcnt lgkmcnt(0)
  v_perm_b32 v116, v105, v104, s57
  v_perm_b32 v117, v107, v106, s57
  v_perm_b32 v118, v109, v108, s57
  v_perm_b32 v119, v111, v110, s57
  v_perm_b32 v112, v105, v104, s56
  v_perm_b32 v113, v107, v106, s56
  v_perm_b32 v114, v109, v108, s56
  v_perm_b32 v115, v111, v110, s56
  v_accvgpr_write_b32 a108, v116
  v_accvgpr_write_b32 a109, v117
  v_accvgpr_write_b32 a110, v118
  v_accvgpr_write_b32 a111, v119
  v_accvgpr_write_b32 a100, v112
  v_accvgpr_write_b32 a101, v113
  v_accvgpr_write_b32 a102, v114
  v_accvgpr_write_b32 a103, v115
  s_waitcnt vmcnt(24)
  s_barrier
  s_add_u32 m0, s53, 32768
  s_mov_b32 s59, 524288
  buffer_load_dwordx4 v10, s[36:39], s59 offen lds
  s_add_u32 m0, s53, 33792
  s_mov_b32 s59, 557056
  buffer_load_dwordx4 v11, s[36:39], s59 offen lds
  s_add_u32 m0, s53, 34816
  s_mov_b32 s59, 589824
  buffer_load_dwordx4 v10, s[36:39], s59 offen lds
  s_add_u32 m0, s53, 35840
  s_mov_b32 s59, 622592
  buffer_load_dwordx4 v11, s[36:39], s59 offen lds
  s_add_u32 m0, s53, 36864
  s_mov_b32 s59, 655360
  buffer_load_dwordx4 v10, s[36:39], s59 offen lds
  s_add_u32 m0, s53, 37888
  s_mov_b32 s59, 688128
  buffer_load_dwordx4 v11, s[36:39], s59 offen lds
  s_add_u32 m0, s53, 38912
  s_mov_b32 s59, 720896
  buffer_load_dwordx4 v10, s[36:39], s59 offen lds
  s_add_u32 m0, s53, 39936
  s_mov_b32 s59, 753664
  buffer_load_dwordx4 v11, s[36:39], s59 offen lds
  v_xor_b32 v12, 65536, v5
  ds_read2st64_b32 v[96:97], v12 offset0:0 offset1:1
  ds_read2st64_b32 v[98:99], v12 offset0:8 offset1:9
  ds_read2st64_b32 v[100:101], v12 offset0:2 offset1:3
  ds_read2st64_b32 v[102:103], v12 offset0:10 offset1:11
  v_xor_b32 v13, 73728, v5
  ds_read2st64_b32 v[104:105], v13 offset0:0 offset1:1
  ds_read2st64_b32 v[106:107], v13 offset0:8 offset1:9
  ds_read2st64_b32 v[108:109], v13 offset0:2 offset1:3
  ds_read2st64_b32 v[110:111], v13 offset0:10 offset1:11
  s_waitcnt lgkmcnt(4)
  v_perm_b32 v116, v97, v96, s57
  v_perm_b32 v117, v99, v98, s57
  v_perm_b32 v118, v101, v100, s57
  v_perm_b32 v119, v103, v102, s57
  v_perm_b32 v112, v97, v96, s56
  v_perm_b32 v113, v99, v98, s56
  v_perm_b32 v114, v101, v100, s56
  v_perm_b32 v115, v103, v102, s56
  v_accvgpr_write_b32 a24, v116
  v_accvgpr_write_b32 a25, v117
  v_accvgpr_write_b32 a26, v118
  v_accvgpr_write_b32 a27, v119
  v_accvgpr_write_b32 a16, v112
  v_accvgpr_write_b32 a17, v113
  v_accvgpr_write_b32 a18, v114
  v_accvgpr_write_b32 a19, v115
  v_xor_b32 v12, 81920, v5
  ds_read2st64_b32 v[96:97], v12 offset0:0 offset1:1
  ds_read2st64_b32 v[98:99], v12 offset0:8 offset1:9
  ds_read2st64_b32 v[100:101], v12 offset0:2 offset1:3
  ds_read2st64_b32 v[102:103], v12 offset0:10 offset1:11
  s_waitcnt lgkmcnt(4)
  v_perm_b32 v116, v105, v104, s57
  v_perm_b32 v117, v107, v106, s57
  v_perm_b32 v118, v109, v108, s57
  v_perm_b32 v119, v111, v110, s57
  v_perm_b32 v112, v105, v104, s56
  v_perm_b32 v113, v107, v106, s56
  v_perm_b32 v114, v109, v108, s56
  v_perm_b32 v115, v111, v110, s56
  v_accvgpr_write_b32 a56, v116
  v_accvgpr_write_b32 a57, v117
  v_accvgpr_write_b32 a58, v118
  v_accvgpr_write_b32 a59, v119
  v_accvgpr_write_b32 a48, v112
  v_accvgpr_write_b32 a49, v113
  v_accvgpr_write_b32 a50, v114
  v_accvgpr_write_b32 a51, v115
  v_xor_b32 v13, 90112, v5
  ds_read2st64_b32 v[104:105], v13 offset0:0 offset1:1
  ds_read2st64_b32 v[106:107], v13 offset0:8 offset1:9
  ds_read2st64_b32 v[108:109], v13 offset0:2 offset1:3
  ds_read2st64_b32 v[110:111], v13 offset0:10 offset1:11
  s_waitcnt lgkmcnt(4)
  v_perm_b32 v116, v97, v96, s57
  v_perm_b32 v117, v99, v98, s57
  v_perm_b32 v118, v101, v100, s57
  v_perm_b32 v119, v103, v102, s57
  v_perm_b32 v112, v97, v96, s56
  v_perm_b32 v113, v99, v98, s56
  v_perm_b32 v114, v101, v100, s56
  v_perm_b32 v115, v103, v102, s56
  v_accvgpr_write_b32 a88, v116
  v_accvgpr_write_b32 a89, v117
  v_accvgpr_write_b32 a90, v118
  v_accvgpr_write_b32 a91, v119
  v_accvgpr_write_b32 a80, v112
  v_accvgpr_write_b32 a81, v113
  v_accvgpr_write_b32 a82, v114
  v_accvgpr_write_b32 a83, v115
  s_waitcnt lgkmcnt(0)
  v_perm_b32 v116, v105, v104, s57
  v_perm_b32 v117, v107, v106, s57
  v_perm_b32 v118, v109, v108, s57
  v_perm_b32 v119, v111, v110, s57
  v_perm_b32 v112, v105, v104, s56
  v_perm_b32 v113, v107, v106, s56
  v_perm_b32 v114, v109, v108, s56
  v_perm_b32 v115, v111, v110, s56
  v_accvgpr_write_b32 a120, v116
  v_accvgpr_write_b32 a121, v117
  v_accvgpr_write_b32 a122, v118
  v_accvgpr_write_b32 a123, v119
  v_accvgpr_write_b32 a112, v112
  v_accvgpr_write_b32 a113, v113
  v_accvgpr_write_b32 a114, v114
  v_accvgpr_write_b32 a115, v115
  s_waitcnt vmcnt(24)
  s_barrier
  s_add_u32 m0, s53, 65536
  s_mov_b32 s59, 786432
  buffer_load_dwordx4 v10, s[36:39], s59 offen lds
  s_add_u32 m0, s53, 66560
  s_mov_b32 s59, 819200
  buffer_load_dwordx4 v11, s[36:39], s59 offen lds
  s_add_u32 m0, s53, 67584
  s_mov_b32 s59, 851968
  buffer_load_dwordx4 v10, s[36:39], s59 offen lds
  s_add_u32 m0, s53, 68608
  s_mov_b32 s59, 884736
  buffer_load_dwordx4 v11, s[36:39], s59 offen lds
  s_add_u32 m0, s53, 69632
  s_mov_b32 s59, 917504
  buffer_load_dwordx4 v10, s[36:39], s59 offen lds
  s_add_u32 m0, s53, 70656
  s_mov_b32 s59, 950272
  buffer_load_dwordx4 v11, s[36:39], s59 offen lds
  s_add_u32 m0, s53, 71680
  s_mov_b32 s59, 983040
  buffer_load_dwordx4 v10, s[36:39], s59 offen lds
  s_add_u32 m0, s53, 72704
  s_mov_b32 s59, 1015808
  buffer_load_dwordx4 v11, s[36:39], s59 offen lds
  v_xor_b32 v12, 98304, v5
  ds_read2st64_b32 v[96:97], v12 offset0:0 offset1:1
  ds_read2st64_b32 v[98:99], v12 offset0:8 offset1:9
  ds_read2st64_b32 v[100:101], v12 offset0:2 offset1:3
  ds_read2st64_b32 v[102:103], v12 offset0:10 offset1:11
  v_xor_b32 v13, 106496, v5
  ds_read2st64_b32 v[104:105], v13 offset0:0 offset1:1
  ds_read2st64_b32 v[106:107], v13 offset0:8 offset1:9
  ds_read2st64_b32 v[108:109], v13 offset0:2 offset1:3
  ds_read2st64_b32 v[110:111], v13 offset0:10 offset1:11
  s_waitcnt lgkmcnt(4)
  v_perm_b32 v116, v97, v96, s57
  v_perm_b32 v117, v99, v98, s57
  v_perm_b32 v118, v101, v100, s57
  v_perm_b32 v119, v103, v102, s57
  v_perm_b32 v112, v97, v96, s56
  v_perm_b32 v113, v99, v98, s56
  v_perm_b32 v114, v101, v100, s56
  v_perm_b32 v115, v103, v102, s56
  v_accvgpr_write_b32 a28, v116
  v_accvgpr_write_b32 a29, v117
  v_accvgpr_write_b32 a30, v118
  v_accvgpr_write_b32 a31, v119
  v_accvgpr_write_b32 a20, v112
  v_accvgpr_write_b32 a21, v113
  v_accvgpr_write_b32 a22, v114
  v_accvgpr_write_b32 a23, v115
  v_xor_b32 v12, 114688, v5
  ds_read2st64_b32 v[96:97], v12 offset0:0 offset1:1
  ds_read2st64_b32 v[98:99], v12 offset0:8 offset1:9
  ds_read2st64_b32 v[100:101], v12 offset0:2 offset1:3
  ds_read2st64_b32 v[102:103], v12 offset0:10 offset1:11
  s_waitcnt lgkmcnt(4)
  v_perm_b32 v116, v105, v104, s57
  v_perm_b32 v117, v107, v106, s57
  v_perm_b32 v118, v109, v108, s57
  v_perm_b32 v119, v111, v110, s57
  v_perm_b32 v112, v105, v104, s56
  v_perm_b32 v113, v107, v106, s56
  v_perm_b32 v114, v109, v108, s56
  v_perm_b32 v115, v111, v110, s56
  v_accvgpr_write_b32 a60, v116
  v_accvgpr_write_b32 a61, v117
  v_accvgpr_write_b32 a62, v118
  v_accvgpr_write_b32 a63, v119
  v_accvgpr_write_b32 a52, v112
  v_accvgpr_write_b32 a53, v113
  v_accvgpr_write_b32 a54, v114
  v_accvgpr_write_b32 a55, v115
  v_xor_b32 v13, 122880, v5
  ds_read2st64_b32 v[104:105], v13 offset0:0 offset1:1
  ds_read2st64_b32 v[106:107], v13 offset0:8 offset1:9
  ds_read2st64_b32 v[108:109], v13 offset0:2 offset1:3
  ds_read2st64_b32 v[110:111], v13 offset0:10 offset1:11
  s_waitcnt lgkmcnt(4)
  v_perm_b32 v116, v97, v96, s57
  v_perm_b32 v117, v99, v98, s57
  v_perm_b32 v118, v101, v100, s57
  v_perm_b32 v119, v103, v102, s57
  v_perm_b32 v112, v97, v96, s56
  v_perm_b32 v113, v99, v98, s56
  v_perm_b32 v114, v101, v100, s56
  v_perm_b32 v115, v103, v102, s56
  v_accvgpr_write_b32 a92, v116
  v_accvgpr_write_b32 a93, v117
  v_accvgpr_write_b32 a94, v118
  v_accvgpr_write_b32 a95, v119
  v_accvgpr_write_b32 a84, v112
  v_accvgpr_write_b32 a85, v113
  v_accvgpr_write_b32 a86, v114
  v_accvgpr_write_b32 a87, v115
  s_waitcnt lgkmcnt(0)
  v_perm_b32 v116, v105, v104, s57
  v_perm_b32 v117, v107, v106, s57
  v_perm_b32 v118, v109, v108, s57
  v_perm_b32 v119, v111, v110, s57
  v_perm_b32 v112, v105, v104, s56
  v_perm_b32 v113, v107, v106, s56
  v_perm_b32 v114, v109, v108, s56
  v_perm_b32 v115, v111, v110, s56
  v_accvgpr_write_b32 a124, v116
  v_accvgpr_write_b32 a125, v117
  v_accvgpr_write_b32 a126, v118
  v_accvgpr_write_b32 a127, v119
  v_accvgpr_write_b32 a116, v112
  v_accvgpr_write_b32 a117, v113
  v_accvgpr_write_b32 a118, v114
  v_accvgpr_write_b32 a119, v115
  s_waitcnt vmcnt(24)
  s_barrier
  s_add_u32 m0, s53, 98304
  s_mov_b32 s59, 0
  buffer_load_dwordx4 v10, s[40:43], s59 offen lds
  s_add_u32 m0, s53, 99328
  s_mov_b32 s59, 32768
  buffer_load_dwordx4 v11, s[40:43], s59 offen lds
  s_add_u32 m0, s53, 100352
  s_mov_b32 s59, 65536
  buffer_load_dwordx4 v10, s[40:43], s59 offen lds
  s_add_u32 m0, s53, 101376
  s_mov_b32 s59, 98304
  buffer_load_dwordx4 v11, s[40:43], s59 offen lds
  s_add_u32 m0, s53, 102400
  s_mov_b32 s59, 131072
  buffer_load_dwordx4 v10, s[40:43], s59 offen lds
  s_add_u32 m0, s53, 103424
  s_mov_b32 s59, 163840
  buffer_load_dwordx4 v11, s[40:43], s59 offen lds
  s_add_u32 m0, s53, 104448
  s_mov_b32 s59, 196608
  buffer_load_dwordx4 v10, s[40:43], s59 offen lds
  s_add_u32 m0, s53, 105472
  s_mov_b32 s59, 229376
  buffer_load_dwordx4 v11, s[40:43], s59 offen lds
  v_xor_b32 v12, 131072, v4
  ds_read2st64_b32 v[96:97], v12 offset0:0 offset1:1
  ds_read2st64_b32 v[98:99], v12 offset0:8 offset1:9
  ds_read2st64_b32 v[100:101], v12 offset0:2 offset1:3
  ds_read2st64_b32 v[102:103], v12 offset0:10 offset1:11
  v_xor_b32 v13, 139264, v4
  ds_read2st64_b32 v[104:105], v13 offset0:0 offset1:1
  ds_read2st64_b32 v[106:107], v13 offset0:8 offset1:9
  ds_read2st64_b32 v[108:109], v13 offset0:2 offset1:3
  ds_read2st64_b32 v[110:111], v13 offset0:10 offset1:11
  s_waitcnt lgkmcnt(4)
  v_perm_b32 v116, v97, v96, s57
  v_perm_b32 v117, v99, v98, s57
  v_perm_b32 v118, v101, v100, s57
  v_perm_b32 v119, v103, v102, s57
  v_perm_b32 v128, v97, v96, s56
  v_perm_b32 v129, v99, v98, s56
  v_perm_b32 v130, v101, v100, s56
  v_perm_b32 v131, v103, v102, s56
  v_accvgpr_write_b32 a128, v116
  v_accvgpr_write_b32 a129, v117
  v_accvgpr_write_b32 a130, v118
  v_accvgpr_write_b32 a131, v119
  v_xor_b32 v12, 147456, v4
  ds_read2st64_b32 v[96:97], v12 offset0:0 offset1:1
  ds_read2st64_b32 v[98:99], v12 offset0:8 offset1:9
  ds_read2st64_b32 v[100:101], v12 offset0:2 offset1:3
  ds_read2st64_b32 v[102:103], v12 offset0:10 offset1:11
  s_waitcnt lgkmcnt(4)
  v_perm_b32 v116, v105, v104, s57
  v_perm_b32 v117, v107, v106, s57
  v_perm_b32 v118, v109, v108, s57
  v_perm_b32 v119, v111, v110, s57
  v_perm_b32 v160, v105, v104, s56
  v_perm_b32 v161, v107, v106, s56
  v_perm_b32 v162, v109, v108, s56
  v_perm_b32 v163, v111, v110, s56
  v_accvgpr_write_b32 a160, v116
  v_accvgpr_write_b32 a161, v117
  v_accvgpr_write_b32 a162, v118
  v_accvgpr_write_b32 a163, v119
  v_xor_b32 v13, 155648, v4
  ds_read2st64_b32 v[104:105], v13 offset0:0 offset1:1
  ds_read2st64_b32 v[106:107], v13 offset0:8 offset1:9
  ds_read2st64_b32 v[108:109], v13 offset0:2 offset1:3
  ds_read2st64_b32 v[110:111], v13 offset0:10 offset1:11
  s_waitcnt lgkmcnt(4)
  v_perm_b32 v116, v97, v96, s57
  v_perm_b32 v117, v99, v98, s57
  v_perm_b32 v118, v101, v100, s57
  v_perm_b32 v119, v103, v102, s57
  v_perm_b32 v192, v97, v96, s56
  v_perm_b32 v193, v99, v98, s56
  v_perm_b32 v194, v101, v100, s56
  v_perm_b32 v195, v103, v102, s56
  v_accvgpr_write_b32 a192, v116
  v_accvgpr_write_b32 a193, v117
  v_accvgpr_write_b32 a194, v118
  v_accvgpr_write_b32 a195, v119
  s_waitcnt lgkmcnt(0)
  v_perm_b32 v116, v105, v104, s57
  v_perm_b32 v117, v107, v106, s57
  v_perm_b32 v118, v109, v108, s57
  v_perm_b32 v119, v111, v110, s57
  v_perm_b32 v224, v105, v104, s56
  v_perm_b32 v225, v107, v106, s56
  v_perm_b32 v226, v109, v108, s56
  v_perm_b32 v227, v111, v110, s56
  v_accvgpr_write_b32 a224, v116
  v_accvgpr_write_b32 a225, v117
  v_accvgpr_write_b32 a226, v118
  v_accvgpr_write_b32 a227, v119
  s_waitcnt vmcnt(24)
  s_barrier
  s_add_u32 m0, s53, 131072
  s_mov_b32 s59, 262144
  buffer_load_dwordx4 v10, s[40:43], s59 offen lds
  s_add_u32 m0, s53, 132096
  s_mov_b32 s59, 294912
  buffer_load_dwordx4 v11, s[40:43], s59 offen lds
  s_add_u32 m0, s53, 133120
  s_mov_b32 s59, 327680
  buffer_load_dwordx4 v10, s[40:43], s59 offen lds
  s_add_u32 m0, s53, 134144
  s_mov_b32 s59, 360448
  buffer_load_dwordx4 v11, s[40:43], s59 offen lds
  s_add_u32 m0, s53, 135168
  s_mov_b32 s59, 393216
  buffer_load_dwordx4 v10, s[40:43], s59 offen lds
  s_add_u32 m0, s53, 136192
  s_mov_b32 s59, 425984
  buffer_load_dwordx4 v11, s[40:43], s59 offen lds
  s_add_u32 m0, s53, 137216
  s_mov_b32 s59, 458752
  buffer_load_dwordx4 v10, s[40:43], s59 offen lds
  s_add_u32 m0, s53, 138240
  s_mov_b32 s59, 491520
  buffer_load_dwordx4 v11, s[40:43], s59 offen lds
  v_xor_b32 v12, 0, v4
  ds_read2st64_b32 v[96:97], v12 offset0:0 offset1:1
  ds_read2st64_b32 v[98:99], v12 offset0:8 offset1:9
  ds_read2st64_b32 v[100:101], v12 offset0:2 offset1:3
  ds_read2st64_b32 v[102:103], v12 offset0:10 offset1:11
  v_xor_b32 v13, 8192, v4
  ds_read2st64_b32 v[104:105], v13 offset0:0 offset1:1
  ds_read2st64_b32 v[106:107], v13 offset0:8 offset1:9
  ds_read2st64_b32 v[108:109], v13 offset0:2 offset1:3
  ds_read2st64_b32 v[110:111], v13 offset0:10 offset1:11
  s_waitcnt lgkmcnt(4)
  v_perm_b32 v116, v97, v96, s57
  v_perm_b32 v117, v99, v98, s57
  v_perm_b32 v118, v101, v100, s57
  v_perm_b32 v119, v103, v102, s57
  v_perm_b32 v132, v97, v96, s56
  v_perm_b32 v133, v99, v98, s56
  v_perm_b32 v134, v101, v100, s56
  v_perm_b32 v135, v103, v102, s56
  v_accvgpr_write_b32 a132, v116
  v_accvgpr_write_b32 a133, v117
  v_accvgpr_write_b32 a134, v118
  v_accvgpr_write_b32 a135, v119
  v_xor_b32 v12, 16384, v4
  ds_read2st64_b32 v[96:97], v12 offset0:0 offset1:1
  ds_read2st64_b32 v[98:99], v12 offset0:8 offset1:9
  ds_read2st64_b32 v[100:101], v12 offset0:2 offset1:3
  ds_read2st64_b32 v[102:103], v12 offset0:10 offset1:11
  s_waitcnt lgkmcnt(4)
  v_perm_b32 v116, v105, v104, s57
  v_perm_b32 v117, v107, v106, s57
  v_perm_b32 v118, v109, v108, s57
  v_perm_b32 v119, v111, v110, s57
  v_perm_b32 v164, v105, v104, s56
  v_perm_b32 v165, v107, v106, s56
  v_perm_b32 v166, v109, v108, s56
  v_perm_b32 v167, v111, v110, s56
  v_accvgpr_write_b32 a164, v116
  v_accvgpr_write_b32 a165, v117
  v_accvgpr_write_b32 a166, v118
  v_accvgpr_write_b32 a167, v119
  v_xor_b32 v13, 24576, v4
  ds_read2st64_b32 v[104:105], v13 offset0:0 offset1:1
  ds_read2st64_b32 v[106:107], v13 offset0:8 offset1:9
  ds_read2st64_b32 v[108:109], v13 offset0:2 offset1:3
  ds_read2st64_b32 v[110:111], v13 offset0:10 offset1:11
  s_waitcnt lgkmcnt(4)
  v_perm_b32 v116, v97, v96, s57
  v_perm_b32 v117, v99, v98, s57
  v_perm_b32 v118, v101, v100, s57
  v_perm_b32 v119, v103, v102, s57
  v_perm_b32 v196, v97, v96, s56
  v_perm_b32 v197, v99, v98, s56
  v_perm_b32 v198, v101, v100, s56
  v_perm_b32 v199, v103, v102, s56
  v_accvgpr_write_b32 a196, v116
  v_accvgpr_write_b32 a197, v117
  v_accvgpr_write_b32 a198, v118
  v_accvgpr_write_b32 a199, v119
  s_waitcnt lgkmcnt(0)
  v_perm_b32 v116, v105, v104, s57
  v_perm_b32 v117, v107, v106, s57
  v_perm_b32 v118, v109, v108, s57
  v_perm_b32 v119, v111, v110, s57
  v_perm_b32 v228, v105, v104, s56
  v_perm_b32 v229, v107, v106, s56
  v_perm_b32 v230, v109, v108, s56
  v_perm_b32 v231, v111, v110, s56
  v_accvgpr_write_b32 a228, v116
  v_accvgpr_write_b32 a229, v117
  v_accvgpr_write_b32 a230, v118
  v_accvgpr_write_b32 a231, v119
  s_waitcnt vmcnt(24)
  s_barrier
  s_add_u32 m0, s53, 0
  s_mov_b32 s59, 524288
  buffer_load_dwordx4 v10, s[40:43], s59 offen lds
  s_add_u32 m0, s53, 1024
  s_mov_b32 s59, 557056
  buffer_load_dwordx4 v11, s[40:43], s59 offen lds
  s_add_u32 m0, s53, 2048
  s_mov_b32 s59, 589824
  buffer_load_dwordx4 v10, s[40:43], s59 offen lds
  s_add_u32 m0, s53, 3072
  s_mov_b32 s59, 622592
  buffer_load_dwordx4 v11, s[40:43], s59 offen lds
  s_add_u32 m0, s53, 4096
  s_mov_b32 s59, 655360
  buffer_load_dwordx4 v10, s[40:43], s59 offen lds
  s_add_u32 m0, s53, 5120
  s_mov_b32 s59, 688128
  buffer_load_dwordx4 v11, s[40:43], s59 offen lds
  s_add_u32 m0, s53, 6144
  s_mov_b32 s59, 720896
  buffer_load_dwordx4 v10, s[40:43], s59 offen lds
  s_add_u32 m0, s53, 7168
  s_mov_b32 s59, 753664
  buffer_load_dwordx4 v11, s[40:43], s59 offen lds
  v_xor_b32 v12, 32768, v4
  ds_read2st64_b32 v[96:97], v12 offset0:0 offset1:1
  ds_read2st64_b32 v[98:99], v12 offset0:8 offset1:9
  ds_read2st64_b32 v[100:101], v12 offset0:2 offset1:3
  ds_read2st64_b32 v[102:103], v12 offset0:10 offset1:11
  v_xor_b32 v13, 40960, v4
  ds_read2st64_b32 v[104:105], v13 offset0:0 offset1:1
  ds_read2st64_b32 v[106:107], v13 offset0:8 offset1:9
  ds_read2st64_b32 v[108:109], v13 offset0:2 offset1:3
  ds_read2st64_b32 v[110:111], v13 offset0:10 offset1:11
  s_waitcnt lgkmcnt(4)
  v_perm_b32 v116, v97, v96, s57
  v_perm_b32 v117, v99, v98, s57
  v_perm_b32 v118, v101, v100, s57
  v_perm_b32 v119, v103, v102, s57
  v_perm_b32 v144, v97, v96, s56
  v_perm_b32 v145, v99, v98, s56
  v_perm_b32 v146, v101, v100, s56
  v_perm_b32 v147, v103, v102, s56
  v_accvgpr_write_b32 a144, v116
  v_accvgpr_write_b32 a145, v117
  v_accvgpr_write_b32 a146, v118
  v_accvgpr_write_b32 a147, v119
  v_xor_b32 v12, 49152, v4
  ds_read2st64_b32 v[96:97], v12 offset0:0 offset1:1
  ds_read2st64_b32 v[98:99], v12 offset0:8 offset1:9
  ds_read2st64_b32 v[100:101], v12 offset0:2 offset1:3
  ds_read2st64_b32 v[102:103], v12 offset0:10 offset1:11
  s_waitcnt lgkmcnt(4)
  v_perm_b32 v116, v105, v104, s57
  v_perm_b32 v117, v107, v106, s57
  v_perm_b32 v118, v109, v108, s57
  v_perm_b32 v119, v111, v110, s57
  v_perm_b32 v176, v105, v104, s56
  v_perm_b32 v177, v107, v106, s56
  v_perm_b32 v178, v109, v108, s56
  v_perm_b32 v179, v111, v110, s56
  v_accvgpr_write_b32 a176, v116
  v_accvgpr_write_b32 a177, v117
  v_accvgpr_write_b32 a178, v118
  v_accvgpr_write_b32 a179, v119
  v_xor_b32 v13, 57344, v4
  ds_read2st64_b32 v[104:105], v13 offset0:0 offset1:1
  ds_read2st64_b32 v[106:107], v13 offset0:8 offset1:9
  ds_read2st64_b32 v[108:109], v13 offset0:2 offset1:3
  ds_read2st64_b32 v[110:111], v13 offset0:10 offset1:11
  s_waitcnt lgkmcnt(4)
  v_perm_b32 v116, v97, v96, s57
  v_perm_b32 v117, v99, v98, s57
  v_perm_b32 v118, v101, v100, s57
  v_perm_b32 v119, v103, v102, s57
  v_perm_b32 v208, v97, v96, s56
  v_perm_b32 v209, v99, v98, s56
  v_perm_b32 v210, v101, v100, s56
  v_perm_b32 v211, v103, v102, s56
  v_accvgpr_write_b32 a208, v116
  v_accvgpr_write_b32 a209, v117
  v_accvgpr_write_b32 a210, v118
  v_accvgpr_write_b32 a211, v119
  s_waitcnt lgkmcnt(0)
  v_perm_b32 v116, v105, v104, s57
  v_perm_b32 v117, v107, v106, s57
  v_perm_b32 v118, v109, v108, s57
  v_perm_b32 v119, v111, v110, s57
  v_perm_b32 v240, v105, v104, s56
  v_perm_b32 v241, v107, v106, s56
  v_perm_b32 v242, v109, v108, s56
  v_perm_b32 v243, v111, v110, s56
  v_accvgpr_write_b32 a240, v116
  v_accvgpr_write_b32 a241, v117
  v_accvgpr_write_b32 a242, v118
  v_accvgpr_write_b32 a243, v119
  s_waitcnt vmcnt(24)
  s_barrier
  s_add_u32 m0, s53, 32768
  s_mov_b32 s59, 786432
  buffer_load_dwordx4 v10, s[40:43], s59 offen lds
  s_add_u32 m0, s53, 33792
  s_mov_b32 s59, 819200
  buffer_load_dwordx4 v11, s[40:43], s59 offen lds
  s_add_u32 m0, s53, 34816
  s_mov_b32 s59, 851968
  buffer_load_dwordx4 v10, s[40:43], s59 offen lds
  s_add_u32 m0, s53, 35840
  s_mov_b32 s59, 884736
  buffer_load_dwordx4 v11, s[40:43], s59 offen lds
  s_add_u32 m0, s53, 36864
  s_mov_b32 s59, 917504
  buffer_load_dwordx4 v10, s[40:43], s59 offen lds
  s_add_u32 m0, s53, 37888
  s_mov_b32 s59, 950272
  buffer_load_dwordx4 v11, s[40:43], s59 offen lds
  s_add_u32 m0, s53, 38912
  s_mov_b32 s59, 983040
  buffer_load_dwordx4 v10, s[40:43], s59 offen lds
  s_add_u32 m0, s53, 39936
  s_mov_b32 s59, 1015808
  buffer_load_dwordx4 v11, s[40:43], s59 offen lds
  v_xor_b32 v12, 65536, v4
  ds_read2st64_b32 v[96:97], v12 offset0:0 offset1:1
  ds_read2st64_b32 v[98:99], v12 offset0:8 offset1:9
  ds_read2st64_b32 v[100:101], v12 offset0:2 offset1:3
  ds_read2st64_b32 v[102:103], v12 offset0:10 offset1:11
  v_xor_b32 v13, 73728, v4
  ds_read2st64_b32 v[104:105], v13 offset0:0 offset1:1
  ds_read2st64_b32 v[106:107], v13 offset0:8 offset1:9
  ds_read2st64_b32 v[108:109], v13 offset0:2 offset1:3
  ds_read2st64_b32 v[110:111], v13 offset0:10 offset1:11
  s_waitcnt lgkmcnt(4)
  v_perm_b32 v116, v97, v96, s57
  v_perm_b32 v117, v99, v98, s57
  v_perm_b32 v118, v101, v100, s57
  v_perm_b32 v119, v103, v102, s57
  v_perm_b32 v148, v97, v96, s56
  v_perm_b32 v149, v99, v98, s56
  v_perm_b32 v150, v101, v100, s56
  v_perm_b32 v151, v103, v102, s56
  v_accvgpr_write_b32 a148, v116
  v_accvgpr_write_b32 a149, v117
  v_accvgpr_write_b32 a150, v118
  v_accvgpr_write_b32 a151, v119
  v_xor_b32 v12, 81920, v4
  ds_read2st64_b32 v[96:97], v12 offset0:0 offset1:1
  ds_read2st64_b32 v[98:99], v12 offset0:8 offset1:9
  ds_read2st64_b32 v[100:101], v12 offset0:2 offset1:3
  ds_read2st64_b32 v[102:103], v12 offset0:10 offset1:11
  s_waitcnt lgkmcnt(4)
  v_perm_b32 v116, v105, v104, s57
  v_perm_b32 v117, v107, v106, s57
  v_perm_b32 v118, v109, v108, s57
  v_perm_b32 v119, v111, v110, s57
  v_perm_b32 v180, v105, v104, s56
  v_perm_b32 v181, v107, v106, s56
  v_perm_b32 v182, v109, v108, s56
  v_perm_b32 v183, v111, v110, s56
  v_accvgpr_write_b32 a180, v116
  v_accvgpr_write_b32 a181, v117
  v_accvgpr_write_b32 a182, v118
  v_accvgpr_write_b32 a183, v119
  v_xor_b32 v13, 90112, v4
  ds_read2st64_b32 v[104:105], v13 offset0:0 offset1:1
  ds_read2st64_b32 v[106:107], v13 offset0:8 offset1:9
  ds_read2st64_b32 v[108:109], v13 offset0:2 offset1:3
  ds_read2st64_b32 v[110:111], v13 offset0:10 offset1:11
  s_waitcnt lgkmcnt(4)
  v_perm_b32 v116, v97, v96, s57
  v_perm_b32 v117, v99, v98, s57
  v_perm_b32 v118, v101, v100, s57
  v_perm_b32 v119, v103, v102, s57
  v_perm_b32 v212, v97, v96, s56
  v_perm_b32 v213, v99, v98, s56
  v_perm_b32 v214, v101, v100, s56
  v_perm_b32 v215, v103, v102, s56
  v_accvgpr_write_b32 a212, v116
  v_accvgpr_write_b32 a213, v117
  v_accvgpr_write_b32 a214, v118
  v_accvgpr_write_b32 a215, v119
  s_waitcnt lgkmcnt(0)
  v_perm_b32 v116, v105, v104, s57
  v_perm_b32 v117, v107, v106, s57
  v_perm_b32 v118, v109, v108, s57
  v_perm_b32 v119, v111, v110, s57
  v_perm_b32 v244, v105, v104, s56
  v_perm_b32 v245, v107, v106, s56
  v_perm_b32 v246, v109, v108, s56
  v_perm_b32 v247, v111, v110, s56
  v_accvgpr_write_b32 a244, v116
  v_accvgpr_write_b32 a245, v117
  v_accvgpr_write_b32 a246, v118
  v_accvgpr_write_b32 a247, v119
  s_waitcnt vmcnt(24)
  s_barrier
  s_xor_b32 s59, s52, 0
  buffer_load_dwordx2 v[32:33], v6, s[48:51], s59 offen
  buffer_load_dwordx2 v[34:35], v6, s[48:51], s59 offen offset:32
  s_xor_b32 s59, s52, 1024
  buffer_load_dwordx2 v[36:37], v6, s[48:51], s59 offen
  buffer_load_dwordx2 v[38:39], v6, s[48:51], s59 offen offset:32
  s_xor_b32 s59, s52, 2048
  buffer_load_dwordx2 v[40:41], v6, s[48:51], s59 offen
  buffer_load_dwordx2 v[42:43], v6, s[48:51], s59 offen offset:32
  s_xor_b32 s59, s52, 3072
  buffer_load_dwordx2 v[44:45], v6, s[48:51], s59 offen
  buffer_load_dwordx2 v[46:47], v6, s[48:51], s59 offen offset:32
  v_xor_b32 v12, 98304, v4
  ds_read2st64_b32 v[96:97], v12 offset0:0 offset1:1
  ds_read2st64_b32 v[98:99], v12 offset0:8 offset1:9
  ds_read2st64_b32 v[100:101], v12 offset0:2 offset1:3
  ds_read2st64_b32 v[102:103], v12 offset0:10 offset1:11
  v_xor_b32 v13, 106496, v4
  ds_read2st64_b32 v[104:105], v13 offset0:0 offset1:1
  ds_read2st64_b32 v[106:107], v13 offset0:8 offset1:9
  ds_read2st64_b32 v[108:109], v13 offset0:2 offset1:3
  ds_read2st64_b32 v[110:111], v13 offset0:10 offset1:11
  s_waitcnt lgkmcnt(4)
  v_perm_b32 v116, v97, v96, s57
  v_perm_b32 v117, v99, v98, s57
  v_perm_b32 v118, v101, v100, s57
  v_perm_b32 v119, v103, v102, s57
  v_perm_b32 v136, v97, v96, s56
  v_perm_b32 v137, v99, v98, s56
  v_perm_b32 v138, v101, v100, s56
  v_perm_b32 v139, v103, v102, s56
  v_accvgpr_write_b32 a136, v116
  v_accvgpr_write_b32 a137, v117
  v_accvgpr_write_b32 a138, v118
  v_accvgpr_write_b32 a139, v119
  v_xor_b32 v12, 114688, v4
  ds_read2st64_b32 v[96:97], v12 offset0:0 offset1:1
  ds_read2st64_b32 v[98:99], v12 offset0:8 offset1:9
  ds_read2st64_b32 v[100:101], v12 offset0:2 offset1:3
  ds_read2st64_b32 v[102:103], v12 offset0:10 offset1:11
  s_waitcnt lgkmcnt(4)
  v_perm_b32 v116, v105, v104, s57
  v_perm_b32 v117, v107, v106, s57
  v_perm_b32 v118, v109, v108, s57
  v_perm_b32 v119, v111, v110, s57
  v_perm_b32 v168, v105, v104, s56
  v_perm_b32 v169, v107, v106, s56
  v_perm_b32 v170, v109, v108, s56
  v_perm_b32 v171, v111, v110, s56
  v_accvgpr_write_b32 a168, v116
  v_accvgpr_write_b32 a169, v117
  v_accvgpr_write_b32 a170, v118
  v_accvgpr_write_b32 a171, v119
  v_xor_b32 v13, 122880, v4
  ds_read2st64_b32 v[104:105], v13 offset0:0 offset1:1
  ds_read2st64_b32 v[106:107], v13 offset0:8 offset1:9
  ds_read2st64_b32 v[108:109], v13 offset0:2 offset1:3
  ds_read2st64_b32 v[110:111], v13 offset0:10 offset1:11
  s_waitcnt lgkmcnt(4)
  v_perm_b32 v116, v97, v96, s57
  v_perm_b32 v117, v99, v98, s57
  v_perm_b32 v118, v101, v100, s57
  v_perm_b32 v119, v103, v102, s57
  v_perm_b32 v200, v97, v96, s56
  v_perm_b32 v201, v99, v98, s56
  v_perm_b32 v202, v101, v100, s56
  v_perm_b32 v203, v103, v102, s56
  v_accvgpr_write_b32 a200, v116
  v_accvgpr_write_b32 a201, v117
  v_accvgpr_write_b32 a202, v118
  v_accvgpr_write_b32 a203, v119
  s_waitcnt lgkmcnt(0)
  v_perm_b32 v116, v105, v104, s57
  v_perm_b32 v117, v107, v106, s57
  v_perm_b32 v118, v109, v108, s57
  v_perm_b32 v119, v111, v110, s57
  v_perm_b32 v232, v105, v104, s56
  v_perm_b32 v233, v107, v106, s56
  v_perm_b32 v234, v109, v108, s56
  v_perm_b32 v235, v111, v110, s56
  v_accvgpr_write_b32 a232, v116
  v_accvgpr_write_b32 a233, v117
  v_accvgpr_write_b32 a234, v118
  v_accvgpr_write_b32 a235, v119
  s_waitcnt vmcnt(24)
  s_barrier
  s_xor_b32 s59, s52, 4096
  buffer_load_dwordx2 v[48:49], v6, s[48:51], s59 offen
  buffer_load_dwordx2 v[50:51], v6, s[48:51], s59 offen offset:32
  s_xor_b32 s59, s52, 5120
  buffer_load_dwordx2 v[52:53], v6, s[48:51], s59 offen
  buffer_load_dwordx2 v[54:55], v6, s[48:51], s59 offen offset:32
  s_xor_b32 s59, s52, 6144
  buffer_load_dwordx2 v[56:57], v6, s[48:51], s59 offen
  buffer_load_dwordx2 v[58:59], v6, s[48:51], s59 offen offset:32
  s_xor_b32 s59, s52, 7168
  buffer_load_dwordx2 v[60:61], v6, s[48:51], s59 offen
  buffer_load_dwordx2 v[62:63], v6, s[48:51], s59 offen offset:32
  v_xor_b32 v12, 131072, v4
  ds_read2st64_b32 v[96:97], v12 offset0:0 offset1:1
  ds_read2st64_b32 v[98:99], v12 offset0:8 offset1:9
  ds_read2st64_b32 v[100:101], v12 offset0:2 offset1:3
  ds_read2st64_b32 v[102:103], v12 offset0:10 offset1:11
  v_xor_b32 v13, 139264, v4
  ds_read2st64_b32 v[104:105], v13 offset0:0 offset1:1
  ds_read2st64_b32 v[106:107], v13 offset0:8 offset1:9
  ds_read2st64_b32 v[108:109], v13 offset0:2 offset1:3
  ds_read2st64_b32 v[110:111], v13 offset0:10 offset1:11
  s_waitcnt lgkmcnt(4)
  v_perm_b32 v116, v97, v96, s57
  v_perm_b32 v117, v99, v98, s57
  v_perm_b32 v118, v101, v100, s57
  v_perm_b32 v119, v103, v102, s57
  v_perm_b32 v140, v97, v96, s56
  v_perm_b32 v141, v99, v98, s56
  v_perm_b32 v142, v101, v100, s56
  v_perm_b32 v143, v103, v102, s56
  v_accvgpr_write_b32 a140, v116
  v_accvgpr_write_b32 a141, v117
  v_accvgpr_write_b32 a142, v118
  v_accvgpr_write_b32 a143, v119
  v_xor_b32 v12, 147456, v4
  ds_read2st64_b32 v[96:97], v12 offset0:0 offset1:1
  ds_read2st64_b32 v[98:99], v12 offset0:8 offset1:9
  ds_read2st64_b32 v[100:101], v12 offset0:2 offset1:3
  ds_read2st64_b32 v[102:103], v12 offset0:10 offset1:11
  s_waitcnt lgkmcnt(4)
  v_perm_b32 v116, v105, v104, s57
  v_perm_b32 v117, v107, v106, s57
  v_perm_b32 v118, v109, v108, s57
  v_perm_b32 v119, v111, v110, s57
  v_perm_b32 v172, v105, v104, s56
  v_perm_b32 v173, v107, v106, s56
  v_perm_b32 v174, v109, v108, s56
  v_perm_b32 v175, v111, v110, s56
  v_accvgpr_write_b32 a172, v116
  v_accvgpr_write_b32 a173, v117
  v_accvgpr_write_b32 a174, v118
  v_accvgpr_write_b32 a175, v119
  v_xor_b32 v13, 155648, v4
  ds_read2st64_b32 v[104:105], v13 offset0:0 offset1:1
  ds_read2st64_b32 v[106:107], v13 offset0:8 offset1:9
  ds_read2st64_b32 v[108:109], v13 offset0:2 offset1:3
  ds_read2st64_b32 v[110:111], v13 offset0:10 offset1:11
  s_waitcnt lgkmcnt(4)
  v_perm_b32 v116, v97, v96, s57
  v_perm_b32 v117, v99, v98, s57
  v_perm_b32 v118, v101, v100, s57
  v_perm_b32 v119, v103, v102, s57
  v_perm_b32 v204, v97, v96, s56
  v_perm_b32 v205, v99, v98, s56
  v_perm_b32 v206, v101, v100, s56
  v_perm_b32 v207, v103, v102, s56
  v_accvgpr_write_b32 a204, v116
  v_accvgpr_write_b32 a205, v117
  v_accvgpr_write_b32 a206, v118
  v_accvgpr_write_b32 a207, v119
  s_waitcnt lgkmcnt(0)
  v_perm_b32 v116, v105, v104, s57
  v_perm_b32 v117, v107, v106, s57
  v_perm_b32 v118, v109, v108, s57
  v_perm_b32 v119, v111, v110, s57
  v_perm_b32 v236, v105, v104, s56
  v_perm_b32 v237, v107, v106, s56
  v_perm_b32 v238, v109, v108, s56
  v_perm_b32 v239, v111, v110, s56
  v_accvgpr_write_b32 a236, v116
  v_accvgpr_write_b32 a237, v117
  v_accvgpr_write_b32 a238, v118
  v_accvgpr_write_b32 a239, v119
  s_waitcnt vmcnt(24)
  s_barrier
  s_xor_b32 s59, s52, 32768
  buffer_load_dwordx2 v[64:65], v6, s[48:51], s59 offen
  buffer_load_dwordx2 v[66:67], v6, s[48:51], s59 offen offset:32
  s_xor_b32 s59, s52, 33792
  buffer_load_dwordx2 v[68:69], v6, s[48:51], s59 offen
  buffer_load_dwordx2 v[70:71], v6, s[48:51], s59 offen offset:32
  s_xor_b32 s59, s52, 34816
  buffer_load_dwordx2 v[72:73], v6, s[48:51], s59 offen
  buffer_load_dwordx2 v[74:75], v6, s[48:51], s59 offen offset:32
  s_xor_b32 s59, s52, 35840
  buffer_load_dwordx2 v[76:77], v6, s[48:51], s59 offen
  buffer_load_dwordx2 v[78:79], v6, s[48:51], s59 offen offset:32
  v_xor_b32 v12, 0, v4
  ds_read2st64_b32 v[96:97], v12 offset0:0 offset1:1
  ds_read2st64_b32 v[98:99], v12 offset0:8 offset1:9
  ds_read2st64_b32 v[100:101], v12 offset0:2 offset1:3
  ds_read2st64_b32 v[102:103], v12 offset0:10 offset1:11
  v_xor_b32 v13, 8192, v4
  ds_read2st64_b32 v[104:105], v13 offset0:0 offset1:1
  ds_read2st64_b32 v[106:107], v13 offset0:8 offset1:9
  ds_read2st64_b32 v[108:109], v13 offset0:2 offset1:3
  ds_read2st64_b32 v[110:111], v13 offset0:10 offset1:11
  s_waitcnt lgkmcnt(4)
  v_perm_b32 v116, v97, v96, s57
  v_perm_b32 v117, v99, v98, s57
  v_perm_b32 v118, v101, v100, s57
  v_perm_b32 v119, v103, v102, s57
  v_perm_b32 v152, v97, v96, s56
  v_perm_b32 v153, v99, v98, s56
  v_perm_b32 v154, v101, v100, s56
  v_perm_b32 v155, v103, v102, s56
  v_accvgpr_write_b32 a152, v116
  v_accvgpr_write_b32 a153, v117
  v_accvgpr_write_b32 a154, v118
  v_accvgpr_write_b32 a155, v119
  v_xor_b32 v12, 16384, v4
  ds_read2st64_b32 v[96:97], v12 offset0:0 offset1:1
  ds_read2st64_b32 v[98:99], v12 offset0:8 offset1:9
  ds_read2st64_b32 v[100:101], v12 offset0:2 offset1:3
  ds_read2st64_b32 v[102:103], v12 offset0:10 offset1:11
  s_waitcnt lgkmcnt(4)
  v_perm_b32 v116, v105, v104, s57
  v_perm_b32 v117, v107, v106, s57
  v_perm_b32 v118, v109, v108, s57
  v_perm_b32 v119, v111, v110, s57
  v_perm_b32 v184, v105, v104, s56
  v_perm_b32 v185, v107, v106, s56
  v_perm_b32 v186, v109, v108, s56
  v_perm_b32 v187, v111, v110, s56
  v_accvgpr_write_b32 a184, v116
  v_accvgpr_write_b32 a185, v117
  v_accvgpr_write_b32 a186, v118
  v_accvgpr_write_b32 a187, v119
  v_xor_b32 v13, 24576, v4
  ds_read2st64_b32 v[104:105], v13 offset0:0 offset1:1
  ds_read2st64_b32 v[106:107], v13 offset0:8 offset1:9
  ds_read2st64_b32 v[108:109], v13 offset0:2 offset1:3
  ds_read2st64_b32 v[110:111], v13 offset0:10 offset1:11
  s_waitcnt lgkmcnt(4)
  v_perm_b32 v116, v97, v96, s57
  v_perm_b32 v117, v99, v98, s57
  v_perm_b32 v118, v101, v100, s57
  v_perm_b32 v119, v103, v102, s57
  v_perm_b32 v216, v97, v96, s56
  v_perm_b32 v217, v99, v98, s56
  v_perm_b32 v218, v101, v100, s56
  v_perm_b32 v219, v103, v102, s56
  v_accvgpr_write_b32 a216, v116
  v_accvgpr_write_b32 a217, v117
  v_accvgpr_write_b32 a218, v118
  v_accvgpr_write_b32 a219, v119
  s_waitcnt lgkmcnt(0)
  v_perm_b32 v116, v105, v104, s57
  v_perm_b32 v117, v107, v106, s57
  v_perm_b32 v118, v109, v108, s57
  v_perm_b32 v119, v111, v110, s57
  v_perm_b32 v248, v105, v104, s56
  v_perm_b32 v249, v107, v106, s56
  v_perm_b32 v250, v109, v108, s56
  v_perm_b32 v251, v111, v110, s56
  v_accvgpr_write_b32 a248, v116
  v_accvgpr_write_b32 a249, v117
  v_accvgpr_write_b32 a250, v118
  v_accvgpr_write_b32 a251, v119
  s_waitcnt vmcnt(24)
  s_barrier
  s_xor_b32 s59, s52, 36864
  buffer_load_dwordx2 v[80:81], v6, s[48:51], s59 offen
  buffer_load_dwordx2 v[82:83], v6, s[48:51], s59 offen offset:32
  s_xor_b32 s59, s52, 37888
  buffer_load_dwordx2 v[84:85], v6, s[48:51], s59 offen
  buffer_load_dwordx2 v[86:87], v6, s[48:51], s59 offen offset:32
  s_xor_b32 s59, s52, 38912
  buffer_load_dwordx2 v[88:89], v6, s[48:51], s59 offen
  buffer_load_dwordx2 v[90:91], v6, s[48:51], s59 offen offset:32
  s_xor_b32 s59, s52, 39936
  buffer_load_dwordx2 v[92:93], v6, s[48:51], s59 offen
  buffer_load_dwordx2 v[94:95], v6, s[48:51], s59 offen offset:32
  v_xor_b32 v12, 32768, v4
  ds_read2st64_b32 v[96:97], v12 offset0:0 offset1:1
  ds_read2st64_b32 v[98:99], v12 offset0:8 offset1:9
  ds_read2st64_b32 v[100:101], v12 offset0:2 offset1:3
  ds_read2st64_b32 v[102:103], v12 offset0:10 offset1:11
  v_xor_b32 v13, 40960, v4
  ds_read2st64_b32 v[104:105], v13 offset0:0 offset1:1
  ds_read2st64_b32 v[106:107], v13 offset0:8 offset1:9
  ds_read2st64_b32 v[108:109], v13 offset0:2 offset1:3
  ds_read2st64_b32 v[110:111], v13 offset0:10 offset1:11
  s_waitcnt lgkmcnt(4)
  v_perm_b32 v116, v97, v96, s57
  v_perm_b32 v117, v99, v98, s57
  v_perm_b32 v118, v101, v100, s57
  v_perm_b32 v119, v103, v102, s57
  v_perm_b32 v156, v97, v96, s56
  v_perm_b32 v157, v99, v98, s56
  v_perm_b32 v158, v101, v100, s56
  v_perm_b32 v159, v103, v102, s56
  v_accvgpr_write_b32 a156, v116
  v_accvgpr_write_b32 a157, v117
  v_accvgpr_write_b32 a158, v118
  v_accvgpr_write_b32 a159, v119
  v_xor_b32 v12, 49152, v4
  ds_read2st64_b32 v[96:97], v12 offset0:0 offset1:1
  ds_read2st64_b32 v[98:99], v12 offset0:8 offset1:9
  ds_read2st64_b32 v[100:101], v12 offset0:2 offset1:3
  ds_read2st64_b32 v[102:103], v12 offset0:10 offset1:11
  s_waitcnt lgkmcnt(4)
  v_perm_b32 v116, v105, v104, s57
  v_perm_b32 v117, v107, v106, s57
  v_perm_b32 v118, v109, v108, s57
  v_perm_b32 v119, v111, v110, s57
  v_perm_b32 v188, v105, v104, s56
  v_perm_b32 v189, v107, v106, s56
  v_perm_b32 v190, v109, v108, s56
  v_perm_b32 v191, v111, v110, s56
  v_accvgpr_write_b32 a188, v116
  v_accvgpr_write_b32 a189, v117
  v_accvgpr_write_b32 a190, v118
  v_accvgpr_write_b32 a191, v119
  v_xor_b32 v13, 57344, v4
  ds_read2st64_b32 v[104:105], v13 offset0:0 offset1:1
  ds_read2st64_b32 v[106:107], v13 offset0:8 offset1:9
  ds_read2st64_b32 v[108:109], v13 offset0:2 offset1:3
  ds_read2st64_b32 v[110:111], v13 offset0:10 offset1:11
  s_waitcnt lgkmcnt(4)
  v_perm_b32 v116, v97, v96, s57
  v_perm_b32 v117, v99, v98, s57
  v_perm_b32 v118, v101, v100, s57
  v_perm_b32 v119, v103, v102, s57
  v_perm_b32 v220, v97, v96, s56
  v_perm_b32 v221, v99, v98, s56
  v_perm_b32 v222, v101, v100, s56
  v_perm_b32 v223, v103, v102, s56
  v_accvgpr_write_b32 a220, v116
  v_accvgpr_write_b32 a221, v117
  v_accvgpr_write_b32 a222, v118
  v_accvgpr_write_b32 a223, v119
  s_waitcnt lgkmcnt(0)
  v_perm_b32 v116, v105, v104, s57
  v_perm_b32 v117, v107, v106, s57
  v_perm_b32 v118, v109, v108, s57
  v_perm_b32 v119, v111, v110, s57
  v_perm_b32 v252, v105, v104, s56
  v_perm_b32 v253, v107, v106, s56
  v_perm_b32 v254, v109, v108, s56
  v_perm_b32 v255, v111, v110, s56
  v_accvgpr_write_b32 a252, v116
  v_accvgpr_write_b32 a253, v117
  v_accvgpr_write_b32 a254, v118
  v_accvgpr_write_b32 a255, v119
  s_barrier
  ds_write_b128 v7, a[128:131] offset:0
  ds_write_b128 v7, a[132:135] offset:1024
  ds_write_b128 v7, a[136:139] offset:2048
  ds_write_b128 v7, a[140:143] offset:3072
  ds_write_b128 v7, a[144:147] offset:4096
  ds_write_b128 v7, a[148:151] offset:5120
  ds_write_b128 v7, a[152:155] offset:6144
  ds_write_b128 v7, a[156:159] offset:7168
  ds_write_b128 v7, a[160:163] offset:8192
  ds_write_b128 v7, a[164:167] offset:9216
  ds_write_b128 v7, a[168:171] offset:10240
  ds_write_b128 v7, a[172:175] offset:11264
  ds_write_b128 v7, a[176:179] offset:12288
  ds_write_b128 v7, a[180:183] offset:13312
  ds_write_b128 v7, a[184:187] offset:14336
  ds_write_b128 v7, a[188:191] offset:15360
  ds_write_b128 v7, a[192:195] offset:16384
  ds_write_b128 v7, a[196:199] offset:17408
  ds_write_b128 v7, a[200:203] offset:18432
  ds_write_b128 v7, a[204:207] offset:19456
  ds_write_b128 v7, a[208:211] offset:20480
  ds_write_b128 v7, a[212:215] offset:21504
  ds_write_b128 v7, a[216:219] offset:22528
  ds_write_b128 v7, a[220:223] offset:23552
  ds_write_b128 v7, a[224:227] offset:24576
  ds_write_b128 v7, a[228:231] offset:25600
  ds_write_b128 v7, a[232:235] offset:26624
  ds_write_b128 v7, a[236:239] offset:27648
  ds_write_b128 v7, a[240:243] offset:28672
  ds_write_b128 v7, a[244:247] offset:29696
  ds_write_b128 v7, a[248:251] offset:30720
  ds_write_b128 v7, a[252:255] offset:31744
  s_waitcnt lgkmcnt(0)
  s_waitcnt vmcnt(24)
  v_perm_b32 v112, v36, v32, s56
  v_perm_b32 v113, v36, v32, s57
  v_perm_b32 v114, v37, v33, s56
  v_perm_b32 v115, v37, v33, s57
  v_perm_b32 v116, v38, v34, s56
  v_perm_b32 v117, v38, v34, s57
  v_perm_b32 v118, v39, v35, s56
  v_perm_b32 v119, v39, v35, s57
  v_perm_b32 v120, v44, v40, s56
  v_perm_b32 v121, v44, v40, s57
  v_perm_b32 v122, v45, v41, s56
  v_perm_b32 v123, v45, v41, s57
  v_perm_b32 v124, v46, v42, s56
  v_perm_b32 v125, v46, v42, s57
  v_perm_b32 v126, v47, v43, s56
  v_perm_b32 v127, v47, v43, s57
  v_accvgpr_write_b32 a128, v112
  v_accvgpr_write_b32 a129, v113
  v_accvgpr_write_b32 a136, v114
  v_accvgpr_write_b32 a137, v115
  v_accvgpr_write_b32 a144, v116
  v_accvgpr_write_b32 a145, v117
  v_accvgpr_write_b32 a152, v118
  v_accvgpr_write_b32 a153, v119
  v_accvgpr_write_b32 a160, v120
  v_accvgpr_write_b32 a161, v121
  v_accvgpr_write_b32 a168, v122
  v_accvgpr_write_b32 a169, v123
  v_accvgpr_write_b32 a176, v124
  v_accvgpr_write_b32 a177, v125
  v_accvgpr_write_b32 a184, v126
  v_accvgpr_write_b32 a185, v127
  s_xor_b32 s59, s52, 65536
  buffer_load_dwordx2 v[32:33], v6, s[48:51], s59 offen
  buffer_load_dwordx2 v[34:35], v6, s[48:51], s59 offen offset:32
  s_xor_b32 s59, s52, 66560
  buffer_load_dwordx2 v[36:37], v6, s[48:51], s59 offen
  buffer_load_dwordx2 v[38:39], v6, s[48:51], s59 offen offset:32
  s_xor_b32 s59, s52, 67584
  buffer_load_dwordx2 v[40:41], v6, s[48:51], s59 offen
  buffer_load_dwordx2 v[42:43], v6, s[48:51], s59 offen offset:32
  s_xor_b32 s59, s52, 68608
  buffer_load_dwordx2 v[44:45], v6, s[48:51], s59 offen
  buffer_load_dwordx2 v[46:47], v6, s[48:51], s59 offen offset:32
  s_waitcnt vmcnt(24)
  v_perm_b32 v112, v52, v48, s56
  v_perm_b32 v113, v52, v48, s57
  v_perm_b32 v114, v53, v49, s56
  v_perm_b32 v115, v53, v49, s57
  v_perm_b32 v116, v54, v50, s56
  v_perm_b32 v117, v54, v50, s57
  v_perm_b32 v118, v55, v51, s56
  v_perm_b32 v119, v55, v51, s57
  v_perm_b32 v120, v60, v56, s56
  v_perm_b32 v121, v60, v56, s57
  v_perm_b32 v122, v61, v57, s56
  v_perm_b32 v123, v61, v57, s57
  v_perm_b32 v124, v62, v58, s56
  v_perm_b32 v125, v62, v58, s57
  v_perm_b32 v126, v63, v59, s56
  v_perm_b32 v127, v63, v59, s57
  v_accvgpr_write_b32 a130, v112
  v_accvgpr_write_b32 a131, v113
  v_accvgpr_write_b32 a138, v114
  v_accvgpr_write_b32 a139, v115
  v_accvgpr_write_b32 a146, v116
  v_accvgpr_write_b32 a147, v117
  v_accvgpr_write_b32 a154, v118
  v_accvgpr_write_b32 a155, v119
  v_accvgpr_write_b32 a162, v120
  v_accvgpr_write_b32 a163, v121
  v_accvgpr_write_b32 a170, v122
  v_accvgpr_write_b32 a171, v123
  v_accvgpr_write_b32 a178, v124
  v_accvgpr_write_b32 a179, v125
  v_accvgpr_write_b32 a186, v126
  v_accvgpr_write_b32 a187, v127
  s_xor_b32 s59, s52, 69632
  buffer_load_dwordx2 v[48:49], v6, s[48:51], s59 offen
  buffer_load_dwordx2 v[50:51], v6, s[48:51], s59 offen offset:32
  s_xor_b32 s59, s52, 70656
  buffer_load_dwordx2 v[52:53], v6, s[48:51], s59 offen
  buffer_load_dwordx2 v[54:55], v6, s[48:51], s59 offen offset:32
  s_xor_b32 s59, s52, 71680
  buffer_load_dwordx2 v[56:57], v6, s[48:51], s59 offen
  buffer_load_dwordx2 v[58:59], v6, s[48:51], s59 offen offset:32
  s_xor_b32 s59, s52, 72704
  buffer_load_dwordx2 v[60:61], v6, s[48:51], s59 offen
  buffer_load_dwordx2 v[62:63], v6, s[48:51], s59 offen offset:32
  s_waitcnt vmcnt(24)
  v_perm_b32 v112, v68, v64, s56
  v_perm_b32 v113, v68, v64, s57
  v_perm_b32 v114, v69, v65, s56
  v_perm_b32 v115, v69, v65, s57
  v_perm_b32 v116, v70, v66, s56
  v_perm_b32 v117, v70, v66, s57
  v_perm_b32 v118, v71, v67, s56
  v_perm_b32 v119, v71, v67, s57
  v_perm_b32 v120, v76, v72, s56
  v_perm_b32 v121, v76, v72, s57
  v_perm_b32 v122, v77, v73, s56
  v_perm_b32 v123, v77, v73, s57
  v_perm_b32 v124, v78, v74, s56
  v_perm_b32 v125, v78, v74, s57
  v_perm_b32 v126, v79, v75, s56
  v_perm_b32 v127, v79, v75, s57
  v_accvgpr_write_b32 a132, v112
  v_accvgpr_write_b32 a133, v113
  v_accvgpr_write_b32 a140, v114
  v_accvgpr_write_b32 a141, v115
  v_accvgpr_write_b32 a148, v116
  v_accvgpr_write_b32 a149, v117
  v_accvgpr_write_b32 a156, v118
  v_accvgpr_write_b32 a157, v119
  v_accvgpr_write_b32 a164, v120
  v_accvgpr_write_b32 a165, v121
  v_accvgpr_write_b32 a172, v122
  v_accvgpr_write_b32 a173, v123
  v_accvgpr_write_b32 a180, v124
  v_accvgpr_write_b32 a181, v125
  v_accvgpr_write_b32 a188, v126
  v_accvgpr_write_b32 a189, v127
  s_xor_b32 s59, s52, 98304
  buffer_load_dwordx2 v[64:65], v6, s[48:51], s59 offen
  buffer_load_dwordx2 v[66:67], v6, s[48:51], s59 offen offset:32
  s_xor_b32 s59, s52, 99328
  buffer_load_dwordx2 v[68:69], v6, s[48:51], s59 offen
  buffer_load_dwordx2 v[70:71], v6, s[48:51], s59 offen offset:32
  s_xor_b32 s59, s52, 100352
  buffer_load_dwordx2 v[72:73], v6, s[48:51], s59 offen
  buffer_load_dwordx2 v[74:75], v6, s[48:51], s59 offen offset:32
  s_xor_b32 s59, s52, 101376
  buffer_load_dwordx2 v[76:77], v6, s[48:51], s59 offen
  buffer_load_dwordx2 v[78:79], v6, s[48:51], s59 offen offset:32
  s_waitcnt vmcnt(24)
  v_perm_b32 v112, v84, v80, s56
  v_perm_b32 v113, v84, v80, s57
  v_perm_b32 v114, v85, v81, s56
  v_perm_b32 v115, v85, v81, s57
  v_perm_b32 v116, v86, v82, s56
  v_perm_b32 v117, v86, v82, s57
  v_perm_b32 v118, v87, v83, s56
  v_perm_b32 v119, v87, v83, s57
  v_perm_b32 v120, v92, v88, s56
  v_perm_b32 v121, v92, v88, s57
  v_perm_b32 v122, v93, v89, s56
  v_perm_b32 v123, v93, v89, s57
  v_perm_b32 v124, v94, v90, s56
  v_perm_b32 v125, v94, v90, s57
  v_perm_b32 v126, v95, v91, s56
  v_perm_b32 v127, v95, v91, s57
  v_accvgpr_write_b32 a134, v112
  v_accvgpr_write_b32 a135, v113
  v_accvgpr_write_b32 a142, v114
  v_accvgpr_write_b32 a143, v115
  v_accvgpr_write_b32 a150, v116
  v_accvgpr_write_b32 a151, v117
  v_accvgpr_write_b32 a158, v118
  v_accvgpr_write_b32 a159, v119
  v_accvgpr_write_b32 a166, v120
  v_accvgpr_write_b32 a167, v121
  v_accvgpr_write_b32 a174, v122
  v_accvgpr_write_b32 a175, v123
  v_accvgpr_write_b32 a182, v124
  v_accvgpr_write_b32 a183, v125
  v_accvgpr_write_b32 a190, v126
  v_accvgpr_write_b32 a191, v127
  s_xor_b32 s59, s52, 102400
  buffer_load_dwordx2 v[80:81], v6, s[48:51], s59 offen
  buffer_load_dwordx2 v[82:83], v6, s[48:51], s59 offen offset:32
  s_xor_b32 s59, s52, 103424
  buffer_load_dwordx2 v[84:85], v6, s[48:51], s59 offen
  buffer_load_dwordx2 v[86:87], v6, s[48:51], s59 offen offset:32
  s_xor_b32 s59, s52, 104448
  buffer_load_dwordx2 v[88:89], v6, s[48:51], s59 offen
  buffer_load_dwordx2 v[90:91], v6, s[48:51], s59 offen offset:32
  s_xor_b32 s59, s52, 105472
  buffer_load_dwordx2 v[92:93], v6, s[48:51], s59 offen
  buffer_load_dwordx2 v[94:95], v6, s[48:51], s59 offen offset:32
  s_waitcnt vmcnt(24)
  v_perm_b32 v112, v36, v32, s56
  v_perm_b32 v113, v36, v32, s57
  v_perm_b32 v114, v37, v33, s56
  v_perm_b32 v115, v37, v33, s57
  v_perm_b32 v116, v38, v34, s56
  v_perm_b32 v117, v38, v34, s57
  v_perm_b32 v118, v39, v35, s56
  v_perm_b32 v119, v39, v35, s57
  v_perm_b32 v120, v44, v40, s56
  v_perm_b32 v121, v44, v40, s57
  v_perm_b32 v122, v45, v41, s56
  v_perm_b32 v123, v45, v41, s57
  v_perm_b32 v124, v46, v42, s56
  v_perm_b32 v125, v46, v42, s57
  v_perm_b32 v126, v47, v43, s56
  v_perm_b32 v127, v47, v43, s57
  v_accvgpr_write_b32 a192, v112
  v_accvgpr_write_b32 a193, v113
  v_accvgpr_write_b32 a200, v114
  v_accvgpr_write_b32 a201, v115
  v_accvgpr_write_b32 a208, v116
  v_accvgpr_write_b32 a209, v117
  v_accvgpr_write_b32 a216, v118
  v_accvgpr_write_b32 a217, v119
  v_accvgpr_write_b32 a224, v120
  v_accvgpr_write_b32 a225, v121
  v_accvgpr_write_b32 a232, v122
  v_accvgpr_write_b32 a233, v123
  v_accvgpr_write_b32 a240, v124
  v_accvgpr_write_b32 a241, v125
  v_accvgpr_write_b32 a248, v126
  v_accvgpr_write_b32 a249, v127
  s_waitcnt vmcnt(16)
  v_perm_b32 v112, v52, v48, s56
  v_perm_b32 v113, v52, v48, s57
  v_perm_b32 v114, v53, v49, s56
  v_perm_b32 v115, v53, v49, s57
  v_perm_b32 v116, v54, v50, s56
  v_perm_b32 v117, v54, v50, s57
  v_perm_b32 v118, v55, v51, s56
  v_perm_b32 v119, v55, v51, s57
  v_perm_b32 v120, v60, v56, s56
  v_perm_b32 v121, v60, v56, s57
  v_perm_b32 v122, v61, v57, s56
  v_perm_b32 v123, v61, v57, s57
  v_perm_b32 v124, v62, v58, s56
  v_perm_b32 v125, v62, v58, s57
  v_perm_b32 v126, v63, v59, s56
  v_perm_b32 v127, v63, v59, s57
  v_accvgpr_write_b32 a194, v112
  v_accvgpr_write_b32 a195, v113
  v_accvgpr_write_b32 a202, v114
  v_accvgpr_write_b32 a203, v115
  v_accvgpr_write_b32 a210, v116
  v_accvgpr_write_b32 a211, v117
  v_accvgpr_write_b32 a218, v118
  v_accvgpr_write_b32 a219, v119
  v_accvgpr_write_b32 a226, v120
  v_accvgpr_write_b32 a227, v121
  v_accvgpr_write_b32 a234, v122
  v_accvgpr_write_b32 a235, v123
  v_accvgpr_write_b32 a242, v124
  v_accvgpr_write_b32 a243, v125
  v_accvgpr_write_b32 a250, v126
  v_accvgpr_write_b32 a251, v127
  s_waitcnt vmcnt(8)
  v_perm_b32 v112, v68, v64, s56
  v_perm_b32 v113, v68, v64, s57
  v_perm_b32 v114, v69, v65, s56
  v_perm_b32 v115, v69, v65, s57
  v_perm_b32 v116, v70, v66, s56
  v_perm_b32 v117, v70, v66, s57
  v_perm_b32 v118, v71, v67, s56
  v_perm_b32 v119, v71, v67, s57
  v_perm_b32 v120, v76, v72, s56
  v_perm_b32 v121, v76, v72, s57
  v_perm_b32 v122, v77, v73, s56
  v_perm_b32 v123, v77, v73, s57
  v_perm_b32 v124, v78, v74, s56
  v_perm_b32 v125, v78, v74, s57
  v_perm_b32 v126, v79, v75, s56
  v_perm_b32 v127, v79, v75, s57
  v_accvgpr_write_b32 a196, v112
  v_accvgpr_write_b32 a197, v113
  v_accvgpr_write_b32 a204, v114
  v_accvgpr_write_b32 a205, v115
  v_accvgpr_write_b32 a212, v116
  v_accvgpr_write_b32 a213, v117
  v_accvgpr_write_b32 a220, v118
  v_accvgpr_write_b32 a221, v119
  v_accvgpr_write_b32 a228, v120
  v_accvgpr_write_b32 a229, v121
  v_accvgpr_write_b32 a236, v122
  v_accvgpr_write_b32 a237, v123
  v_accvgpr_write_b32 a244, v124
  v_accvgpr_write_b32 a245, v125
  v_accvgpr_write_b32 a252, v126
  v_accvgpr_write_b32 a253, v127
  s_waitcnt vmcnt(0)
  v_perm_b32 v112, v84, v80, s56
  v_perm_b32 v113, v84, v80, s57
  v_perm_b32 v114, v85, v81, s56
  v_perm_b32 v115, v85, v81, s57
  v_perm_b32 v116, v86, v82, s56
  v_perm_b32 v117, v86, v82, s57
  v_perm_b32 v118, v87, v83, s56
  v_perm_b32 v119, v87, v83, s57
  v_perm_b32 v120, v92, v88, s56
  v_perm_b32 v121, v92, v88, s57
  v_perm_b32 v122, v93, v89, s56
  v_perm_b32 v123, v93, v89, s57
  v_perm_b32 v124, v94, v90, s56
  v_perm_b32 v125, v94, v90, s57
  v_perm_b32 v126, v95, v91, s56
  v_perm_b32 v127, v95, v91, s57
  v_accvgpr_write_b32 a198, v112
  v_accvgpr_write_b32 a199, v113
  v_accvgpr_write_b32 a206, v114
  v_accvgpr_write_b32 a207, v115
  v_accvgpr_write_b32 a214, v116
  v_accvgpr_write_b32 a215, v117
  v_accvgpr_write_b32 a222, v118
  v_accvgpr_write_b32 a223, v119
  v_accvgpr_write_b32 a230, v120
  v_accvgpr_write_b32 a231, v121
  v_accvgpr_write_b32 a238, v122
  v_accvgpr_write_b32 a239, v123
  v_accvgpr_write_b32 a246, v124
  v_accvgpr_write_b32 a247, v125
  v_accvgpr_write_b32 a254, v126
  v_accvgpr_write_b32 a255, v127
  v_mov_b32 v16, v1
  v_mov_b32 v17, v2
  v_mov_b32 v18, v3
  v_mov_b32 v2, v7
  v_lshlrev_b32 v1, 4, v16
  v_bfe_u32 v19, v17, 1, 1
  v_mov_b32 v20, 0x4444
  v_mov_b32 v21, 0xeeee
  v_cmp_eq_u32 vcc, 1, v19
  s_lshl_b32 s33, s28, 11
  s_add_u32 s33, s33, 147456
  v_cndmask_b32 v0, v20, v21, vcc
  v_add_u32 v3, s33, v1
  v_xor_b32 v4, 2048, v3
  v_xor_b32 v5, 4096, v3
  v_xor_b32 v6, 6144, v3
  v_lshrrev_b32 v20, 2, v17
  v_and_b32 v21, 1, v17
  v_lshl_add_u32 v21, v20, 1, v21
  v_lshlrev_b32 v21, 10, v21
  v_lshl_add_u32 v21, v18, 5, v21
  v_lshl_add_u32 v21, v19, 4, v21
  s_lshl_b32 s33, s28, 8
  v_add_u32 v7, s33, v21
  v_lshlrev_b32 v21, 16, v18
  v_lshl_add_u32 v21, v20, 11, v21
  v_and_b32 v22, 3, v17
  v_lshl_add_u32 v21, v22, 4, v21
  s_lshl_b32 s33, s28, 13
  v_lshl_add_u32 v23, v18, 2, v20
  v_lshlrev_b32 v23, 5, v23
  v_and_b32 v23, 31, v23
  v_xor_b32 v23, s29, v23
  v_lshl_add_u32 v21, v23, 6, v21
  v_add_u32 v8, s33, v21
  s_lshl_b32 s33, s29, 2
  s_add_u32 s33, s33, s28
  s_and_b32 s34, s33, 15
  s_lshl_b32 s34, s34, 9
  s_lshr_b32 s35, s33, 5
  s_lshl_b32 s35, s35, 6
  s_add_u32 s34, s34, s35
  s_bfe_u32 s35, s33, 0x10004
  s_lshl_b32 s35, s35, 8
  s_add_u32 s34, s34, s35
  v_lshrrev_b32 v21, 1, v22
  v_lshlrev_b32 v21, 5, v21
  v_lshl_add_u32 v21, v18, 4, v21
  v_and_b32 v23, 1, v22
  v_lshl_add_u32 v21, v23, 3, v21
  v_add_u32 v9, s34, v21
  s_lshl_b32 s33, s33, 11
  s_add_u32 s33, s33, 87031808
  s_mul_i32 s34, s28, 1088
  s_add_u32 s34, s34, 157696
  v_lshl_add_u32 v10, v16, 2, s34
  v_mul_u32_u24 v21, 272, v22
  v_lshl_add_u32 v21, v20, 6, v21
  v_lshl_add_u32 v21, v18, 4, v21
  v_add_u32 v11, 157696, v21
  v_add_u32 v12, 131072, v1
  v_mov_b32 v14, v12
  v_and_b32 v21, 61, v16
  v_lshlrev_b32 v21, 4, v21
  s_lshl_b32 s34, s30, 10
  s_lshl_b32 s35, s31, 5
  s_add_u32 s34, s34, s35
  s_add_u32 s34, s34, 155648
  v_add_u32 v13, s34, v21
  s_add_u32 s36, s26, 87031808
  s_addc_u32 s37, s27, 0
  s_add_u32 s38, s26, 87064576
  s_addc_u32 s39, s27, 0
  s_add_u32 s40, s26, s33
  s_addc_u32 s41, s27, 0
  s_add_u32 s42, s26, 88080384
  s_addc_u32 s43, s27, 0
  s_lshl_b32 s33, s29, 13
  s_lshl_b32 s34, s28, 11
  s_add_u32 s33, s33, s34
  s_add_u32 s35, s33, 16777216
  s_add_u32 s50, s34, 131072
  s_add_u32 s44, s26, s35
  s_addc_u32 s45, s27, 0
  s_add_u32 s35, s33, 33554432
  s_add_u32 s46, s26, s35
  s_addc_u32 s47, s27, 0
  s_lshr_b32 s33, s33, 1
  s_add_u32 s33, s33, 77594624
  s_add_u32 s48, s26, s33
  s_addc_u32 s49, s27, 0
  v_and_b32 v21, 1, v17
  v_mov_b32 v22, 0x3f80
  v_lshlrev_b32 v21, 4, v21
  v_lshlrev_b32 v21, v21, v22
  v_lshrrev_b32 v22, 1, v17
  v_cmp_eq_u32 vcc, 0, v22
  s_nop 1
  v_cndmask_b32 v24, 0, v21, vcc
  v_cmp_eq_u32 vcc, 1, v22
  s_nop 1
  v_cndmask_b32 v25, 0, v21, vcc
  v_cmp_eq_u32 vcc, 2, v22
  s_nop 1
  v_cndmask_b32 v26, 0, v21, vcc
  v_cmp_eq_u32 vcc, 3, v22
  s_nop 1
  v_cndmask_b32 v27, 0, v21, vcc
  ds_write_b128 v12, v[24:27] offset:30976
  v_mov_b64 v[24:25], 0
  v_mov_b64 v[26:27], 0
  v_mov_b64 v[28:29], 0
  v_mov_b64 v[30:31], 0
  v_mov_b64 v[32:33], 0
  v_mov_b64 v[34:35], 0
  v_mov_b64 v[36:37], 0
  v_mov_b64 v[38:39], 0
  v_mov_b64 v[40:41], 0
  v_mov_b64 v[42:43], 0
  v_mov_b64 v[44:45], 0
  v_mov_b64 v[46:47], 0
  s_mov_b32 s52, 0x000f000f
  s_mov_b32 s53, 0
  s_mov_b32 s54, 0xcccccccc
  s_mov_b32 s55, 0xcccccccc
  s_mov_b32 s56, 0x3e0293ee
  s_mov_b32 s57, s56
  s_mov_b32 s51, 0
  s_mov_b32 s58, 0
  s_mov_b32 s59, 0
  global_load_dwordx4 v[48:51], v7, s[10:11]
  global_load_dwordx4 v[52:55], v7, s[10:11] offset:128
  s_lshl_b32 s33, s28, 11
  s_nop 3
  v_add_u32 v7, s33, v1
  s_lshr_b32 s33, s29, 1
  s_lshl_b32 s33, s33, 7
  s_and_b32 s34, s29, 1
  s_lshl_b32 s34, s34, 6
  s_add_u32 s33, s33, s34
  s_lshl_b32 s34, s30, 5
  s_add_u32 s33, s33, s34
  s_add_u32 s33, s33, 89128960
  s_lshl_b32 s34, s29, 7
  s_lshl_b32 s35, s28, 5
  s_add_u32 s34, s34, s35
  s_add_u32 s34, s34, 89137152
  v_mov_b32 v16, 0
  s_add_u32 s8, s26, s33
  s_addc_u32 s9, s27, 0
  s_add_u32 s4, s26, s34
  s_addc_u32 s5, s27, 0
  s_mov_b32 s6, 4
  s_mov_b32 s7, 0x20000
  s_mov_b32 s10, 32
  s_mov_b32 s11, 0x20000
  s_mov_b32 s60, 0
sp_2:
  global_load_dwordx2 v[18:19], v16, s[24:25] sc1
  global_load_dword v17, v16, s[24:25] offset:192 sc1
  s_add_u32 s60, s60, 1
  s_waitcnt vmcnt(0)
  v_readfirstlane_b32 s62, v18
  v_readfirstlane_b32 s61, v19
  v_readfirstlane_b32 s63, v17
  s_cmp_lg_u32 s63, 0
  s_cselect_b32 s61, s61, 0
  s_cmp_ge_u32 s61, 32
  s_cbranch_scc1 sp_3
  s_cmp_ge_u32 s60, 400000
  s_cbranch_scc1 k_end
  s_sleep 1
  s_branch sp_2
sp_3:
  s_mov_b32 s60, 0
sp_4:
  buffer_load_dword v15, v1, s[8:11], 0 offen sc1
  s_add_u32 s60, s60, 1
  s_waitcnt vmcnt(0)
  v_cmp_gt_u32 vcc, 2, v15
  s_nop 1
  s_and_b32 s61, vcc_lo, 3
  s_cmp_eq_u32 s61, 0
  s_cbranch_scc1 sp_5
  s_cmp_ge_u32 s60, 400000
  s_cbranch_scc1 k_end
  s_sleep 1
  s_branch sp_4
sp_5:
  s_mov_b32 m0, s50
  s_nop 0
  global_load_lds_dwordx4 v1, s[44:45] sc1
  global_load_lds_dwordx4 v1, s[44:45] offset:1024 sc1
  s_add_u32 s44, s44, 0x40000
  s_addc_u32 s45, s45, 0
  s_xor_b32 s50, s50, 8192
  s_mov_b32 m0, s50
  s_waitcnt lgkmcnt(0)
  ds_read_b128 v[80:83], v2 offset:0
  ds_read_b128 v[84:87], v2 offset:1024
  ds_read_b128 v[88:91], v2 offset:2048
  ds_read_b128 v[92:95], v2 offset:3072
  ds_read_b128 v[96:99], v2 offset:4096
  ds_read_b128 v[100:103], v2 offset:5120
  ds_read_b128 v[104:107], v2 offset:6144
  ds_read_b128 v[108:111], v2 offset:7168
  ds_read_b128 v[112:115], v2 offset:8192
  ds_read_b128 v[116:119], v2 offset:9216
  ds_read_b128 v[120:123], v2 offset:10240
  ds_read_b128 v[124:127], v2 offset:11264
  s_waitcnt lgkmcnt(0)
  s_waitcnt vmcnt(0)
  s_lshr_b32 s62, s62, 16
  s_cmp_lg_u32 s62, 0
  s_cbranch_scc1 k_slow
  v_mov_b32 v15, 0
  ds_write_b128 v3, v[48:51]
  ds_write_b128 v3, v[52:55] offset:1024
  s_branch tent_8
tl_6:
  s_waitcnt vmcnt(0)
pp_9:
  global_load_dwordx4 v[48:51], v7, s[42:43] sc1
  global_load_dwordx4 v[52:55], v7, s[42:43] offset:1024 sc1
  s_add_u32 s60, s60, 1
  s_cmp_ge_u32 s60, 200000
  s_cbranch_scc1 k_end
  s_waitcnt vmcnt(1) lgkmcnt(0)
  ds_write_b128 v3, v[48:51]
  v_bitop3_b32 v72, v48, v50, s58 bitop3:0x7e
  s_waitcnt vmcnt(0)
  ds_write_b128 v3, v[52:55] offset:1024
  v_bitop3_b32 v73, v52, v54, s58 bitop3:0x7e
  v_bitop3_b32 v72, v72, v73, 1 bitop3:0xa8
  v_cmp_ne_u32 vcc, 0, v72
  s_nop 0
  s_and_b64 exec, vcc, vcc
  s_cbranch_scc1 pp_9
  s_mov_b64 exec, -1
tent_8:
  s_waitcnt lgkmcnt(0)
  s_barrier
  ds_read_b128 v[56:59], v4 offset:0
  ds_read_b128 v[60:63], v4 offset:1024
  v_smfmac_f32_16x16x64_bf16 v[24:27], v[48:51], v[128:135], v0
  ds_read_b128 v[64:67], v5 offset:0
  v_smfmac_f32_16x16x64_bf16 v[28:31], v[48:51], v[136:143], v0
  ds_read_b128 v[68:71], v5 offset:1024
  global_load_dwordx4 v[16:19], v1, s[46:47] sc1
  v_smfmac_f32_16x16x64_bf16 v[32:35], v[48:51], v[80:87], v0
  ds_read_b128 v[72:75], v6 offset:0
  global_load_dwordx4 v[20:23], v1, s[46:47] offset:1024 sc1
  v_smfmac_f32_16x16x64_bf16 v[36:39], v[48:51], v[88:95], v0
  ds_read_b128 v[76:79], v6 offset:1024
  s_xor_b32 s58, s58, 1
  v_smfmac_f32_16x16x64_bf16 v[24:27], v[52:55], v[144:151], v0
  ds_read_b128 v[80:83], v2 offset:12288
  v_smfmac_f32_16x16x64_bf16 v[28:31], v[52:55], v[152:159], v0
  ds_read_b128 v[84:87], v2 offset:13312
  v_smfmac_f32_16x16x64_bf16 v[32:35], v[52:55], v[96:103], v0
  ds_read_b128 v[88:91], v2 offset:14336
  v_smfmac_f32_16x16x64_bf16 v[36:39], v[52:55], v[104:111], v0
  ds_read_b128 v[92:95], v2 offset:15360
  s_waitcnt lgkmcnt(9)
  v_smfmac_f32_16x16x64_bf16 v[24:27], v[56:59], v[160:167], v0
  ds_read_b128 v[96:99], v2 offset:16384
  v_smfmac_f32_16x16x64_bf16 v[28:31], v[56:59], v[168:175], v0
  ds_read_b128 v[100:103], v2 offset:17408
  v_smfmac_f32_16x16x64_bf16 v[32:35], v[56:59], v[112:119], v0
  ds_read_b128 v[104:107], v2 offset:18432
  v_smfmac_f32_16x16x64_bf16 v[36:39], v[56:59], v[120:127], v0
  ds_read_b128 v[108:111], v2 offset:19456
  s_waitcnt lgkmcnt(12)
  v_smfmac_f32_16x16x64_bf16 v[24:27], v[60:63], v[176:183], v0
  ds_read_b128 v[112:115], v2 offset:20480
  v_smfmac_f32_16x16x64_bf16 v[28:31], v[60:63], v[184:191], v0
  ds_read_b128 v[116:119], v2 offset:21504
  s_waitcnt lgkmcnt(6)
  v_smfmac_f32_16x16x64_bf16 v[32:35], v[60:63], v[80:87], v0
  ds_read_b128 v[120:123], v2 offset:22528
  v_smfmac_f32_16x16x64_bf16 v[36:39], v[60:63], v[88:95], v0
  ds_read_b128 v[124:127], v2 offset:23552
  v_smfmac_f32_16x16x64_bf16 v[24:27], v[64:67], v[192:199], v0
  ds_read_b128 v[80:83], v2 offset:24576
  v_smfmac_f32_16x16x64_bf16 v[28:31], v[64:67], v[200:207], v0
  ds_read_b128 v[84:87], v2 offset:25600
  s_waitcnt lgkmcnt(6)
  v_smfmac_f32_16x16x64_bf16 v[32:35], v[64:67], v[96:103], v0
  ds_read_b128 v[88:91], v2 offset:26624
  v_smfmac_f32_16x16x64_bf16 v[36:39], v[64:67], v[104:111], v0
  ds_read_b128 v[92:95], v2 offset:27648
  v_smfmac_f32_16x16x64_bf16 v[24:27], v[68:71], v[208:215], v0
  ds_read_b128 v[96:99], v2 offset:28672
  v_smfmac_f32_16x16x64_bf16 v[28:31], v[68:71], v[216:223], v0
  ds_read_b128 v[100:103], v2 offset:29696
  s_waitcnt lgkmcnt(6)
  v_smfmac_f32_16x16x64_bf16 v[32:35], v[68:71], v[112:119], v0
  ds_read_b128 v[104:107], v2 offset:30720
  v_smfmac_f32_16x16x64_bf16 v[36:39], v[68:71], v[120:127], v0
  ds_read_b128 v[108:111], v2 offset:31744
  v_smfmac_f32_16x16x64_bf16 v[24:27], v[72:75], v[224:231], v0
  ds_read_b128 v[112:115], v14 offset:0
  global_store_dwordx4 v1, v[40:43], s[48:49] sc1
  v_smfmac_f32_16x16x64_bf16 v[28:31], v[72:75], v[232:239], v0
  ds_read_b128 v[116:119], v14 offset:1024
  s_waitcnt lgkmcnt(6)
  v_smfmac_f32_16x16x64_bf16 v[32:35], v[72:75], v[80:87], v0
  ds_read_b128 v[120:123], v14 offset:2048
  v_mov_b64 v[40:41], 0
  v_smfmac_f32_16x16x64_bf16 v[36:39], v[72:75], v[88:95], v0
  ds_read_b128 v[124:127], v14 offset:3072
  v_mov_b64 v[42:43], 0
  v_smfmac_f32_16x16x64_bf16 v[24:27], v[76:79], v[240:247], v0
  ds_read_b128 v[80:83], v14 offset:4096
  v_smfmac_f32_16x16x64_bf16 v[28:31], v[76:79], v[248:255], v0
  ds_read_b128 v[84:87], v14 offset:5120
  s_waitcnt lgkmcnt(6)
  v_smfmac_f32_16x16x64_bf16 v[32:35], v[76:79], v[96:103], v0
  ds_read_b128 v[88:91], v14 offset:6144
  v_smfmac_f32_16x16x64_bf16 v[36:39], v[76:79], v[104:111], v0
  ds_read_b128 v[92:95], v14 offset:7168
  v_add_f32 v24, v24, v26
  v_add_f32 v25, v25, v27
  v_add_f32 v28, v28, v30
  v_add_f32 v29, v29, v31
  v_smfmac_f32_16x16x64_bf16 v[40:43], v[48:51], a[0:7], v0
  v_add_f32 v32, v32, v34
  v_add_f32 v33, v33, v35
  v_add_f32 v36, v36, v38
  v_add_f32 v37, v37, v39
  v_cvt_pk_bf16_f32 v38, v28, v36
  v_cvt_pk_bf16_f32 v39, v29, v37
  v_smfmac_f32_16x16x64_bf16 v[44:47], v[48:51], a[8:15], v0
  ds_write2_b32 v10, v38, v39 offset0:0 offset1:68
  v_cvt_pk_bf16_f32 v36, v24, v32
  v_cvt_pk_bf16_f32 v37, v25, v33
  ds_write2_b32 v10, v36, v37 offset0:136 offset1:204
  v_smfmac_f32_16x16x64_bf16 v[40:43], v[52:55], a[16:23], v0
  s_cmp_eq_u32 s51, 63
  v_smfmac_f32_16x16x64_bf16 v[44:47], v[52:55], a[24:31], v0
  s_cbranch_scc1 tlast_7
  v_smfmac_f32_16x16x64_bf16 v[40:43], v[56:59], a[32:39], v0
  s_waitcnt lgkmcnt(0)
  s_barrier
  ds_read_b128 v[96:99], v11 offset:0
  v_smfmac_f32_16x16x64_bf16 v[44:47], v[56:59], a[40:47], v0
  ds_read_b128 v[100:103], v11 offset:1088
  v_smfmac_f32_16x16x64_bf16 v[40:43], v[60:63], a[48:55], v0
  ds_read_b128 v[104:107], v11 offset:2176
  v_smfmac_f32_16x16x64_bf16 v[44:47], v[60:63], a[56:63], v0
  ds_read_b128 v[108:111], v11 offset:3264
  v_smfmac_f32_16x16x64_bf16 v[40:43], v[64:67], a[64:71], v0
  v_smfmac_f32_16x16x64_bf16 v[44:47], v[64:67], a[72:79], v0
  global_load_lds_dwordx4 v1, s[44:45] sc1
  v_smfmac_f32_16x16x64_bf16 v[40:43], v[68:71], a[80:87], v0
  global_load_lds_dwordx4 v1, s[44:45] offset:1024 sc1
  s_waitcnt lgkmcnt(3)
  v_mfma_f32_16x16x32_bf16 v[24:27], v[112:115], v[96:99], 0
  buffer_store_dword v15, v1, s[4:7], 0 offen sc1
  v_mfma_f32_16x16x32_bf16 v[28:31], v[116:119], v[96:99], 0
  buffer_load_dword v15, v1, s[8:11], 0 offen sc1
  v_mfma_f32_16x16x32_bf16 v[32:35], v[96:99], v[96:99], 0
  v_mov_b64 v[48:49], 0
  s_waitcnt lgkmcnt(2)
  v_mfma_f32_16x16x32_bf16 v[24:27], v[120:123], v[100:103], v[24:27]
  v_mov_b64 v[50:51], 0
  v_mfma_f32_16x16x32_bf16 v[28:31], v[124:127], v[100:103], v[28:31]
  v_mov_b64 v[52:53], 0
  v_mfma_f32_16x16x32_bf16 v[32:35], v[100:103], v[100:103], v[32:35]
  v_mov_b64 v[54:55], 0
  s_waitcnt lgkmcnt(1)
  v_mfma_f32_16x16x32_bf16 v[24:27], v[80:83], v[104:107], v[24:27]
  v_mov_b64 v[56:57], 0
  v_mfma_f32_16x16x32_bf16 v[28:31], v[84:87], v[104:107], v[28:31]
  v_mov_b64 v[58:59], 0
  v_mfma_f32_16x16x32_bf16 v[32:35], v[104:107], v[104:107], v[32:35]
  v_mov_b64 v[60:61], 0
  s_waitcnt lgkmcnt(0)
  v_mfma_f32_16x16x32_bf16 v[24:27], v[88:91], v[108:111], v[24:27]
  v_mov_b64 v[62:63], 0
  s_mov_b32 vcc_lo, 0xcccccccc
  s_mov_b32 vcc_hi, 0xcccccccc
  v_mfma_f32_16x16x32_bf16 v[28:31], v[92:95], v[108:111], v[28:31]
  v_mfma_f32_16x16x32_bf16 v[32:35], v[108:111], v[108:111], v[32:35]
  v_smfmac_f32_16x16x64_bf16 v[44:47], v[68:71], a[88:95], v0
  v_xor_b32 v14, 8192, v14
  v_cndmask_b32_dpp v24, v28, v24, vcc quad_perm:[2,3,2,3] row_mask:0xf bank_mask:0xf
  v_cndmask_b32_dpp v25, v29, v25, vcc quad_perm:[2,3,2,3] row_mask:0xf bank_mask:0xf
  v_cndmask_b32_dpp v26, v30, v26, vcc quad_perm:[2,3,2,3] row_mask:0xf bank_mask:0xf
  v_cndmask_b32_dpp v27, v31, v27, vcc quad_perm:[2,3,2,3] row_mask:0xf bank_mask:0xf
  v_cndmask_b32_dpp v32, v33, v32, vcc quad_perm:[2,3,2,3] row_mask:0xf bank_mask:0xf
  v_max3_f32 v93, v24, v25, v26
  v_max3_f32 v93, v93, v27, v32
  v_smfmac_f32_16x16x64_bf16 v[40:43], v[72:75], a[96:103], v0
  v_mov_b32 v104, 0x3f803f80
  v_max_f32_dpp v92, v93, v93 quad_perm:[2,3,0,1] row_mask:0xf bank_mask:0xf
  v_max_f32_dpp v93, v93, v93 quad_perm:[2,3,0,1] row_mask:0xf bank_mask:0xf
  v_smfmac_f32_16x16x64_bf16 v[44:47], v[72:75], a[104:111], v0
  v_mov_b32 v101, 0
  v_permlane16_swap_b32 v93, v92
  v_max_f32 v93, v93, v92
  v_max_f32 v92, v93, v92
  v_smfmac_f32_16x16x64_bf16 v[40:43], v[76:79], a[112:119], v0
  v_mov_b32 v102, 0
  v_permlane32_swap_b32 v93, v92
  v_max_f32 v93, v93, v92
  v_mul_f32 v92, s56, v93
  v_smfmac_f32_16x16x64_bf16 v[44:47], v[76:79], a[120:127], v0
  v_fma_f32 v32, v32, s56, -v92
  v_fma_f32 v24, v24, s56, -v92
  v_exp_f32 v32, v32
  v_fma_f32 v25, v25, s56, -v92
  v_exp_f32 v24, v24
  v_fma_f32 v26, v26, s56, -v92
  v_exp_f32 v25, v25
  v_mov_b32_dpp v33, v32 quad_perm:[0,1,0,1] row_mask:0xf bank_mask:0xf
  v_fma_f32 v27, v27, s56, -v92
  v_exp_f32 v26, v26
  v_cvt_pk_bf16_f32 v100, v32, v33
  v_exp_f32 v27, v27
  v_cvt_pk_bf16_f32 v96, v24, v25
  v_mov_b32 v105, v104
  v_cvt_pk_bf16_f32 v97, v26, v27
  v_cvt_pk_bf16_f32 v103, v32, v33
  v_mfma_f32_16x16x16bf16_1k v[88:91], v[104:105], v[100:101], 0
  v_mov_b32_dpp v98, v96 quad_perm:[0,1,0,1] row_mask:0xf bank_mask:0xf
  v_mov_b32_dpp v99, v97 quad_perm:[0,1,0,1] row_mask:0xf bank_mask:0xf
  v_mov_b64 v[106:107], v[104:105]
  s_waitcnt vmcnt(5)
  v_add_f32 v40, v40, v42
  v_mfma_f32_16x16x32_bf16 v[88:91], v[104:107], v[96:99], v[88:91]
  v_add_f32 v41, v41, v43
  v_add_f32 v44, v44, v46
  v_mfma_f32_16x16x32_bf16 v[80:83], v[16:19], v[96:99], 0
  v_add_f32 v45, v45, v47
  v_cvt_pk_bf16_f32 v40, v40, v41
  v_mfma_f32_16x16x32_bf16 v[84:87], v[20:23], v[96:99], 0
  v_cvt_pk_bf16_f32 v41, v44, v45
  v_mov_b64 v[42:43], v[38:39]
  v_rcp_f32_dpp v92, v88 quad_perm:[2,3,2,3] row_mask:0xf bank_mask:0xf
  v_mfma_f32_16x16x16bf16_1k v[80:83], v[40:41], v[100:101], v[80:83]
  v_mfma_f32_16x16x16bf16_1k v[84:87], v[40:41], v[102:103], v[84:87]
  s_nop 0
  v_xor_b32 v73, 32, v13
  v_xor_b32 v74, 1024, v13
  v_xor_b32 v75, 1056, v13
  v_mul_f32_dpp v80, v80, v92 quad_perm:[2,3,2,3] row_mask:0xf bank_mask:0xf
  v_mul_f32_dpp v81, v81, v92 quad_perm:[2,3,2,3] row_mask:0xf bank_mask:0xf
  v_mul_f32_dpp v82, v82, v92 quad_perm:[2,3,2,3] row_mask:0xf bank_mask:0xf
  v_mul_f32_dpp v83, v83, v92 quad_perm:[2,3,2,3] row_mask:0xf bank_mask:0xf
  v_mul_f32_dpp v84, v84, v92 quad_perm:[2,3,2,3] row_mask:0xf bank_mask:0xf
  v_mul_f32_dpp v85, v85, v92 quad_perm:[2,3,2,3] row_mask:0xf bank_mask:0xf
  v_mul_f32_dpp v86, v86, v92 quad_perm:[2,3,2,3] row_mask:0xf bank_mask:0xf
  v_mul_f32_dpp v87, v87, v92 quad_perm:[2,3,2,3] row_mask:0xf bank_mask:0xf
  v_cvt_pk_bf16_f32 v24, v80, v84
  v_cvt_pk_bf16_f32 v25, v81, v85
  v_cvt_pk_bf16_f32 v26, v82, v86
  v_cvt_pk_bf16_f32 v27, v83, v87
  ds_write_b128 v13, v[24:27]
  s_nop 0
  v_smfmac_f32_16x16x64_bf16 v[48:51], v[24:27], a[128:135], v0
  v_smfmac_f32_16x16x64_bf16 v[52:55], v[24:27], a[136:143], v0
  s_waitcnt lgkmcnt(0)
  s_barrier
  ds_read_b128 v[28:31], v73
  v_smfmac_f32_16x16x64_bf16 v[56:59], v[24:27], a[144:151], v0
  ds_read_b128 v[64:67], v74
  v_smfmac_f32_16x16x64_bf16 v[60:63], v[24:27], a[152:159], v0
  ds_read_b128 v[68:71], v75
  s_waitcnt lgkmcnt(2)
  v_smfmac_f32_16x16x64_bf16 v[48:51], v[28:31], a[160:167], v0
  v_smfmac_f32_16x16x64_bf16 v[52:55], v[28:31], a[168:175], v0
  s_waitcnt lgkmcnt(1)
  v_smfmac_f32_16x16x64_bf16 v[48:51], v[64:67], a[192:199], v0
  v_smfmac_f32_16x16x64_bf16 v[52:55], v[64:67], a[200:207], v0
  s_waitcnt lgkmcnt(0)
  v_smfmac_f32_16x16x64_bf16 v[48:51], v[68:71], a[224:231], v0
  v_smfmac_f32_16x16x64_bf16 v[52:55], v[68:71], a[232:239], v0
  v_smfmac_f32_16x16x64_bf16 v[56:59], v[28:31], a[176:183], v0
  ds_read_b128 v[88:91], v2 offset:2048
  v_cvt_pk_bf16_f32 v32, v48, v50
  v_smfmac_f32_16x16x64_bf16 v[56:59], v[64:67], a[208:215], v0
  v_cvt_pk_bf16_f32 v34, v49, v51
  v_cvt_pk_bf16_f32 v33, v52, v54
  v_cvt_pk_bf16_f32 v35, v53, v55
  v_smfmac_f32_16x16x64_bf16 v[60:63], v[28:31], a[184:191], v0
  v_and_or_b32 v32, v32, -2, s58
  global_store_dwordx4 v8, v[32:35], s[36:37]
  v_smfmac_f32_16x16x64_bf16 v[56:59], v[68:71], a[240:247], v0
  ds_read_b128 v[80:83], v2 offset:0
  v_smfmac_f32_16x16x64_bf16 v[60:63], v[64:67], a[216:223], v0
  ds_read_b128 v[84:87], v2 offset:1024
  v_smfmac_f32_16x16x64_bf16 v[60:63], v[68:71], a[248:255], v0
  s_mov_b32 s60, 0
  v_cvt_pk_bf16_f32 v36, v56, v58
  v_cvt_pk_bf16_f32 v38, v57, v59
  v_and_or_b32 v36, v36, -2, s58
  s_nop 3
  v_cvt_pk_bf16_f32 v37, v60, v62
  v_cvt_pk_bf16_f32 v39, v61, v63
  global_store_dwordx4 v8, v[36:39], s[38:39]
  ds_read_b128 v[92:95], v2 offset:3072
  ds_read_b128 v[96:99], v2 offset:4096
  ds_read_b128 v[100:103], v2 offset:5120
  ds_read_b128 v[104:107], v2 offset:6144
  ds_read_b128 v[108:111], v2 offset:7168
  ds_read_b128 v[112:115], v2 offset:8192
  ds_read_b128 v[116:119], v2 offset:9216
  ds_read_b128 v[120:123], v2 offset:10240
  ds_read_b128 v[124:127], v2 offset:11264
  ds_read_b128 v[44:47], v12 offset:30976
  s_add_u32 s44, s44, 0x40000
  s_addc_u32 s45, s45, 0
  s_add_u32 s46, s46, 0x40000
  s_addc_u32 s47, s47, 0
  s_add_u32 s48, s48, s59
  s_addc_u32 s49, s49, 0
  s_mov_b32 s59, 0x20000
  s_xor_b32 s50, s50, 8192
  s_mov_b32 m0, s50
  s_waitcnt vmcnt(0)
pp_12:
  global_load_dwordx4 v[64:67], v1, s[40:41] sc1
  global_load_dwordx4 v[68:71], v1, s[40:41] offset:1024 sc1
  s_add_u32 s60, s60, 1
  s_cmp_ge_u32 s60, 200000
  s_cbranch_scc1 k_end
  s_waitcnt vmcnt(1) lgkmcnt(0)
  v_mfma_f32_16x16x32_bf16 v[32:35], v[44:47], v[64:67], 0
  s_waitcnt vmcnt(0)
  v_mfma_f32_16x16x32_bf16 v[32:35], v[44:47], v[68:71], v[32:35]
  v_bitop3_b32 v72, v64, v68, s58 bitop3:0x7e
  v_and_b32 v72, 1, v72
  v_cmp_ne_u32 vcc, 0, v72
  s_nop 0
  s_and_b64 exec, vcc, vcc
  s_cbranch_scc1 pp_12
  s_mov_b64 exec, -1
  s_nop 0
  v_add_f32_dpp v32, v32, v32 row_ror:4 row_mask:0xf bank_mask:0xf
  v_add_f32_dpp v33, v33, v33 row_ror:4 row_mask:0xf bank_mask:0xf
  v_add_f32_dpp v34, v34, v34 row_ror:4 row_mask:0xf bank_mask:0xf
  v_add_f32_dpp v35, v35, v35 row_ror:4 row_mask:0xf bank_mask:0xf
  v_add_f32_dpp v32, v32, v32 row_ror:8 row_mask:0xf bank_mask:0xf
  v_add_f32_dpp v33, v33, v33 row_ror:8 row_mask:0xf bank_mask:0xf
  v_add_f32_dpp v34, v34, v34 row_ror:8 row_mask:0xf bank_mask:0xf
  v_add_f32_dpp v35, v35, v35 row_ror:8 row_mask:0xf bank_mask:0xf
  v_cvt_pk_bf16_f32 v36, v32, v33
  v_cvt_pk_bf16_f32 v37, v34, v35
  v_and_or_b32 v36, v36, -2, s58
  s_mov_b64 exec, s[52:53]
  global_store_dwordx2 v9, v[36:37], s[42:43]
  s_mov_b64 exec, -1
  s_mov_b32 s60, 0
  s_add_u32 s35, s51, 3
  s_min_u32 s35, s35, 64
  v_cmp_gt_u32 vcc, s35, v15
  s_nop 1
  s_and_b32 s61, vcc_lo, 3
  s_cmp_eq_u32 s61, 0
  s_cbranch_scc1 kvok_15
  s_mov_b32 s63, 0
sp_16:
  buffer_load_dword v15, v1, s[8:11], 0 offen sc1
  s_add_u32 s63, s63, 1
  s_waitcnt vmcnt(0)
  v_cmp_gt_u32 vcc, s35, v15
  s_nop 1
  s_and_b32 s61, vcc_lo, 3
  s_cmp_eq_u32 s61, 0
  s_cbranch_scc1 sp_17
  s_cmp_ge_u32 s63, 400000
  s_cbranch_scc1 k_end
  s_sleep 1
  s_branch sp_16
sp_17:
kvok_15:
  v_mov_b32 v15, s51
  s_and_b32 s61, s35, 0x4f
  s_cmp_eq_u32 s61, 0
  s_cselect_b32 s61, 2048, 0
  s_add_u32 s8, s8, s61
  s_addc_u32 s9, s9, 0
  v_mov_b64 v[24:25], 0
  v_mov_b64 v[26:27], 0
  v_mov_b64 v[28:29], 0
  v_mov_b64 v[30:31], 0
  v_mov_b64 v[32:33], 0
  v_mov_b64 v[34:35], 0
  v_mov_b64 v[36:37], 0
  v_mov_b64 v[38:39], 0
  v_mov_b64 v[44:45], 0
  v_mov_b64 v[46:47], 0
  s_add_u32 s51, s51, 1
  s_branch tl_6
tlast_7:
  s_add_u32 s48, s48, s59
  s_addc_u32 s49, s49, 0
  v_smfmac_f32_16x16x64_bf16 v[40:43], v[56:59], a[32:39], v0
  v_smfmac_f32_16x16x64_bf16 v[44:47], v[56:59], a[40:47], v0
  v_smfmac_f32_16x16x64_bf16 v[40:43], v[60:63], a[48:55], v0
  v_smfmac_f32_16x16x64_bf16 v[44:47], v[60:63], a[56:63], v0
  v_smfmac_f32_16x16x64_bf16 v[40:43], v[64:67], a[64:71], v0
  v_smfmac_f32_16x16x64_bf16 v[44:47], v[64:67], a[72:79], v0
  v_smfmac_f32_16x16x64_bf16 v[40:43], v[68:71], a[80:87], v0
  v_smfmac_f32_16x16x64_bf16 v[44:47], v[68:71], a[88:95], v0
  v_smfmac_f32_16x16x64_bf16 v[40:43], v[72:75], a[96:103], v0
  v_smfmac_f32_16x16x64_bf16 v[44:47], v[72:75], a[104:111], v0
  v_smfmac_f32_16x16x64_bf16 v[40:43], v[76:79], a[112:119], v0
  v_smfmac_f32_16x16x64_bf16 v[44:47], v[76:79], a[120:127], v0
  s_nop 7
  v_add_f32 v40, v40, v42
  v_add_f32 v41, v41, v43
  v_add_f32 v44, v44, v46
  v_add_f32 v45, v45, v47
  v_cvt_pk_bf16_f32 v40, v40, v41
  v_cvt_pk_bf16_f32 v41, v44, v45
  v_mov_b64 v[42:43], v[38:39]
  global_store_dwordx4 v1, v[40:43], s[48:49] sc1
  s_waitcnt vmcnt(0) lgkmcnt(0)
  s_branch k_td
k_slow:
  v_mov_b32 v15, 0
  ds_write_b128 v3, v[48:51]
  ds_write_b128 v3, v[52:55] offset:1024
  s_branch tent_20
tl_18:
  s_waitcnt vmcnt(0)
pp_21:
  global_load_dwordx4 v[48:51], v7, s[42:43] sc1
  global_load_dwordx4 v[52:55], v7, s[42:43] offset:1024 sc1
  s_add_u32 s60, s60, 1
  s_cmp_ge_u32 s60, 200000
  s_cbranch_scc1 k_end
  s_waitcnt vmcnt(1) lgkmcnt(0)
  ds_write_b128 v3, v[48:51]
  v_bitop3_b32 v72, v48, v50, s58 bitop3:0x7e
  s_waitcnt vmcnt(0)
  ds_write_b128 v3, v[52:55] offset:1024
  v_bitop3_b32 v73, v52, v54, s58 bitop3:0x7e
  v_bitop3_b32 v72, v72, v73, 1 bitop3:0xa8
  v_cmp_ne_u32 vcc, 0, v72
  s_nop 0
  s_and_b64 exec, vcc, vcc
  s_cbranch_scc1 pp_21
  s_mov_b64 exec, -1
tent_20:
  s_waitcnt lgkmcnt(0)
  s_barrier
  ds_read_b128 v[56:59], v4 offset:0
  ds_read_b128 v[60:63], v4 offset:1024
  v_smfmac_f32_16x16x64_bf16 v[24:27], v[48:51], v[128:135], v0
  ds_read_b128 v[64:67], v5 offset:0
  v_smfmac_f32_16x16x64_bf16 v[28:31], v[48:51], v[136:143], v0
  ds_read_b128 v[68:71], v5 offset:1024
  global_load_dwordx4 v[16:19], v1, s[46:47] sc1
  v_smfmac_f32_16x16x64_bf16 v[32:35], v[48:51], v[80:87], v0
  ds_read_b128 v[72:75], v6 offset:0
  global_load_dwordx4 v[20:23], v1, s[46:47] offset:1024 sc1
  v_smfmac_f32_16x16x64_bf16 v[36:39], v[48:51], v[88:95], v0
  ds_read_b128 v[76:79], v6 offset:1024
  s_xor_b32 s58, s58, 1
  v_smfmac_f32_16x16x64_bf16 v[24:27], v[52:55], v[144:151], v0
  ds_read_b128 v[80:83], v2 offset:12288
  v_smfmac_f32_16x16x64_bf16 v[28:31], v[52:55], v[152:159], v0
  ds_read_b128 v[84:87], v2 offset:13312
  v_smfmac_f32_16x16x64_bf16 v[32:35], v[52:55], v[96:103], v0
  ds_read_b128 v[88:91], v2 offset:14336
  v_smfmac_f32_16x16x64_bf16 v[36:39], v[52:55], v[104:111], v0
  ds_read_b128 v[92:95], v2 offset:15360
  s_waitcnt lgkmcnt(9)
  v_smfmac_f32_16x16x64_bf16 v[24:27], v[56:59], v[160:167], v0
  ds_read_b128 v[96:99], v2 offset:16384
  v_smfmac_f32_16x16x64_bf16 v[28:31], v[56:59], v[168:175], v0
  ds_read_b128 v[100:103], v2 offset:17408
  v_smfmac_f32_16x16x64_bf16 v[32:35], v[56:59], v[112:119], v0
  ds_read_b128 v[104:107], v2 offset:18432
  v_smfmac_f32_16x16x64_bf16 v[36:39], v[56:59], v[120:127], v0
  ds_read_b128 v[108:111], v2 offset:19456
  s_waitcnt lgkmcnt(12)
  v_smfmac_f32_16x16x64_bf16 v[24:27], v[60:63], v[176:183], v0
  ds_read_b128 v[112:115], v2 offset:20480
  v_smfmac_f32_16x16x64_bf16 v[28:31], v[60:63], v[184:191], v0
  ds_read_b128 v[116:119], v2 offset:21504
  s_waitcnt lgkmcnt(6)
  v_smfmac_f32_16x16x64_bf16 v[32:35], v[60:63], v[80:87], v0
  ds_read_b128 v[120:123], v2 offset:22528
  v_smfmac_f32_16x16x64_bf16 v[36:39], v[60:63], v[88:95], v0
  ds_read_b128 v[124:127], v2 offset:23552
  v_smfmac_f32_16x16x64_bf16 v[24:27], v[64:67], v[192:199], v0
  ds_read_b128 v[80:83], v2 offset:24576
  v_smfmac_f32_16x16x64_bf16 v[28:31], v[64:67], v[200:207], v0
  ds_read_b128 v[84:87], v2 offset:25600
  s_waitcnt lgkmcnt(6)
  v_smfmac_f32_16x16x64_bf16 v[32:35], v[64:67], v[96:103], v0
  ds_read_b128 v[88:91], v2 offset:26624
  v_smfmac_f32_16x16x64_bf16 v[36:39], v[64:67], v[104:111], v0
  ds_read_b128 v[92:95], v2 offset:27648
  v_smfmac_f32_16x16x64_bf16 v[24:27], v[68:71], v[208:215], v0
  ds_read_b128 v[96:99], v2 offset:28672
  v_smfmac_f32_16x16x64_bf16 v[28:31], v[68:71], v[216:223], v0
  ds_read_b128 v[100:103], v2 offset:29696
  s_waitcnt lgkmcnt(6)
  v_smfmac_f32_16x16x64_bf16 v[32:35], v[68:71], v[112:119], v0
  ds_read_b128 v[104:107], v2 offset:30720
  v_smfmac_f32_16x16x64_bf16 v[36:39], v[68:71], v[120:127], v0
  ds_read_b128 v[108:111], v2 offset:31744
  v_smfmac_f32_16x16x64_bf16 v[24:27], v[72:75], v[224:231], v0
  ds_read_b128 v[112:115], v14 offset:0
  global_store_dwordx4 v1, v[40:43], s[48:49] sc1
  v_smfmac_f32_16x16x64_bf16 v[28:31], v[72:75], v[232:239], v0
  ds_read_b128 v[116:119], v14 offset:1024
  s_waitcnt lgkmcnt(6)
  v_smfmac_f32_16x16x64_bf16 v[32:35], v[72:75], v[80:87], v0
  ds_read_b128 v[120:123], v14 offset:2048
  v_mov_b64 v[40:41], 0
  v_smfmac_f32_16x16x64_bf16 v[36:39], v[72:75], v[88:95], v0
  ds_read_b128 v[124:127], v14 offset:3072
  v_mov_b64 v[42:43], 0
  v_smfmac_f32_16x16x64_bf16 v[24:27], v[76:79], v[240:247], v0
  ds_read_b128 v[80:83], v14 offset:4096
  v_smfmac_f32_16x16x64_bf16 v[28:31], v[76:79], v[248:255], v0
  ds_read_b128 v[84:87], v14 offset:5120
  s_waitcnt lgkmcnt(6)
  v_smfmac_f32_16x16x64_bf16 v[32:35], v[76:79], v[96:103], v0
  ds_read_b128 v[88:91], v14 offset:6144
  v_smfmac_f32_16x16x64_bf16 v[36:39], v[76:79], v[104:111], v0
  ds_read_b128 v[92:95], v14 offset:7168
  v_add_f32 v24, v24, v26
  v_add_f32 v25, v25, v27
  v_add_f32 v28, v28, v30
  v_add_f32 v29, v29, v31
  v_smfmac_f32_16x16x64_bf16 v[40:43], v[48:51], a[0:7], v0
  v_add_f32 v32, v32, v34
  v_add_f32 v33, v33, v35
  v_add_f32 v36, v36, v38
  v_add_f32 v37, v37, v39
  v_cvt_pk_bf16_f32 v38, v28, v36
  v_cvt_pk_bf16_f32 v39, v29, v37
  v_smfmac_f32_16x16x64_bf16 v[44:47], v[48:51], a[8:15], v0
  ds_write2_b32 v10, v38, v39 offset0:0 offset1:68
  v_cvt_pk_bf16_f32 v36, v24, v32
  v_cvt_pk_bf16_f32 v37, v25, v33
  ds_write2_b32 v10, v36, v37 offset0:136 offset1:204
  v_smfmac_f32_16x16x64_bf16 v[40:43], v[52:55], a[16:23], v0
  s_cmp_eq_u32 s51, 63
  v_smfmac_f32_16x16x64_bf16 v[44:47], v[52:55], a[24:31], v0
  s_cbranch_scc1 tlast_19
  v_smfmac_f32_16x16x64_bf16 v[40:43], v[56:59], a[32:39], v0
  s_waitcnt lgkmcnt(0)
  s_barrier
  ds_read_b128 v[96:99], v11 offset:0
  v_smfmac_f32_16x16x64_bf16 v[44:47], v[56:59], a[40:47], v0
  ds_read_b128 v[100:103], v11 offset:1088
  v_smfmac_f32_16x16x64_bf16 v[40:43], v[60:63], a[48:55], v0
  ds_read_b128 v[104:107], v11 offset:2176
  v_smfmac_f32_16x16x64_bf16 v[44:47], v[60:63], a[56:63], v0
  ds_read_b128 v[108:111], v11 offset:3264
  v_smfmac_f32_16x16x64_bf16 v[40:43], v[64:67], a[64:71], v0
  v_smfmac_f32_16x16x64_bf16 v[44:47], v[64:67], a[72:79], v0
  global_load_lds_dwordx4 v1, s[44:45] sc1
  v_smfmac_f32_16x16x64_bf16 v[40:43], v[68:71], a[80:87], v0
  global_load_lds_dwordx4 v1, s[44:45] offset:1024 sc1
  s_waitcnt lgkmcnt(3)
  v_mfma_f32_16x16x32_bf16 v[24:27], v[112:115], v[96:99], 0
  buffer_store_dword v15, v1, s[4:7], 0 offen sc1
  v_mfma_f32_16x16x32_bf16 v[28:31], v[116:119], v[96:99], 0
  buffer_load_dword v15, v1, s[8:11], 0 offen sc1
  v_mfma_f32_16x16x32_bf16 v[32:35], v[96:99], v[96:99], 0
  v_mov_b64 v[48:49], 0
  s_waitcnt lgkmcnt(2)
  v_mfma_f32_16x16x32_bf16 v[24:27], v[120:123], v[100:103], v[24:27]
  v_mov_b64 v[50:51], 0
  v_mfma_f32_16x16x32_bf16 v[28:31], v[124:127], v[100:103], v[28:31]
  v_mov_b64 v[52:53], 0
  v_mfma_f32_16x16x32_bf16 v[32:35], v[100:103], v[100:103], v[32:35]
  v_mov_b64 v[54:55], 0
  s_waitcnt lgkmcnt(1)
  v_mfma_f32_16x16x32_bf16 v[24:27], v[80:83], v[104:107], v[24:27]
  v_mov_b64 v[56:57], 0
  v_mfma_f32_16x16x32_bf16 v[28:31], v[84:87], v[104:107], v[28:31]
  v_mov_b64 v[58:59], 0
  v_mfma_f32_16x16x32_bf16 v[32:35], v[104:107], v[104:107], v[32:35]
  v_mov_b64 v[60:61], 0
  s_waitcnt lgkmcnt(0)
  v_mfma_f32_16x16x32_bf16 v[24:27], v[88:91], v[108:111], v[24:27]
  v_mov_b64 v[62:63], 0
  s_mov_b32 vcc_lo, 0xcccccccc
  s_mov_b32 vcc_hi, 0xcccccccc
  v_mfma_f32_16x16x32_bf16 v[28:31], v[92:95], v[108:111], v[28:31]
  v_mfma_f32_16x16x32_bf16 v[32:35], v[108:111], v[108:111], v[32:35]
  v_smfmac_f32_16x16x64_bf16 v[44:47], v[68:71], a[88:95], v0
  v_xor_b32 v14, 8192, v14
  v_cndmask_b32_dpp v24, v28, v24, vcc quad_perm:[2,3,2,3] row_mask:0xf bank_mask:0xf
  v_cndmask_b32_dpp v25, v29, v25, vcc quad_perm:[2,3,2,3] row_mask:0xf bank_mask:0xf
  v_cndmask_b32_dpp v26, v30, v26, vcc quad_perm:[2,3,2,3] row_mask:0xf bank_mask:0xf
  v_cndmask_b32_dpp v27, v31, v27, vcc quad_perm:[2,3,2,3] row_mask:0xf bank_mask:0xf
  v_cndmask_b32_dpp v32, v33, v32, vcc quad_perm:[2,3,2,3] row_mask:0xf bank_mask:0xf
  v_max3_f32 v93, v24, v25, v26
  v_max3_f32 v93, v93, v27, v32
  v_smfmac_f32_16x16x64_bf16 v[40:43], v[72:75], a[96:103], v0
  v_mov_b32 v104, 0x3f803f80
  v_max_f32_dpp v92, v93, v93 quad_perm:[2,3,0,1] row_mask:0xf bank_mask:0xf
  v_max_f32_dpp v93, v93, v93 quad_perm:[2,3,0,1] row_mask:0xf bank_mask:0xf
  v_smfmac_f32_16x16x64_bf16 v[44:47], v[72:75], a[104:111], v0
  v_mov_b32 v101, 0
  v_permlane16_swap_b32 v93, v92
  v_max_f32 v93, v93, v92
  v_max_f32 v92, v93, v92
  v_smfmac_f32_16x16x64_bf16 v[40:43], v[76:79], a[112:119], v0
  v_mov_b32 v102, 0
  v_permlane32_swap_b32 v93, v92
  v_max_f32 v93, v93, v92
  v_mul_f32 v92, s56, v93
  v_smfmac_f32_16x16x64_bf16 v[44:47], v[76:79], a[120:127], v0
  v_fma_f32 v32, v32, s56, -v92
  v_fma_f32 v24, v24, s56, -v92
  v_exp_f32 v32, v32
  v_fma_f32 v25, v25, s56, -v92
  v_exp_f32 v24, v24
  v_fma_f32 v26, v26, s56, -v92
  v_exp_f32 v25, v25
  v_mov_b32_dpp v33, v32 quad_perm:[0,1,0,1] row_mask:0xf bank_mask:0xf
  v_fma_f32 v27, v27, s56, -v92
  v_exp_f32 v26, v26
  v_cvt_pk_bf16_f32 v100, v32, v33
  v_exp_f32 v27, v27
  v_cvt_pk_bf16_f32 v96, v24, v25
  v_mov_b32 v105, v104
  v_cvt_pk_bf16_f32 v97, v26, v27
  v_cvt_pk_bf16_f32 v103, v32, v33
  v_mfma_f32_16x16x16bf16_1k v[88:91], v[104:105], v[100:101], 0
  v_mov_b32_dpp v98, v96 quad_perm:[0,1,0,1] row_mask:0xf bank_mask:0xf
  v_mov_b32_dpp v99, v97 quad_perm:[0,1,0,1] row_mask:0xf bank_mask:0xf
  v_mov_b64 v[106:107], v[104:105]
  s_waitcnt vmcnt(5)
  v_add_f32 v40, v40, v42
  v_mfma_f32_16x16x32_bf16 v[88:91], v[104:107], v[96:99], v[88:91]
  v_add_f32 v41, v41, v43
  v_add_f32 v44, v44, v46
  v_mfma_f32_16x16x32_bf16 v[80:83], v[16:19], v[96:99], 0
  v_add_f32 v45, v45, v47
  v_cvt_pk_bf16_f32 v40, v40, v41
  v_mfma_f32_16x16x32_bf16 v[84:87], v[20:23], v[96:99], 0
  v_cvt_pk_bf16_f32 v41, v44, v45
  v_mov_b64 v[42:43], v[38:39]
  v_rcp_f32_dpp v92, v88 quad_perm:[2,3,2,3] row_mask:0xf bank_mask:0xf
  v_mfma_f32_16x16x16bf16_1k v[80:83], v[40:41], v[100:101], v[80:83]
  v_mfma_f32_16x16x16bf16_1k v[84:87], v[40:41], v[102:103], v[84:87]
  s_nop 0
  v_xor_b32 v73, 32, v13
  v_xor_b32 v74, 1024, v13
  v_xor_b32 v75, 1056, v13
  v_mul_f32_dpp v80, v80, v92 quad_perm:[2,3,2,3] row_mask:0xf bank_mask:0xf
  v_mul_f32_dpp v81, v81, v92 quad_perm:[2,3,2,3] row_mask:0xf bank_mask:0xf
  v_mul_f32_dpp v82, v82, v92 quad_perm:[2,3,2,3] row_mask:0xf bank_mask:0xf
  v_mul_f32_dpp v83, v83, v92 quad_perm:[2,3,2,3] row_mask:0xf bank_mask:0xf
  v_mul_f32_dpp v84, v84, v92 quad_perm:[2,3,2,3] row_mask:0xf bank_mask:0xf
  v_mul_f32_dpp v85, v85, v92 quad_perm:[2,3,2,3] row_mask:0xf bank_mask:0xf
  v_mul_f32_dpp v86, v86, v92 quad_perm:[2,3,2,3] row_mask:0xf bank_mask:0xf
  v_mul_f32_dpp v87, v87, v92 quad_perm:[2,3,2,3] row_mask:0xf bank_mask:0xf
  v_cvt_pk_bf16_f32 v24, v80, v84
  v_cvt_pk_bf16_f32 v25, v81, v85
  v_cvt_pk_bf16_f32 v26, v82, v86
  v_cvt_pk_bf16_f32 v27, v83, v87
  ds_write_b128 v13, v[24:27]
  s_nop 0
  v_smfmac_f32_16x16x64_bf16 v[48:51], v[24:27], a[128:135], v0
  v_smfmac_f32_16x16x64_bf16 v[52:55], v[24:27], a[136:143], v0
  s_waitcnt lgkmcnt(0)
  s_barrier
  ds_read_b128 v[28:31], v73
  v_smfmac_f32_16x16x64_bf16 v[56:59], v[24:27], a[144:151], v0
  ds_read_b128 v[64:67], v74
  v_smfmac_f32_16x16x64_bf16 v[60:63], v[24:27], a[152:159], v0
  ds_read_b128 v[68:71], v75
  s_waitcnt lgkmcnt(2)
  v_smfmac_f32_16x16x64_bf16 v[48:51], v[28:31], a[160:167], v0
  v_smfmac_f32_16x16x64_bf16 v[52:55], v[28:31], a[168:175], v0
  s_waitcnt lgkmcnt(1)
  v_smfmac_f32_16x16x64_bf16 v[48:51], v[64:67], a[192:199], v0
  v_smfmac_f32_16x16x64_bf16 v[52:55], v[64:67], a[200:207], v0
  s_waitcnt lgkmcnt(0)
  v_smfmac_f32_16x16x64_bf16 v[48:51], v[68:71], a[224:231], v0
  v_smfmac_f32_16x16x64_bf16 v[52:55], v[68:71], a[232:239], v0
  v_smfmac_f32_16x16x64_bf16 v[56:59], v[28:31], a[176:183], v0
  ds_read_b128 v[88:91], v2 offset:2048
  v_cvt_pk_bf16_f32 v32, v48, v50
  v_smfmac_f32_16x16x64_bf16 v[56:59], v[64:67], a[208:215], v0
  v_cvt_pk_bf16_f32 v34, v49, v51
  v_cvt_pk_bf16_f32 v33, v52, v54
  v_cvt_pk_bf16_f32 v35, v53, v55
  v_smfmac_f32_16x16x64_bf16 v[60:63], v[28:31], a[184:191], v0
  v_and_or_b32 v32, v32, -2, s58
  global_store_dwordx4 v8, v[32:35], s[36:37] sc1
  v_smfmac_f32_16x16x64_bf16 v[56:59], v[68:71], a[240:247], v0
  ds_read_b128 v[80:83], v2 offset:0
  v_smfmac_f32_16x16x64_bf16 v[60:63], v[64:67], a[216:223], v0
  ds_read_b128 v[84:87], v2 offset:1024
  v_smfmac_f32_16x16x64_bf16 v[60:63], v[68:71], a[248:255], v0
  s_mov_b32 s60, 0
  v_cvt_pk_bf16_f32 v36, v56, v58
  v_cvt_pk_bf16_f32 v38, v57, v59
  v_and_or_b32 v36, v36, -2, s58
  s_nop 3
  v_cvt_pk_bf16_f32 v37, v60, v62
  v_cvt_pk_bf16_f32 v39, v61, v63
  global_store_dwordx4 v8, v[36:39], s[38:39] sc1
  ds_read_b128 v[92:95], v2 offset:3072
  ds_read_b128 v[96:99], v2 offset:4096
  ds_read_b128 v[100:103], v2 offset:5120
  ds_read_b128 v[104:107], v2 offset:6144
  ds_read_b128 v[108:111], v2 offset:7168
  ds_read_b128 v[112:115], v2 offset:8192
  ds_read_b128 v[116:119], v2 offset:9216
  ds_read_b128 v[120:123], v2 offset:10240
  ds_read_b128 v[124:127], v2 offset:11264
  ds_read_b128 v[44:47], v12 offset:30976
  s_add_u32 s44, s44, 0x40000
  s_addc_u32 s45, s45, 0
  s_add_u32 s46, s46, 0x40000
  s_addc_u32 s47, s47, 0
  s_add_u32 s48, s48, s59
  s_addc_u32 s49, s49, 0
  s_mov_b32 s59, 0x20000
  s_xor_b32 s50, s50, 8192
  s_mov_b32 m0, s50
  s_waitcnt vmcnt(0)
pp_24:
  global_load_dwordx4 v[64:67], v1, s[40:41] sc1
  global_load_dwordx4 v[68:71], v1, s[40:41] offset:1024 sc1
  s_add_u32 s60, s60, 1
  s_cmp_ge_u32 s60, 200000
  s_cbranch_scc1 k_end
  s_waitcnt vmcnt(1) lgkmcnt(0)
  v_mfma_f32_16x16x32_bf16 v[32:35], v[44:47], v[64:67], 0
  s_waitcnt vmcnt(0)
  v_mfma_f32_16x16x32_bf16 v[32:35], v[44:47], v[68:71], v[32:35]
  v_bitop3_b32 v72, v64, v68, s58 bitop3:0x7e
  v_and_b32 v72, 1, v72
  v_cmp_ne_u32 vcc, 0, v72
  s_nop 0
  s_and_b64 exec, vcc, vcc
  s_cbranch_scc1 pp_24
  s_mov_b64 exec, -1
  s_nop 0
  v_add_f32_dpp v32, v32, v32 row_ror:4 row_mask:0xf bank_mask:0xf
  v_add_f32_dpp v33, v33, v33 row_ror:4 row_mask:0xf bank_mask:0xf
  v_add_f32_dpp v34, v34, v34 row_ror:4 row_mask:0xf bank_mask:0xf
  v_add_f32_dpp v35, v35, v35 row_ror:4 row_mask:0xf bank_mask:0xf
  v_add_f32_dpp v32, v32, v32 row_ror:8 row_mask:0xf bank_mask:0xf
  v_add_f32_dpp v33, v33, v33 row_ror:8 row_mask:0xf bank_mask:0xf
  v_add_f32_dpp v34, v34, v34 row_ror:8 row_mask:0xf bank_mask:0xf
  v_add_f32_dpp v35, v35, v35 row_ror:8 row_mask:0xf bank_mask:0xf
  v_cvt_pk_bf16_f32 v36, v32, v33
  v_cvt_pk_bf16_f32 v37, v34, v35
  v_and_or_b32 v36, v36, -2, s58
  s_mov_b64 exec, s[52:53]
  global_store_dwordx2 v9, v[36:37], s[42:43] sc1
  s_mov_b64 exec, -1
  s_mov_b32 s60, 0
  s_add_u32 s35, s51, 3
  s_min_u32 s35, s35, 64
  v_cmp_gt_u32 vcc, s35, v15
  s_nop 1
  s_and_b32 s61, vcc_lo, 3
  s_cmp_eq_u32 s61, 0
  s_cbranch_scc1 kvok_27
  s_mov_b32 s63, 0
sp_28:
  buffer_load_dword v15, v1, s[8:11], 0 offen sc1
  s_add_u32 s63, s63, 1
  s_waitcnt vmcnt(0)
  v_cmp_gt_u32 vcc, s35, v15
  s_nop 1
  s_and_b32 s61, vcc_lo, 3
  s_cmp_eq_u32 s61, 0
  s_cbranch_scc1 sp_29
  s_cmp_ge_u32 s63, 400000
  s_cbranch_scc1 k_end
  s_sleep 1
  s_branch sp_28
sp_29:
kvok_27:
  v_mov_b32 v15, s51
  s_and_b32 s61, s35, 0x4f
  s_cmp_eq_u32 s61, 0
  s_cselect_b32 s61, 2048, 0
  s_add_u32 s8, s8, s61
  s_addc_u32 s9, s9, 0
  v_mov_b64 v[24:25], 0
  v_mov_b64 v[26:27], 0
  v_mov_b64 v[28:29], 0
  v_mov_b64 v[30:31], 0
  v_mov_b64 v[32:33], 0
  v_mov_b64 v[34:35], 0
  v_mov_b64 v[36:37], 0
  v_mov_b64 v[38:39], 0
  v_mov_b64 v[44:45], 0
  v_mov_b64 v[46:47], 0
  s_add_u32 s51, s51, 1
  s_branch tl_18
tlast_19:
  s_add_u32 s48, s48, s59
  s_addc_u32 s49, s49, 0
  v_smfmac_f32_16x16x64_bf16 v[40:43], v[56:59], a[32:39], v0
  v_smfmac_f32_16x16x64_bf16 v[44:47], v[56:59], a[40:47], v0
  v_smfmac_f32_16x16x64_bf16 v[40:43], v[60:63], a[48:55], v0
  v_smfmac_f32_16x16x64_bf16 v[44:47], v[60:63], a[56:63], v0
  v_smfmac_f32_16x16x64_bf16 v[40:43], v[64:67], a[64:71], v0
  v_smfmac_f32_16x16x64_bf16 v[44:47], v[64:67], a[72:79], v0
  v_smfmac_f32_16x16x64_bf16 v[40:43], v[68:71], a[80:87], v0
  v_smfmac_f32_16x16x64_bf16 v[44:47], v[68:71], a[88:95], v0
  v_smfmac_f32_16x16x64_bf16 v[40:43], v[72:75], a[96:103], v0
  v_smfmac_f32_16x16x64_bf16 v[44:47], v[72:75], a[104:111], v0
  v_smfmac_f32_16x16x64_bf16 v[40:43], v[76:79], a[112:119], v0
  v_smfmac_f32_16x16x64_bf16 v[44:47], v[76:79], a[120:127], v0
  s_nop 7
  v_add_f32 v40, v40, v42
  v_add_f32 v41, v41, v43
  v_add_f32 v44, v44, v46
  v_add_f32 v45, v45, v47
  v_cvt_pk_bf16_f32 v40, v40, v41
  v_cvt_pk_bf16_f32 v41, v44, v45
  v_mov_b64 v[42:43], v[38:39]
  global_store_dwordx4 v1, v[40:43], s[48:49] sc1
  s_waitcnt vmcnt(0) lgkmcnt(0)
  s_branch k_td
k_td:
  v_mov_b32 v15, 64
  buffer_store_dword v15, v1, s[4:7], 0 offen sc1
  s_waitcnt vmcnt(0)
  s_load_dwordx4 s[4:7], s[0:1], 0
  s_load_dwordx2 s[8:9], s[0:1], 16
  s_load_dwordx2 s[10:11], s[0:1], 32
  s_waitcnt lgkmcnt(0)
  s_cmp_ge_u32 s99, 480
  s_cbranch_scc1 k_end
  v_mbcnt_lo_u32_b32 v1, -1, 0
  v_mbcnt_hi_u32_b32 v1, -1, v1
  v_and_b32 v2, 15, v1
  v_lshrrev_b32 v3, 4, v1
  s_barrier
  s_branch k_w3
k_worker:
  v_mbcnt_lo_u32_b32 v1, -1, 0
  v_mbcnt_hi_u32_b32 v1, -1, v1
  v_and_b32 v2, 15, v1
  v_lshrrev_b32 v3, 4, v1
  v_mov_b32 v6, 163824
  s_cmp_lg_u32 s28, 0
  s_cbranch_scc1 bc_30
  s_mov_b64 exec, 1
  v_mov_b32 v5, 1
  s_cmp_eq_u32 s100, 2
  s_cbranch_scc1 nx_32
  s_cmp_eq_u32 s100, 1
  s_cbranch_scc1 nx_31
  s_mov_b32 s100, 1
  s_sub_u32 s30, s3, 1
  s_cbranch_scc0 nx_35
nx_31:
  s_mov_b64 exec, 0x7f
  v_lshlrev_b32 v7, 2, v1
  global_load_dword v8, v7, s[24:25] offset:132 sc1
  s_waitcnt vmcnt(0)
  v_cmp_gt_u32 vcc, 32, v8
  s_nop 1
  s_ff1_i32_b32 s30, vcc_lo
  s_mov_b64 exec, 1
  s_cbranch_vccz nx_32
nx_35:
  s_lshl_b32 s31, s30, 2
  v_mov_b32 v7, s31
  global_atomic_add v4, v7, v5, s[24:25] offset:132 sc0 sc1
  s_waitcnt vmcnt(0)
  v_readfirstlane_b32 s31, v4
  s_cmp_ge_u32 s31, 32
  s_cbranch_scc1 nx_31
  s_and_b32 s32, s31, 7
  s_mul_i32 s32, s32, 7
  s_add_u32 s32, s32, s30
  s_lshr_b32 s31, s31, 3
  s_add_u32 s32, s32, 16
  s_cmp_ge_u32 s32, 56
  s_cselect_b32 s33, 56, 0
  s_sub_u32 s32, s32, s33
  s_mul_i32 s33, s31, 54
  s_add_u32 s33, s33, s32
  s_add_u32 s33, s33, 8
  s_sub_u32 s34, s32, 54
  s_lshl_b32 s34, s34, 2
  s_add_u32 s34, s34, s31
  s_cmp_ge_u32 s32, 54
  s_cselect_b32 s33, s34, s33
  v_mov_b32 v4, s33
  s_branch nx_34
nx_32:
  s_mov_b32 s100, 2
  v_mov_b32 v7, 0
  global_atomic_add v4, v7, v5, s[24:25] offset:128 sc0 sc1
  s_waitcnt vmcnt(0)
  v_add_u32 v4, 224, v4
nx_34:
  ds_write_b64 v6, v[4:5]
  s_mov_b64 exec, -1
  s_waitcnt lgkmcnt(0)
bc_30:
  s_barrier
  ds_read_b64 v[4:5], v6
  s_waitcnt lgkmcnt(0)
  v_readfirstlane_b32 s29, v4
  v_readfirstlane_b32 s62, v5
  s_barrier
  s_cmp_ge_u32 s29, 224
  s_cbranch_scc1 k_w2
  s_cmp_ge_u32 s29, 8
  s_cbranch_scc1 k_g1
  s_cmp_lg_u32 s29, 0
  s_cbranch_scc1 k_gate
  v_lshlrev_b32 v4, 4, v0
  v_add_u32 v4, 89133056, v4
  v_add_u32 v5, 8192, v4
  v_add_u32 v6, 16384, v4
  v_add_u32 v7, 24576, v4
  v_mov_b32 v8, 0
  v_mov_b32 v9, 0
  v_mov_b32 v10, 0
  v_mov_b32 v11, 0
  global_store_dwordx4 v4, v[8:11], s[26:27] offset:-4096 sc1
  global_store_dwordx4 v4, v[8:11], s[26:27] offset:0 sc1
  global_store_dwordx4 v5, v[8:11], s[26:27] offset:-4096 sc1
  global_store_dwordx4 v5, v[8:11], s[26:27] offset:0 sc1
  global_store_dwordx4 v6, v[8:11], s[26:27] offset:-4096 sc1
  global_store_dwordx4 v6, v[8:11], s[26:27] offset:0 sc1
  global_store_dwordx4 v7, v[8:11], s[26:27] offset:-4096 sc1
  global_store_dwordx4 v7, v[8:11], s[26:27] offset:0 sc1
  s_waitcnt vmcnt(0)
  s_barrier
  v_mov_b32 v4, 1
  global_store_dword v8, v4, s[24:25] offset:192 sc1
k_gate:
  s_lshl_b32 s30, s29, 8
  s_lshl_b32 s31, s28, 6
  s_add_u32 s30, s30, s31
  s_lshl_b32 s31, s30, 10
  v_lshlrev_b32 v4, 4, v3
  v_lshl_add_u32 v5, v2, 10, v4
  v_add_u32 v5, s31, v5
  s_lshl_b32 s31, s30, 2
  v_lshl_add_u32 v6, v2, 2, s31
  s_add_u32 s32, s26, 85983232
  s_addc_u32 s33, s27, 0
  global_load_dwordx4 v[16:19], v4, s[20:21] offset:0
  global_load_dwordx4 v[20:23], v4, s[20:21] offset:64
  global_load_dwordx4 v[24:27], v4, s[20:21] offset:128
  global_load_dwordx4 v[28:31], v4, s[20:21] offset:192
  global_load_dwordx4 v[32:35], v4, s[20:21] offset:256
  global_load_dwordx4 v[36:39], v4, s[20:21] offset:320
  global_load_dwordx4 v[40:43], v4, s[20:21] offset:384
  global_load_dwordx4 v[44:47], v4, s[20:21] offset:448
  global_load_dwordx4 v[48:51], v4, s[20:21] offset:512
  global_load_dwordx4 v[52:55], v4, s[20:21] offset:576
  global_load_dwordx4 v[56:59], v4, s[20:21] offset:640
  global_load_dwordx4 v[60:63], v4, s[20:21] offset:704
  global_load_dwordx4 v[64:67], v4, s[20:21] offset:768
  global_load_dwordx4 v[68:71], v4, s[20:21] offset:832
  global_load_dwordx4 v[72:75], v4, s[20:21] offset:896
  global_load_dwordx4 v[76:79], v4, s[20:21] offset:960
  global_load_dwordx4 v[80:83], v5, s[4:5] offset:0
  global_load_dwordx4 v[84:87], v5, s[4:5] offset:64
  global_load_dwordx4 v[88:91], v5, s[4:5] offset:128
  global_load_dwordx4 v[92:95], v5, s[4:5] offset:192
  global_load_dwordx4 v[96:99], v5, s[4:5] offset:256
  global_load_dwordx4 v[100:103], v5, s[4:5] offset:320
  global_load_dwordx4 v[104:107], v5, s[4:5] offset:384
  global_load_dwordx4 v[108:111], v5, s[4:5] offset:448
  global_load_dwordx4 v[112:115], v5, s[4:5] offset:512
  global_load_dwordx4 v[116:119], v5, s[4:5] offset:576
  global_load_dwordx4 v[120:123], v5, s[4:5] offset:640
  global_load_dwordx4 v[124:127], v5, s[4:5] offset:704
  global_load_dwordx4 v[128:131], v5, s[4:5] offset:768
  global_load_dwordx4 v[132:135], v5, s[4:5] offset:832
  global_load_dwordx4 v[136:139], v5, s[4:5] offset:896
  global_load_dwordx4 v[140:143], v5, s[4:5] offset:960
  v_add_u32 v5, 0x4000, v5
  s_waitcnt vmcnt(0)
  v_mfma_f32_16x16x32_bf16 v[8:11], v[16:19], v[80:83], 0
  v_mfma_f32_16x16x32_bf16 v[8:11], v[20:23], v[84:87], v[8:11]
  v_mfma_f32_16x16x32_bf16 v[8:11], v[24:27], v[88:91], v[8:11]
  v_mfma_f32_16x16x32_bf16 v[8:11], v[28:31], v[92:95], v[8:11]
  v_mfma_f32_16x16x32_bf16 v[8:11], v[32:35], v[96:99], v[8:11]
  v_mfma_f32_16x16x32_bf16 v[8:11], v[36:39], v[100:103], v[8:11]
  v_mfma_f32_16x16x32_bf16 v[8:11], v[40:43], v[104:107], v[8:11]
  v_mfma_f32_16x16x32_bf16 v[8:11], v[44:47], v[108:111], v[8:11]
  v_mfma_f32_16x16x32_bf16 v[8:11], v[48:51], v[112:115], v[8:11]
  v_mfma_f32_16x16x32_bf16 v[8:11], v[52:55], v[116:119], v[8:11]
  v_mfma_f32_16x16x32_bf16 v[8:11], v[56:59], v[120:123], v[8:11]
  v_mfma_f32_16x16x32_bf16 v[8:11], v[60:63], v[124:127], v[8:11]
  v_mfma_f32_16x16x32_bf16 v[8:11], v[64:67], v[128:131], v[8:11]
  v_mfma_f32_16x16x32_bf16 v[8:11], v[68:71], v[132:135], v[8:11]
  v_mfma_f32_16x16x32_bf16 v[8:11], v[72:75], v[136:139], v[8:11]
  v_mfma_f32_16x16x32_bf16 v[8:11], v[76:79], v[140:143], v[8:11]
  s_nop 7
  v_mul_f32 v8, 0xbfb8aa3b, v8
  v_exp_f32 v8, v8
  s_nop 0
  v_add_f32 v8, 1.0, v8
  v_rcp_f32 v8, v8
  s_mov_b64 exec, 0xffff
  s_nop 0
  global_store_dword v6, v8, s[32:33] offset:0 sc1
  s_mov_b64 exec, -1
  global_load_dwordx4 v[80:83], v5, s[4:5] offset:0
  global_load_dwordx4 v[84:87], v5, s[4:5] offset:64
  global_load_dwordx4 v[88:91], v5, s[4:5] offset:128
  global_load_dwordx4 v[92:95], v5, s[4:5] offset:192
  global_load_dwordx4 v[96:99], v5, s[4:5] offset:256
  global_load_dwordx4 v[100:103], v5, s[4:5] offset:320
  global_load_dwordx4 v[104:107], v5, s[4:5] offset:384
  global_load_dwordx4 v[108:111], v5, s[4:5] offset:448
  global_load_dwordx4 v[112:115], v5, s[4:5] offset:512
  global_load_dwordx4 v[116:119], v5, s[4:5] offset:576
  global_load_dwordx4 v[120:123], v5, s[4:5] offset:640
  global_load_dwordx4 v[124:127], v5, s[4:5] offset:704
  global_load_dwordx4 v[128:131], v5, s[4:5] offset:768
  global_load_dwordx4 v[132:135], v5, s[4:5] offset:832
  global_load_dwordx4 v[136:139], v5, s[4:5] offset:896
  global_load_dwordx4 v[140:143], v5, s[4:5] offset:960
  v_add_u32 v5, 0x4000, v5
  s_waitcnt vmcnt(0)
  v_mfma_f32_16x16x32_bf16 v[8:11], v[16:19], v[80:83], 0
  v_mfma_f32_16x16x32_bf16 v[8:11], v[20:23], v[84:87], v[8:11]
  v_mfma_f32_16x16x32_bf16 v[8:11], v[24:27], v[88:91], v[8:11]
  v_mfma_f32_16x16x32_bf16 v[8:11], v[28:31], v[92:95], v[8:11]
  v_mfma_f32_16x16x32_bf16 v[8:11], v[32:35], v[96:99], v[8:11]
  v_mfma_f32_16x16x32_bf16 v[8:11], v[36:39], v[100:103], v[8:11]
  v_mfma_f32_16x16x32_bf16 v[8:11], v[40:43], v[104:107], v[8:11]
  v_mfma_f32_16x16x32_bf16 v[8:11], v[44:47], v[108:111], v[8:11]
  v_mfma_f32_16x16x32_bf16 v[8:11], v[48:51], v[112:115], v[8:11]
  v_mfma_f32_16x16x32_bf16 v[8:11], v[52:55], v[116:119], v[8:11]
  v_mfma_f32_16x16x32_bf16 v[8:11], v[56:59], v[120:123], v[8:11]
  v_mfma_f32_16x16x32_bf16 v[8:11], v[60:63], v[124:127], v[8:11]
  v_mfma_f32_16x16x32_bf16 v[8:11], v[64:67], v[128:131], v[8:11]
  v_mfma_f32_16x16x32_bf16 v[8:11], v[68:71], v[132:135], v[8:11]
  v_mfma_f32_16x16x32_bf16 v[8:11], v[72:75], v[136:139], v[8:11]
  v_mfma_f32_16x16x32_bf16 v[8:11], v[76:79], v[140:143], v[8:11]
  s_nop 7
  v_mul_f32 v8, 0xbfb8aa3b, v8
  v_exp_f32 v8, v8
  s_nop 0
  v_add_f32 v8, 1.0, v8
  v_rcp_f32 v8, v8
  s_mov_b64 exec, 0xffff
  s_nop 0
  global_store_dword v6, v8, s[32:33] offset:64 sc1
  s_mov_b64 exec, -1
  global_load_dwordx4 v[80:83], v5, s[4:5] offset:0
  global_load_dwordx4 v[84:87], v5, s[4:5] offset:64
  global_load_dwordx4 v[88:91], v5, s[4:5] offset:128
  global_load_dwordx4 v[92:95], v5, s[4:5] offset:192
  global_load_dwordx4 v[96:99], v5, s[4:5] offset:256
  global_load_dwordx4 v[100:103], v5, s[4:5] offset:320
  global_load_dwordx4 v[104:107], v5, s[4:5] offset:384
  global_load_dwordx4 v[108:111], v5, s[4:5] offset:448
  global_load_dwordx4 v[112:115], v5, s[4:5] offset:512
  global_load_dwordx4 v[116:119], v5, s[4:5] offset:576
  global_load_dwordx4 v[120:123], v5, s[4:5] offset:640
  global_load_dwordx4 v[124:127], v5, s[4:5] offset:704
  global_load_dwordx4 v[128:131], v5, s[4:5] offset:768
  global_load_dwordx4 v[132:135], v5, s[4:5] offset:832
  global_load_dwordx4 v[136:139], v5, s[4:5] offset:896
  global_load_dwordx4 v[140:143], v5, s[4:5] offset:960
  v_add_u32 v5, 0x4000, v5
  s_waitcnt vmcnt(0)
  v_mfma_f32_16x16x32_bf16 v[8:11], v[16:19], v[80:83], 0
  v_mfma_f32_16x16x32_bf16 v[8:11], v[20:23], v[84:87], v[8:11]
  v_mfma_f32_16x16x32_bf16 v[8:11], v[24:27], v[88:91], v[8:11]
  v_mfma_f32_16x16x32_bf16 v[8:11], v[28:31], v[92:95], v[8:11]
  v_mfma_f32_16x16x32_bf16 v[8:11], v[32:35], v[96:99], v[8:11]
  v_mfma_f32_16x16x32_bf16 v[8:11], v[36:39], v[100:103], v[8:11]
  v_mfma_f32_16x16x32_bf16 v[8:11], v[40:43], v[104:107], v[8:11]
  v_mfma_f32_16x16x32_bf16 v[8:11], v[44:47], v[108:111], v[8:11]
  v_mfma_f32_16x16x32_bf16 v[8:11], v[48:51], v[112:115], v[8:11]
  v_mfma_f32_16x16x32_bf16 v[8:11], v[52:55], v[116:119], v[8:11]
  v_mfma_f32_16x16x32_bf16 v[8:11], v[56:59], v[120:123], v[8:11]
  v_mfma_f32_16x16x32_bf16 v[8:11], v[60:63], v[124:127], v[8:11]
  v_mfma_f32_16x16x32_bf16 v[8:11], v[64:67], v[128:131], v[8:11]
  v_mfma_f32_16x16x32_bf16 v[8:11], v[68:71], v[132:135], v[8:11]
  v_mfma_f32_16x16x32_bf16 v[8:11], v[72:75], v[136:139], v[8:11]
  v_mfma_f32_16x16x32_bf16 v[8:11], v[76:79], v[140:143], v[8:11]
  s_nop 7
  v_mul_f32 v8, 0xbfb8aa3b, v8
  v_exp_f32 v8, v8
  s_nop 0
  v_add_f32 v8, 1.0, v8
  v_rcp_f32 v8, v8
  s_mov_b64 exec, 0xffff
  s_nop 0
  global_store_dword v6, v8, s[32:33] offset:128 sc1
  s_mov_b64 exec, -1
  global_load_dwordx4 v[80:83], v5, s[4:5] offset:0
  global_load_dwordx4 v[84:87], v5, s[4:5] offset:64
  global_load_dwordx4 v[88:91], v5, s[4:5] offset:128
  global_load_dwordx4 v[92:95], v5, s[4:5] offset:192
  global_load_dwordx4 v[96:99], v5, s[4:5] offset:256
  global_load_dwordx4 v[100:103], v5, s[4:5] offset:320
  global_load_dwordx4 v[104:107], v5, s[4:5] offset:384
  global_load_dwordx4 v[108:111], v5, s[4:5] offset:448
  global_load_dwordx4 v[112:115], v5, s[4:5] offset:512
  global_load_dwordx4 v[116:119], v5, s[4:5] offset:576
  global_load_dwordx4 v[120:123], v5, s[4:5] offset:640
  global_load_dwordx4 v[124:127], v5, s[4:5] offset:704
  global_load_dwordx4 v[128:131], v5, s[4:5] offset:768
  global_load_dwordx4 v[132:135], v5, s[4:5] offset:832
  global_load_dwordx4 v[136:139], v5, s[4:5] offset:896
  global_load_dwordx4 v[140:143], v5, s[4:5] offset:960
  v_add_u32 v5, 0x4000, v5
  s_waitcnt vmcnt(0)
  v_mfma_f32_16x16x32_bf16 v[8:11], v[16:19], v[80:83], 0
  v_mfma_f32_16x16x32_bf16 v[8:11], v[20:23], v[84:87], v[8:11]
  v_mfma_f32_16x16x32_bf16 v[8:11], v[24:27], v[88:91], v[8:11]
  v_mfma_f32_16x16x32_bf16 v[8:11], v[28:31], v[92:95], v[8:11]
  v_mfma_f32_16x16x32_bf16 v[8:11], v[32:35], v[96:99], v[8:11]
  v_mfma_f32_16x16x32_bf16 v[8:11], v[36:39], v[100:103], v[8:11]
  v_mfma_f32_16x16x32_bf16 v[8:11], v[40:43], v[104:107], v[8:11]
  v_mfma_f32_16x16x32_bf16 v[8:11], v[44:47], v[108:111], v[8:11]
  v_mfma_f32_16x16x32_bf16 v[8:11], v[48:51], v[112:115], v[8:11]
  v_mfma_f32_16x16x32_bf16 v[8:11], v[52:55], v[116:119], v[8:11]
  v_mfma_f32_16x16x32_bf16 v[8:11], v[56:59], v[120:123], v[8:11]
  v_mfma_f32_16x16x32_bf16 v[8:11], v[60:63], v[124:127], v[8:11]
  v_mfma_f32_16x16x32_bf16 v[8:11], v[64:67], v[128:131], v[8:11]
  v_mfma_f32_16x16x32_bf16 v[8:11], v[68:71], v[132:135], v[8:11]
  v_mfma_f32_16x16x32_bf16 v[8:11], v[72:75], v[136:139], v[8:11]
  v_mfma_f32_16x16x32_bf16 v[8:11], v[76:79], v[140:143], v[8:11]
  s_nop 7
  v_mul_f32 v8, 0xbfb8aa3b, v8
  v_exp_f32 v8, v8
  s_nop 0
  v_add_f32 v8, 1.0, v8
  v_rcp_f32 v8, v8
  s_mov_b64 exec, 0xffff
  s_nop 0
  global_store_dword v6, v8, s[32:33] offset:192 sc1
  s_mov_b64 exec, -1
  s_waitcnt vmcnt(0)
  s_branch k_gd
k_gd:
  v_mov_b32 v13, 0
  s_mov_b32 s60, 0
sp_36:
  global_load_dword v14, v13, s[24:25] offset:192 sc1
  s_add_u32 s60, s60, 1
  s_waitcnt vmcnt(0)
  v_readfirstlane_b32 s62, v14
  s_cmp_lg_u32 s62, 0
  s_cbranch_scc1 sp_37
  s_cmp_ge_u32 s60, 400000
  s_cbranch_scc1 k_end
  s_sleep 2
  s_branch sp_36
sp_37:
  s_mov_b32 s31, 22016
  s_waitcnt vmcnt(0)
  s_barrier
  s_cmp_lg_u32 s28, 0
  s_cbranch_scc1 sg_38
  s_add_u32 s30, s31, 89128960
  v_mov_b32 v4, s30
  v_mov_b32 v5, 1
  s_mov_b64 exec, 1
  global_atomic_add v4, v5, s[26:27] sc1
  s_mov_b64 exec, -1
sg_38:
  s_branch k_worker
k_g1:
  s_sub_u32 s29, s29, 8
  s_mov_b32 s30, 0
  s_cmp_ge_u32 s29, 54
  s_addc_u32 s30, s30, 0
  s_cmp_ge_u32 s29, 108
  s_addc_u32 s30, s30, 0
  s_cmp_ge_u32 s29, 162
  s_addc_u32 s30, s30, 0
  s_mul_i32 s31, s30, 54
  s_sub_u32 s31, s29, s31
  s_cmp_ge_u32 s31, 48
  s_cbranch_scc1 g1a_39
  s_lshr_b32 s32, s31, 4
  s_mov_b32 s36, s12
  s_mov_b32 s37, s13
  s_cmp_eq_u32 s32, 1
  s_cselect_b32 s36, s14, s36
  s_cselect_b32 s37, s15, s37
  s_cmp_eq_u32 s32, 2
  s_cselect_b32 s36, s16, s36
  s_cselect_b32 s37, s17, s37
  s_mov_b32 s38, 0x400000
  s_mov_b32 s33, 8192
  s_and_b32 s34, s31, 15
  s_lshl_b32 s35, s34, 9
  s_lshl_b32 s40, s28, 7
  s_add_u32 s35, s35, s40
  s_lshl_b32 s40, s32, 24
  s_lshl_b32 s41, s30, 22
  s_add_u32 s40, s40, s41
  s_lshl_b32 s41, s34, 14
  s_add_u32 s40, s40, s41
  s_lshl_b32 s41, s28, 12
  s_add_u32 s40, s40, s41
  s_mov_b32 s42, 0x40000
  s_mov_b32 s44, 1.0
  s_cmp_eq_u32 s32, 0
  s_cselect_b32 s44, 0x3e0293ee, s44
  v_lshlrev_b32 v4, 4, v1
  v_add_u32 v5, 0x400, v4
  v_add_u32 v6, 0x800, v4
  v_add_u32 v7, 0xc00, v4
  s_branch g1c_40
g1a_39:
  s_sub_u32 s34, s31, 48
  s_lshr_b32 s32, s34, 1
  s_mov_b32 s36, s6
  s_mov_b32 s37, s7
  s_mov_b32 s38, 1572864
  s_mov_b32 s33, 3072
  s_lshl_b32 s35, s34, 9
  s_lshl_b32 s40, s28, 7
  s_add_u32 s35, s35, s40
  s_lshl_b32 s40, s32, 21
  s_add_u32 s40, s40, 71303168
  s_and_b32 s41, s34, 1
  s_lshl_b32 s41, s41, 20
  s_add_u32 s40, s40, s41
  s_lshl_b32 s41, s28, 18
  s_add_u32 s40, s40, s41
  s_lshl_b32 s41, s30, 14
  s_add_u32 s40, s40, s41
  s_mov_b32 s42, 0x400
  s_mov_b32 s44, 1.0
  s_cmp_eq_u32 s32, 0
  s_cselect_b32 s44, 0x3eb8aa3b, s44
  v_lshlrev_b32 v4, 16, v3
  v_lshl_add_u32 v4, v2, 5, v4
  v_add_u32 v5, 512, v4
  v_add_u32 v6, 16, v4
  v_add_u32 v7, 528, v4
  s_cmp_lg_u32 s32, 2
  s_cbranch_scc1 g1c_40
  v_lshrrev_b32 v4, 2, v2
  v_lshlrev_b32 v4, 16, v4
  v_lshl_add_u32 v4, v3, 8, v4
  v_and_b32 v5, 3, v2
  v_lshl_add_u32 v4, v5, 4, v4
  v_add_u32 v5, 64, v4
  v_add_u32 v6, 128, v4
  v_add_u32 v7, 192, v4
g1c_40:
  s_mov_b32 s39, 0x20000
  s_mov_b32 s45, s44
  s_add_u32 s46, s26, s40
  s_addc_u32 s47, s27, 0
  s_mov_b32 s48, s4
  s_mov_b32 s49, s5
  s_mov_b32 s50, 2097152
  s_mov_b32 s51, 0x20000
  v_mul_lo_u32 v8, v3, s33
  v_lshlrev_b32 v8, 3, v8
  v_lshl_add_u32 v8, v2, 3, v8
  v_add_u32 v8, s35, v8
  s_lshr_b32 s52, s28, 1
  s_lshl_b32 s52, s52, 14
  s_and_b32 s53, s28, 1
  s_lshl_b32 s53, s53, 9
  s_add_u32 s52, s52, s53
  v_lshlrev_b32 v9, 10, v2
  v_lshl_add_u32 v9, v3, 4, v9
  v_add_u32 v9, s52, v9
  s_lshl_b32 s54, s30, 19
  s_lshl_b32 s55, s28, 13
  v_lshlrev_b32 v10, 4, v1
  s_mov_b32 s56, 0x05040100
  s_mov_b32 s57, 0x07060302
  s_mul_i32 s59, s33, 24
  s_mov_b32 s58, 0
  s_barrier
  s_add_u32 m0, s55, 0
  s_nop 0
  buffer_load_dwordx4 v9, s[48:51], s54 offen offset:0 lds
  s_add_u32 m0, s55, 960
  s_nop 0
  buffer_load_dwordx4 v9, s[48:51], s54 offen offset:64 lds
  s_add_u32 m0, s55, 1920
  s_nop 0
  buffer_load_dwordx4 v9, s[48:51], s54 offen offset:128 lds
  s_add_u32 m0, s55, 2880
  s_nop 0
  buffer_load_dwordx4 v9, s[48:51], s54 offen offset:192 lds
  s_add_u32 m0, s55, 3840
  s_nop 0
  buffer_load_dwordx4 v9, s[48:51], s54 offen offset:256 lds
  s_add_u32 m0, s55, 4800
  s_nop 0
  buffer_load_dwordx4 v9, s[48:51], s54 offen offset:320 lds
  s_add_u32 m0, s55, 5760
  s_nop 0
  buffer_load_dwordx4 v9, s[48:51], s54 offen offset:384 lds
  s_add_u32 m0, s55, 6720
  s_nop 0
  buffer_load_dwordx4 v9, s[48:51], s54 offen offset:448 lds
  s_add_u32 s54, s54, 0x8000
  s_add_u32 s60, s55, 0x8000
  s_add_u32 m0, s60, 0
  s_nop 0
  buffer_load_dwordx4 v9, s[48:51], s54 offen offset:0 lds
  s_add_u32 m0, s60, 960
  s_nop 0
  buffer_load_dwordx4 v9, s[48:51], s54 offen offset:64 lds
  s_add_u32 m0, s60, 1920
  s_nop 0
  buffer_load_dwordx4 v9, s[48:51], s54 offen offset:128 lds
  s_add_u32 m0, s60, 2880
  s_nop 0
  buffer_load_dwordx4 v9, s[48:51], s54 offen offset:192 lds
  s_add_u32 m0, s60, 3840
  s_nop 0
  buffer_load_dwordx4 v9, s[48:51], s54 offen offset:256 lds
  s_add_u32 m0, s60, 4800
  s_nop 0
  buffer_load_dwordx4 v9, s[48:51], s54 offen offset:320 lds
  s_add_u32 m0, s60, 5760
  s_nop 0
  buffer_load_dwordx4 v9, s[48:51], s54 offen offset:384 lds
  s_add_u32 m0, s60, 6720
  s_nop 0
  buffer_load_dwordx4 v9, s[48:51], s54 offen offset:448 lds
  s_add_u32 s54, s54, 0x8000
  buffer_load_dwordx2 v[128:129], v8, s[36:39], s58 offen
  s_add_u32 s58, s58, s33
  buffer_load_dwordx2 v[130:131], v8, s[36:39], s58 offen
  s_add_u32 s58, s58, s33
  buffer_load_dwordx2 v[132:133], v8, s[36:39], s58 offen
  s_add_u32 s58, s58, s33
  buffer_load_dwordx2 v[134:135], v8, s[36:39], s58 offen
  s_add_u32 s58, s58, s33
  buffer_load_dwordx2 v[136:137], v8, s[36:39], s58 offen
  s_add_u32 s58, s58, s33
  buffer_load_dwordx2 v[138:139], v8, s[36:39], s58 offen
  s_add_u32 s58, s58, s33
  buffer_load_dwordx2 v[140:141], v8, s[36:39], s58 offen
  s_add_u32 s58, s58, s33
  buffer_load_dwordx2 v[142:143], v8, s[36:39], s58 offen
  s_add_u32 s58, s58, s33
  s_add_u32 s58, s58, s59
  buffer_load_dwordx2 v[144:145], v8, s[36:39], s58 offen
  s_add_u32 s58, s58, s33
  buffer_load_dwordx2 v[146:147], v8, s[36:39], s58 offen
  s_add_u32 s58, s58, s33
  buffer_load_dwordx2 v[148:149], v8, s[36:39], s58 offen
  s_add_u32 s58, s58, s33
  buffer_load_dwordx2 v[150:151], v8, s[36:39], s58 offen
  s_add_u32 s58, s58, s33
  buffer_load_dwordx2 v[152:153], v8, s[36:39], s58 offen
  s_add_u32 s58, s58, s33
  buffer_load_dwordx2 v[154:155], v8, s[36:39], s58 offen
  s_add_u32 s58, s58, s33
  buffer_load_dwordx2 v[156:157], v8, s[36:39], s58 offen
  s_add_u32 s58, s58, s33
  buffer_load_dwordx2 v[158:159], v8, s[36:39], s58 offen
  s_add_u32 s58, s58, s33
  s_add_u32 s58, s58, s59
  buffer_load_dwordx2 v[160:161], v8, s[36:39], s58 offen
  s_add_u32 s58, s58, s33
  buffer_load_dwordx2 v[162:163], v8, s[36:39], s58 offen
  s_add_u32 s58, s58, s33
  buffer_load_dwordx2 v[164:165], v8, s[36:39], s58 offen
  s_add_u32 s58, s58, s33
  buffer_load_dwordx2 v[166:167], v8, s[36:39], s58 offen
  s_add_u32 s58, s58, s33
  buffer_load_dwordx2 v[168:169], v8, s[36:39], s58 offen
  s_add_u32 s58, s58, s33
  buffer_load_dwordx2 v[170:171], v8, s[36:39], s58 offen
  s_add_u32 s58, s58, s33
  buffer_load_dwordx2 v[172:173], v8, s[36:39], s58 offen
  s_add_u32 s58, s58, s33
  buffer_load_dwordx2 v[174:175], v8, s[36:39], s58 offen
  s_add_u32 s58, s58, s33
  s_add_u32 s58, s58, s59
  buffer_load_dwordx2 v[176:177], v8, s[36:39], s58 offen
  s_add_u32 s58, s58, s33
  buffer_load_dwordx2 v[178:179], v8, s[36:39], s58 offen
  s_add_u32 s58, s58, s33
  buffer_load_dwordx2 v[180:181], v8, s[36:39], s58 offen
  s_add_u32 s58, s58, s33
  buffer_load_dwordx2 v[182:183], v8, s[36:39], s58 offen
  s_add_u32 s58, s58, s33
  buffer_load_dwordx2 v[184:185], v8, s[36:39], s58 offen
  s_add_u32 s58, s58, s33
  buffer_load_dwordx2 v[186:187], v8, s[36:39], s58 offen
  s_add_u32 s58, s58, s33
  buffer_load_dwordx2 v[188:189], v8, s[36:39], s58 offen
  s_add_u32 s58, s58, s33
  buffer_load_dwordx2 v[190:191], v8, s[36:39], s58 offen
  s_add_u32 s58, s58, s33
  s_add_u32 s58, s58, s59
  buffer_load_dwordx2 v[192:193], v8, s[36:39], s58 offen
  s_add_u32 s58, s58, s33
  buffer_load_dwordx2 v[194:195], v8, s[36:39], s58 offen
  s_add_u32 s58, s58, s33
  buffer_load_dwordx2 v[196:197], v8, s[36:39], s58 offen
  s_add_u32 s58, s58, s33
  buffer_load_dwordx2 v[198:199], v8, s[36:39], s58 offen
  s_add_u32 s58, s58, s33
  buffer_load_dwordx2 v[200:201], v8, s[36:39], s58 offen
  s_add_u32 s58, s58, s33
  buffer_load_dwordx2 v[202:203], v8, s[36:39], s58 offen
  s_add_u32 s58, s58, s33
  buffer_load_dwordx2 v[204:205], v8, s[36:39], s58 offen
  s_add_u32 s58, s58, s33
  buffer_load_dwordx2 v[206:207], v8, s[36:39], s58 offen
  s_add_u32 s58, s58, s33
  s_add_u32 s58, s58, s59
  buffer_load_dwordx2 v[208:209], v8, s[36:39], s58 offen
  s_add_u32 s58, s58, s33
  buffer_load_dwordx2 v[210:211], v8, s[36:39], s58 offen
  s_add_u32 s58, s58, s33
  buffer_load_dwordx2 v[212:213], v8, s[36:39], s58 offen
  s_add_u32 s58, s58, s33
  buffer_load_dwordx2 v[214:215], v8, s[36:39], s58 offen
  s_add_u32 s58, s58, s33
  buffer_load_dwordx2 v[216:217], v8, s[36:39], s58 offen
  s_add_u32 s58, s58, s33
  buffer_load_dwordx2 v[218:219], v8, s[36:39], s58 offen
  s_add_u32 s58, s58, s33
  buffer_load_dwordx2 v[220:221], v8, s[36:39], s58 offen
  s_add_u32 s58, s58, s33
  buffer_load_dwordx2 v[222:223], v8, s[36:39], s58 offen
  s_add_u32 s58, s58, s33
  s_add_u32 s58, s58, s59
  buffer_load_dwordx2 v[224:225], v8, s[36:39], s58 offen
  s_add_u32 s58, s58, s33
  buffer_load_dwordx2 v[226:227], v8, s[36:39], s58 offen
  s_add_u32 s58, s58, s33
  buffer_load_dwordx2 v[228:229], v8, s[36:39], s58 offen
  s_add_u32 s58, s58, s33
  buffer_load_dwordx2 v[230:231], v8, s[36:39], s58 offen
  s_add_u32 s58, s58, s33
  buffer_load_dwordx2 v[232:233], v8, s[36:39], s58 offen
  s_add_u32 s58, s58, s33
  buffer_load_dwordx2 v[234:235], v8, s[36:39], s58 offen
  s_add_u32 s58, s58, s33
  buffer_load_dwordx2 v[236:237], v8, s[36:39], s58 offen
  s_add_u32 s58, s58, s33
  buffer_load_dwordx2 v[238:239], v8, s[36:39], s58 offen
  s_add_u32 s58, s58, s33
  s_add_u32 s58, s58, s59
  s_waitcnt vmcnt(48)
  v_perm_b32 v16, v130, v128, s56
  v_perm_b32 v17, v134, v132, s56
  v_perm_b32 v18, v138, v136, s56
  v_perm_b32 v19, v142, v140, s56
  v_perm_b32 v20, v130, v128, s57
  v_perm_b32 v21, v134, v132, s57
  v_perm_b32 v22, v138, v136, s57
  v_perm_b32 v23, v142, v140, s57
  v_perm_b32 v24, v131, v129, s56
  v_perm_b32 v25, v135, v133, s56
  v_perm_b32 v26, v139, v137, s56
  v_perm_b32 v27, v143, v141, s56
  v_perm_b32 v28, v131, v129, s57
  v_perm_b32 v29, v135, v133, s57
  v_perm_b32 v30, v139, v137, s57
  v_perm_b32 v31, v143, v141, s57
  v_accvgpr_write_b32 a0, v16
  v_accvgpr_write_b32 a1, v17
  v_accvgpr_write_b32 a2, v18
  v_accvgpr_write_b32 a3, v19
  v_accvgpr_write_b32 a4, v20
  v_accvgpr_write_b32 a5, v21
  v_accvgpr_write_b32 a6, v22
  v_accvgpr_write_b32 a7, v23
  v_accvgpr_write_b32 a8, v24
  v_accvgpr_write_b32 a9, v25
  v_accvgpr_write_b32 a10, v26
  v_accvgpr_write_b32 a11, v27
  v_accvgpr_write_b32 a12, v28
  v_accvgpr_write_b32 a13, v29
  v_accvgpr_write_b32 a14, v30
  v_accvgpr_write_b32 a15, v31
  buffer_load_dwordx2 v[128:129], v8, s[36:39], s58 offen
  s_add_u32 s58, s58, s33
  buffer_load_dwordx2 v[130:131], v8, s[36:39], s58 offen
  s_add_u32 s58, s58, s33
  buffer_load_dwordx2 v[132:133], v8, s[36:39], s58 offen
  s_add_u32 s58, s58, s33
  buffer_load_dwordx2 v[134:135], v8, s[36:39], s58 offen
  s_add_u32 s58, s58, s33
  buffer_load_dwordx2 v[136:137], v8, s[36:39], s58 offen
  s_add_u32 s58, s58, s33
  buffer_load_dwordx2 v[138:139], v8, s[36:39], s58 offen
  s_add_u32 s58, s58, s33
  buffer_load_dwordx2 v[140:141], v8, s[36:39], s58 offen
  s_add_u32 s58, s58, s33
  buffer_load_dwordx2 v[142:143], v8, s[36:39], s58 offen
  s_add_u32 s58, s58, s33
  s_add_u32 s58, s58, s59
  s_waitcnt vmcnt(48)
  v_perm_b32 v16, v146, v144, s56
  v_perm_b32 v17, v150, v148, s56
  v_perm_b32 v18, v154, v152, s56
  v_perm_b32 v19, v158, v156, s56
  v_perm_b32 v20, v146, v144, s57
  v_perm_b32 v21, v150, v148, s57
  v_perm_b32 v22, v154, v152, s57
  v_perm_b32 v23, v158, v156, s57
  v_perm_b32 v24, v147, v145, s56
  v_perm_b32 v25, v151, v149, s56
  v_perm_b32 v26, v155, v153, s56
  v_perm_b32 v27, v159, v157, s56
  v_perm_b32 v28, v147, v145, s57
  v_perm_b32 v29, v151, v149, s57
  v_perm_b32 v30, v155, v153, s57
  v_perm_b32 v31, v159, v157, s57
  v_accvgpr_write_b32 a16, v16
  v_accvgpr_write_b32 a17, v17
  v_accvgpr_write_b32 a18, v18
  v_accvgpr_write_b32 a19, v19
  v_accvgpr_write_b32 a20, v20
  v_accvgpr_write_b32 a21, v21
  v_accvgpr_write_b32 a22, v22
  v_accvgpr_write_b32 a23, v23
  v_accvgpr_write_b32 a24, v24
  v_accvgpr_write_b32 a25, v25
  v_accvgpr_write_b32 a26, v26
  v_accvgpr_write_b32 a27, v27
  v_accvgpr_write_b32 a28, v28
  v_accvgpr_write_b32 a29, v29
  v_accvgpr_write_b32 a30, v30
  v_accvgpr_write_b32 a31, v31
  buffer_load_dwordx2 v[144:145], v8, s[36:39], s58 offen
  s_add_u32 s58, s58, s33
  buffer_load_dwordx2 v[146:147], v8, s[36:39], s58 offen
  s_add_u32 s58, s58, s33
  buffer_load_dwordx2 v[148:149], v8, s[36:39], s58 offen
  s_add_u32 s58, s58, s33
  buffer_load_dwordx2 v[150:151], v8, s[36:39], s58 offen
  s_add_u32 s58, s58, s33
  buffer_load_dwordx2 v[152:153], v8, s[36:39], s58 offen
  s_add_u32 s58, s58, s33
  buffer_load_dwordx2 v[154:155], v8, s[36:39], s58 offen
  s_add_u32 s58, s58, s33
  buffer_load_dwordx2 v[156:157], v8, s[36:39], s58 offen
  s_add_u32 s58, s58, s33
  buffer_load_dwordx2 v[158:159], v8, s[36:39], s58 offen
  s_add_u32 s58, s58, s33
  s_add_u32 s58, s58, s59
  s_waitcnt vmcnt(48)
  v_perm_b32 v16, v162, v160, s56
  v_perm_b32 v17, v166, v164, s56
  v_perm_b32 v18, v170, v168, s56
  v_perm_b32 v19, v174, v172, s56
  v_perm_b32 v20, v162, v160, s57
  v_perm_b32 v21, v166, v164, s57
  v_perm_b32 v22, v170, v168, s57
  v_perm_b32 v23, v174, v172, s57
  v_perm_b32 v24, v163, v161, s56
  v_perm_b32 v25, v167, v165, s56
  v_perm_b32 v26, v171, v169, s56
  v_perm_b32 v27, v175, v173, s56
  v_perm_b32 v28, v163, v161, s57
  v_perm_b32 v29, v167, v165, s57
  v_perm_b32 v30, v171, v169, s57
  v_perm_b32 v31, v175, v173, s57
  v_accvgpr_write_b32 a32, v16
  v_accvgpr_write_b32 a33, v17
  v_accvgpr_write_b32 a34, v18
  v_accvgpr_write_b32 a35, v19
  v_accvgpr_write_b32 a36, v20
  v_accvgpr_write_b32 a37, v21
  v_accvgpr_write_b32 a38, v22
  v_accvgpr_write_b32 a39, v23
  v_accvgpr_write_b32 a40, v24
  v_accvgpr_write_b32 a41, v25
  v_accvgpr_write_b32 a42, v26
  v_accvgpr_write_b32 a43, v27
  v_accvgpr_write_b32 a44, v28
  v_accvgpr_write_b32 a45, v29
  v_accvgpr_write_b32 a46, v30
  v_accvgpr_write_b32 a47, v31
  buffer_load_dwordx2 v[160:161], v8, s[36:39], s58 offen
  s_add_u32 s58, s58, s33
  buffer_load_dwordx2 v[162:163], v8, s[36:39], s58 offen
  s_add_u32 s58, s58, s33
  buffer_load_dwordx2 v[164:165], v8, s[36:39], s58 offen
  s_add_u32 s58, s58, s33
  buffer_load_dwordx2 v[166:167], v8, s[36:39], s58 offen
  s_add_u32 s58, s58, s33
  buffer_load_dwordx2 v[168:169], v8, s[36:39], s58 offen
  s_add_u32 s58, s58, s33
  buffer_load_dwordx2 v[170:171], v8, s[36:39], s58 offen
  s_add_u32 s58, s58, s33
  buffer_load_dwordx2 v[172:173], v8, s[36:39], s58 offen
  s_add_u32 s58, s58, s33
  buffer_load_dwordx2 v[174:175], v8, s[36:39], s58 offen
  s_add_u32 s58, s58, s33
  s_add_u32 s58, s58, s59
  s_waitcnt vmcnt(48)
  v_perm_b32 v16, v178, v176, s56
  v_perm_b32 v17, v182, v180, s56
  v_perm_b32 v18, v186, v184, s56
  v_perm_b32 v19, v190, v188, s56
  v_perm_b32 v20, v178, v176, s57
  v_perm_b32 v21, v182, v180, s57
  v_perm_b32 v22, v186, v184, s57
  v_perm_b32 v23, v190, v188, s57
  v_perm_b32 v24, v179, v177, s56
  v_perm_b32 v25, v183, v181, s56
  v_perm_b32 v26, v187, v185, s56
  v_perm_b32 v27, v191, v189, s56
  v_perm_b32 v28, v179, v177, s57
  v_perm_b32 v29, v183, v181, s57
  v_perm_b32 v30, v187, v185, s57
  v_perm_b32 v31, v191, v189, s57
  v_accvgpr_write_b32 a48, v16
  v_accvgpr_write_b32 a49, v17
  v_accvgpr_write_b32 a50, v18
  v_accvgpr_write_b32 a51, v19
  v_accvgpr_write_b32 a52, v20
  v_accvgpr_write_b32 a53, v21
  v_accvgpr_write_b32 a54, v22
  v_accvgpr_write_b32 a55, v23
  v_accvgpr_write_b32 a56, v24
  v_accvgpr_write_b32 a57, v25
  v_accvgpr_write_b32 a58, v26
  v_accvgpr_write_b32 a59, v27
  v_accvgpr_write_b32 a60, v28
  v_accvgpr_write_b32 a61, v29
  v_accvgpr_write_b32 a62, v30
  v_accvgpr_write_b32 a63, v31
  buffer_load_dwordx2 v[176:177], v8, s[36:39], s58 offen
  s_add_u32 s58, s58, s33
  buffer_load_dwordx2 v[178:179], v8, s[36:39], s58 offen
  s_add_u32 s58, s58, s33
  buffer_load_dwordx2 v[180:181], v8, s[36:39], s58 offen
  s_add_u32 s58, s58, s33
  buffer_load_dwordx2 v[182:183], v8, s[36:39], s58 offen
  s_add_u32 s58, s58, s33
  buffer_load_dwordx2 v[184:185], v8, s[36:39], s58 offen
  s_add_u32 s58, s58, s33
  buffer_load_dwordx2 v[186:187], v8, s[36:39], s58 offen
  s_add_u32 s58, s58, s33
  buffer_load_dwordx2 v[188:189], v8, s[36:39], s58 offen
  s_add_u32 s58, s58, s33
  buffer_load_dwordx2 v[190:191], v8, s[36:39], s58 offen
  s_add_u32 s58, s58, s33
  s_add_u32 s58, s58, s59
  s_waitcnt vmcnt(48)
  v_perm_b32 v16, v194, v192, s56
  v_perm_b32 v17, v198, v196, s56
  v_perm_b32 v18, v202, v200, s56
  v_perm_b32 v19, v206, v204, s56
  v_perm_b32 v20, v194, v192, s57
  v_perm_b32 v21, v198, v196, s57
  v_perm_b32 v22, v202, v200, s57
  v_perm_b32 v23, v206, v204, s57
  v_perm_b32 v24, v195, v193, s56
  v_perm_b32 v25, v199, v197, s56
  v_perm_b32 v26, v203, v201, s56
  v_perm_b32 v27, v207, v205, s56
  v_perm_b32 v28, v195, v193, s57
  v_perm_b32 v29, v199, v197, s57
  v_perm_b32 v30, v203, v201, s57
  v_perm_b32 v31, v207, v205, s57
  v_accvgpr_write_b32 a64, v16
  v_accvgpr_write_b32 a65, v17
  v_accvgpr_write_b32 a66, v18
  v_accvgpr_write_b32 a67, v19
  v_accvgpr_write_b32 a68, v20
  v_accvgpr_write_b32 a69, v21
  v_accvgpr_write_b32 a70, v22
  v_accvgpr_write_b32 a71, v23
  v_accvgpr_write_b32 a72, v24
  v_accvgpr_write_b32 a73, v25
  v_accvgpr_write_b32 a74, v26
  v_accvgpr_write_b32 a75, v27
  v_accvgpr_write_b32 a76, v28
  v_accvgpr_write_b32 a77, v29
  v_accvgpr_write_b32 a78, v30
  v_accvgpr_write_b32 a79, v31
  buffer_load_dwordx2 v[192:193], v8, s[36:39], s58 offen
  s_add_u32 s58, s58, s33
  buffer_load_dwordx2 v[194:195], v8, s[36:39], s58 offen
  s_add_u32 s58, s58, s33
  buffer_load_dwordx2 v[196:197], v8, s[36:39], s58 offen
  s_add_u32 s58, s58, s33
  buffer_load_dwordx2 v[198:199], v8, s[36:39], s58 offen
  s_add_u32 s58, s58, s33
  buffer_load_dwordx2 v[200:201], v8, s[36:39], s58 offen
  s_add_u32 s58, s58, s33
  buffer_load_dwordx2 v[202:203], v8, s[36:39], s58 offen
  s_add_u32 s58, s58, s33
  buffer_load_dwordx2 v[204:205], v8, s[36:39], s58 offen
  s_add_u32 s58, s58, s33
  buffer_load_dwordx2 v[206:207], v8, s[36:39], s58 offen
  s_add_u32 s58, s58, s33
  s_add_u32 s58, s58, s59
  s_waitcnt vmcnt(48)
  v_perm_b32 v16, v210, v208, s56
  v_perm_b32 v17, v214, v212, s56
  v_perm_b32 v18, v218, v216, s56
  v_perm_b32 v19, v222, v220, s56
  v_perm_b32 v20, v210, v208, s57
  v_perm_b32 v21, v214, v212, s57
  v_perm_b32 v22, v218, v216, s57
  v_perm_b32 v23, v222, v220, s57
  v_perm_b32 v24, v211, v209, s56
  v_perm_b32 v25, v215, v213, s56
  v_perm_b32 v26, v219, v217, s56
  v_perm_b32 v27, v223, v221, s56
  v_perm_b32 v28, v211, v209, s57
  v_perm_b32 v29, v215, v213, s57
  v_perm_b32 v30, v219, v217, s57
  v_perm_b32 v31, v223, v221, s57
  v_accvgpr_write_b32 a80, v16
  v_accvgpr_write_b32 a81, v17
  v_accvgpr_write_b32 a82, v18
  v_accvgpr_write_b32 a83, v19
  v_accvgpr_write_b32 a84, v20
  v_accvgpr_write_b32 a85, v21
  v_accvgpr_write_b32 a86, v22
  v_accvgpr_write_b32 a87, v23
  v_accvgpr_write_b32 a88, v24
  v_accvgpr_write_b32 a89, v25
  v_accvgpr_write_b32 a90, v26
  v_accvgpr_write_b32 a91, v27
  v_accvgpr_write_b32 a92, v28
  v_accvgpr_write_b32 a93, v29
  v_accvgpr_write_b32 a94, v30
  v_accvgpr_write_b32 a95, v31
  buffer_load_dwordx2 v[208:209], v8, s[36:39], s58 offen
  s_add_u32 s58, s58, s33
  buffer_load_dwordx2 v[210:211], v8, s[36:39], s58 offen
  s_add_u32 s58, s58, s33
  buffer_load_dwordx2 v[212:213], v8, s[36:39], s58 offen
  s_add_u32 s58, s58, s33
  buffer_load_dwordx2 v[214:215], v8, s[36:39], s58 offen
  s_add_u32 s58, s58, s33
  buffer_load_dwordx2 v[216:217], v8, s[36:39], s58 offen
  s_add_u32 s58, s58, s33
  buffer_load_dwordx2 v[218:219], v8, s[36:39], s58 offen
  s_add_u32 s58, s58, s33
  buffer_load_dwordx2 v[220:221], v8, s[36:39], s58 offen
  s_add_u32 s58, s58, s33
  buffer_load_dwordx2 v[222:223], v8, s[36:39], s58 offen
  s_add_u32 s58, s58, s33
  s_add_u32 s58, s58, s59
  s_waitcnt vmcnt(48)
  v_perm_b32 v16, v226, v224, s56
  v_perm_b32 v17, v230, v228, s56
  v_perm_b32 v18, v234, v232, s56
  v_perm_b32 v19, v238, v236, s56
  v_perm_b32 v20, v226, v224, s57
  v_perm_b32 v21, v230, v228, s57
  v_perm_b32 v22, v234, v232, s57
  v_perm_b32 v23, v238, v236, s57
  v_perm_b32 v24, v227, v225, s56
  v_perm_b32 v25, v231, v229, s56
  v_perm_b32 v26, v235, v233, s56
  v_perm_b32 v27, v239, v237, s56
  v_perm_b32 v28, v227, v225, s57
  v_perm_b32 v29, v231, v229, s57
  v_perm_b32 v30, v235, v233, s57
  v_perm_b32 v31, v239, v237, s57
  v_accvgpr_write_b32 a96, v16
  v_accvgpr_write_b32 a97, v17
  v_accvgpr_write_b32 a98, v18
  v_accvgpr_write_b32 a99, v19
  v_accvgpr_write_b32 a100, v20
  v_accvgpr_write_b32 a101, v21
  v_accvgpr_write_b32 a102, v22
  v_accvgpr_write_b32 a103, v23
  v_accvgpr_write_b32 a104, v24
  v_accvgpr_write_b32 a105, v25
  v_accvgpr_write_b32 a106, v26
  v_accvgpr_write_b32 a107, v27
  v_accvgpr_write_b32 a108, v28
  v_accvgpr_write_b32 a109, v29
  v_accvgpr_write_b32 a110, v30
  v_accvgpr_write_b32 a111, v31
  buffer_load_dwordx2 v[224:225], v8, s[36:39], s58 offen
  s_add_u32 s58, s58, s33
  buffer_load_dwordx2 v[226:227], v8, s[36:39], s58 offen
  s_add_u32 s58, s58, s33
  buffer_load_dwordx2 v[228:229], v8, s[36:39], s58 offen
  s_add_u32 s58, s58, s33
  buffer_load_dwordx2 v[230:231], v8, s[36:39], s58 offen
  s_add_u32 s58, s58, s33
  buffer_load_dwordx2 v[232:233], v8, s[36:39], s58 offen
  s_add_u32 s58, s58, s33
  buffer_load_dwordx2 v[234:235], v8, s[36:39], s58 offen
  s_add_u32 s58, s58, s33
  buffer_load_dwordx2 v[236:237], v8, s[36:39], s58 offen
  s_add_u32 s58, s58, s33
  buffer_load_dwordx2 v[238:239], v8, s[36:39], s58 offen
  s_add_u32 s58, s58, s33
  s_add_u32 s58, s58, s59
  s_waitcnt vmcnt(48)
  v_perm_b32 v16, v130, v128, s56
  v_perm_b32 v17, v134, v132, s56
  v_perm_b32 v18, v138, v136, s56
  v_perm_b32 v19, v142, v140, s56
  v_perm_b32 v20, v130, v128, s57
  v_perm_b32 v21, v134, v132, s57
  v_perm_b32 v22, v138, v136, s57
  v_perm_b32 v23, v142, v140, s57
  v_perm_b32 v24, v131, v129, s56
  v_perm_b32 v25, v135, v133, s56
  v_perm_b32 v26, v139, v137, s56
  v_perm_b32 v27, v143, v141, s56
  v_perm_b32 v28, v131, v129, s57
  v_perm_b32 v29, v135, v133, s57
  v_perm_b32 v30, v139, v137, s57
  v_perm_b32 v31, v143, v141, s57
  v_accvgpr_write_b32 a112, v16
  v_accvgpr_write_b32 a113, v17
  v_accvgpr_write_b32 a114, v18
  v_accvgpr_write_b32 a115, v19
  v_accvgpr_write_b32 a116, v20
  v_accvgpr_write_b32 a117, v21
  v_accvgpr_write_b32 a118, v22
  v_accvgpr_write_b32 a119, v23
  v_accvgpr_write_b32 a120, v24
  v_accvgpr_write_b32 a121, v25
  v_accvgpr_write_b32 a122, v26
  v_accvgpr_write_b32 a123, v27
  v_accvgpr_write_b32 a124, v28
  v_accvgpr_write_b32 a125, v29
  v_accvgpr_write_b32 a126, v30
  v_accvgpr_write_b32 a127, v31
  buffer_load_dwordx2 v[128:129], v8, s[36:39], s58 offen
  s_add_u32 s58, s58, s33
  buffer_load_dwordx2 v[130:131], v8, s[36:39], s58 offen
  s_add_u32 s58, s58, s33
  buffer_load_dwordx2 v[132:133], v8, s[36:39], s58 offen
  s_add_u32 s58, s58, s33
  buffer_load_dwordx2 v[134:135], v8, s[36:39], s58 offen
  s_add_u32 s58, s58, s33
  buffer_load_dwordx2 v[136:137], v8, s[36:39], s58 offen
  s_add_u32 s58, s58, s33
  buffer_load_dwordx2 v[138:139], v8, s[36:39], s58 offen
  s_add_u32 s58, s58, s33
  buffer_load_dwordx2 v[140:141], v8, s[36:39], s58 offen
  s_add_u32 s58, s58, s33
  buffer_load_dwordx2 v[142:143], v8, s[36:39], s58 offen
  s_add_u32 s58, s58, s33
  s_add_u32 s58, s58, s59
  s_waitcnt vmcnt(48)
  v_perm_b32 v16, v146, v144, s56
  v_perm_b32 v17, v150, v148, s56
  v_perm_b32 v18, v154, v152, s56
  v_perm_b32 v19, v158, v156, s56
  v_perm_b32 v20, v146, v144, s57
  v_perm_b32 v21, v150, v148, s57
  v_perm_b32 v22, v154, v152, s57
  v_perm_b32 v23, v158, v156, s57
  v_perm_b32 v24, v147, v145, s56
  v_perm_b32 v25, v151, v149, s56
  v_perm_b32 v26, v155, v153, s56
  v_perm_b32 v27, v159, v157, s56
  v_perm_b32 v28, v147, v145, s57
  v_perm_b32 v29, v151, v149, s57
  v_perm_b32 v30, v155, v153, s57
  v_perm_b32 v31, v159, v157, s57
  v_accvgpr_write_b32 a128, v16
  v_accvgpr_write_b32 a129, v17
  v_accvgpr_write_b32 a130, v18
  v_accvgpr_write_b32 a131, v19
  v_accvgpr_write_b32 a132, v20
  v_accvgpr_write_b32 a133, v21
  v_accvgpr_write_b32 a134, v22
  v_accvgpr_write_b32 a135, v23
  v_accvgpr_write_b32 a136, v24
  v_accvgpr_write_b32 a137, v25
  v_accvgpr_write_b32 a138, v26
  v_accvgpr_write_b32 a139, v27
  v_accvgpr_write_b32 a140, v28
  v_accvgpr_write_b32 a141, v29
  v_accvgpr_write_b32 a142, v30
  v_accvgpr_write_b32 a143, v31
  buffer_load_dwordx2 v[144:145], v8, s[36:39], s58 offen
  s_add_u32 s58, s58, s33
  buffer_load_dwordx2 v[146:147], v8, s[36:39], s58 offen
  s_add_u32 s58, s58, s33
  buffer_load_dwordx2 v[148:149], v8, s[36:39], s58 offen
  s_add_u32 s58, s58, s33
  buffer_load_dwordx2 v[150:151], v8, s[36:39], s58 offen
  s_add_u32 s58, s58, s33
  buffer_load_dwordx2 v[152:153], v8, s[36:39], s58 offen
  s_add_u32 s58, s58, s33
  buffer_load_dwordx2 v[154:155], v8, s[36:39], s58 offen
  s_add_u32 s58, s58, s33
  buffer_load_dwordx2 v[156:157], v8, s[36:39], s58 offen
  s_add_u32 s58, s58, s33
  buffer_load_dwordx2 v[158:159], v8, s[36:39], s58 offen
  s_add_u32 s58, s58, s33
  s_add_u32 s58, s58, s59
  v_mov_b32 v13, 0
  global_load_dword v14, v13, s[24:25] offset:192 sc1
  s_waitcnt vmcnt(48)
  v_perm_b32 v16, v162, v160, s56
  v_perm_b32 v17, v166, v164, s56
  v_perm_b32 v18, v170, v168, s56
  v_perm_b32 v19, v174, v172, s56
  v_perm_b32 v20, v162, v160, s57
  v_perm_b32 v21, v166, v164, s57
  v_perm_b32 v22, v170, v168, s57
  v_perm_b32 v23, v174, v172, s57
  v_perm_b32 v24, v163, v161, s56
  v_perm_b32 v25, v167, v165, s56
  v_perm_b32 v26, v171, v169, s56
  v_perm_b32 v27, v175, v173, s56
  v_perm_b32 v28, v163, v161, s57
  v_perm_b32 v29, v167, v165, s57
  v_perm_b32 v30, v171, v169, s57
  v_perm_b32 v31, v175, v173, s57
  v_accvgpr_write_b32 a144, v16
  v_accvgpr_write_b32 a145, v17
  v_accvgpr_write_b32 a146, v18
  v_accvgpr_write_b32 a147, v19
  v_accvgpr_write_b32 a148, v20
  v_accvgpr_write_b32 a149, v21
  v_accvgpr_write_b32 a150, v22
  v_accvgpr_write_b32 a151, v23
  v_accvgpr_write_b32 a152, v24
  v_accvgpr_write_b32 a153, v25
  v_accvgpr_write_b32 a154, v26
  v_accvgpr_write_b32 a155, v27
  v_accvgpr_write_b32 a156, v28
  v_accvgpr_write_b32 a157, v29
  v_accvgpr_write_b32 a158, v30
  v_accvgpr_write_b32 a159, v31
  s_waitcnt vmcnt(40)
  v_perm_b32 v16, v178, v176, s56
  v_perm_b32 v17, v182, v180, s56
  v_perm_b32 v18, v186, v184, s56
  v_perm_b32 v19, v190, v188, s56
  v_perm_b32 v20, v178, v176, s57
  v_perm_b32 v21, v182, v180, s57
  v_perm_b32 v22, v186, v184, s57
  v_perm_b32 v23, v190, v188, s57
  v_perm_b32 v24, v179, v177, s56
  v_perm_b32 v25, v183, v181, s56
  v_perm_b32 v26, v187, v185, s56
  v_perm_b32 v27, v191, v189, s56
  v_perm_b32 v28, v179, v177, s57
  v_perm_b32 v29, v183, v181, s57
  v_perm_b32 v30, v187, v185, s57
  v_perm_b32 v31, v191, v189, s57
  v_accvgpr_write_b32 a160, v16
  v_accvgpr_write_b32 a161, v17
  v_accvgpr_write_b32 a162, v18
  v_accvgpr_write_b32 a163, v19
  v_accvgpr_write_b32 a164, v20
  v_accvgpr_write_b32 a165, v21
  v_accvgpr_write_b32 a166, v22
  v_accvgpr_write_b32 a167, v23
  v_accvgpr_write_b32 a168, v24
  v_accvgpr_write_b32 a169, v25
  v_accvgpr_write_b32 a170, v26
  v_accvgpr_write_b32 a171, v27
  v_accvgpr_write_b32 a172, v28
  v_accvgpr_write_b32 a173, v29
  v_accvgpr_write_b32 a174, v30
  v_accvgpr_write_b32 a175, v31
  s_waitcnt vmcnt(32)
  v_perm_b32 v16, v194, v192, s56
  v_perm_b32 v17, v198, v196, s56
  v_perm_b32 v18, v202, v200, s56
  v_perm_b32 v19, v206, v204, s56
  v_perm_b32 v20, v194, v192, s57
  v_perm_b32 v21, v198, v196, s57
  v_perm_b32 v22, v202, v200, s57
  v_perm_b32 v23, v206, v204, s57
  v_perm_b32 v24, v195, v193, s56
  v_perm_b32 v25, v199, v197, s56
  v_perm_b32 v26, v203, v201, s56
  v_perm_b32 v27, v207, v205, s56
  v_perm_b32 v28, v195, v193, s57
  v_perm_b32 v29, v199, v197, s57
  v_perm_b32 v30, v203, v201, s57
  v_perm_b32 v31, v207, v205, s57
  v_accvgpr_write_b32 a176, v16
  v_accvgpr_write_b32 a177, v17
  v_accvgpr_write_b32 a178, v18
  v_accvgpr_write_b32 a179, v19
  v_accvgpr_write_b32 a180, v20
  v_accvgpr_write_b32 a181, v21
  v_accvgpr_write_b32 a182, v22
  v_accvgpr_write_b32 a183, v23
  v_accvgpr_write_b32 a184, v24
  v_accvgpr_write_b32 a185, v25
  v_accvgpr_write_b32 a186, v26
  v_accvgpr_write_b32 a187, v27
  v_accvgpr_write_b32 a188, v28
  v_accvgpr_write_b32 a189, v29
  v_accvgpr_write_b32 a190, v30
  v_accvgpr_write_b32 a191, v31
  s_waitcnt vmcnt(24)
  v_perm_b32 v16, v210, v208, s56
  v_perm_b32 v17, v214, v212, s56
  v_perm_b32 v18, v218, v216, s56
  v_perm_b32 v19, v222, v220, s56
  v_perm_b32 v20, v210, v208, s57
  v_perm_b32 v21, v214, v212, s57
  v_perm_b32 v22, v218, v216, s57
  v_perm_b32 v23, v222, v220, s57
  v_perm_b32 v24, v211, v209, s56
  v_perm_b32 v25, v215, v213, s56
  v_perm_b32 v26, v219, v217, s56
  v_perm_b32 v27, v223, v221, s56
  v_perm_b32 v28, v211, v209, s57
  v_perm_b32 v29, v215, v213, s57
  v_perm_b32 v30, v219, v217, s57
  v_perm_b32 v31, v223, v221, s57
  v_accvgpr_write_b32 a192, v16
  v_accvgpr_write_b32 a193, v17
  v_accvgpr_write_b32 a194, v18
  v_accvgpr_write_b32 a195, v19
  v_accvgpr_write_b32 a196, v20
  v_accvgpr_write_b32 a197, v21
  v_accvgpr_write_b32 a198, v22
  v_accvgpr_write_b32 a199, v23
  v_accvgpr_write_b32 a200, v24
  v_accvgpr_write_b32 a201, v25
  v_accvgpr_write_b32 a202, v26
  v_accvgpr_write_b32 a203, v27
  v_accvgpr_write_b32 a204, v28
  v_accvgpr_write_b32 a205, v29
  v_accvgpr_write_b32 a206, v30
  v_accvgpr_write_b32 a207, v31
  s_waitcnt vmcnt(16)
  v_perm_b32 v16, v226, v224, s56
  v_perm_b32 v17, v230, v228, s56
  v_perm_b32 v18, v234, v232, s56
  v_perm_b32 v19, v238, v236, s56
  v_perm_b32 v20, v226, v224, s57
  v_perm_b32 v21, v230, v228, s57
  v_perm_b32 v22, v234, v232, s57
  v_perm_b32 v23, v238, v236, s57
  v_perm_b32 v24, v227, v225, s56
  v_perm_b32 v25, v231, v229, s56
  v_perm_b32 v26, v235, v233, s56
  v_perm_b32 v27, v239, v237, s56
  v_perm_b32 v28, v227, v225, s57
  v_perm_b32 v29, v231, v229, s57
  v_perm_b32 v30, v235, v233, s57
  v_perm_b32 v31, v239, v237, s57
  v_accvgpr_write_b32 a208, v16
  v_accvgpr_write_b32 a209, v17
  v_accvgpr_write_b32 a210, v18
  v_accvgpr_write_b32 a211, v19
  v_accvgpr_write_b32 a212, v20
  v_accvgpr_write_b32 a213, v21
  v_accvgpr_write_b32 a214, v22
  v_accvgpr_write_b32 a215, v23
  v_accvgpr_write_b32 a216, v24
  v_accvgpr_write_b32 a217, v25
  v_accvgpr_write_b32 a218, v26
  v_accvgpr_write_b32 a219, v27
  v_accvgpr_write_b32 a220, v28
  v_accvgpr_write_b32 a221, v29
  v_accvgpr_write_b32 a222, v30
  v_accvgpr_write_b32 a223, v31
  s_waitcnt vmcnt(8)
  v_perm_b32 v16, v130, v128, s56
  v_perm_b32 v17, v134, v132, s56
  v_perm_b32 v18, v138, v136, s56
  v_perm_b32 v19, v142, v140, s56
  v_perm_b32 v20, v130, v128, s57
  v_perm_b32 v21, v134, v132, s57
  v_perm_b32 v22, v138, v136, s57
  v_perm_b32 v23, v142, v140, s57
  v_perm_b32 v24, v131, v129, s56
  v_perm_b32 v25, v135, v133, s56
  v_perm_b32 v26, v139, v137, s56
  v_perm_b32 v27, v143, v141, s56
  v_perm_b32 v28, v131, v129, s57
  v_perm_b32 v29, v135, v133, s57
  v_perm_b32 v30, v139, v137, s57
  v_perm_b32 v31, v143, v141, s57
  v_accvgpr_write_b32 a224, v16
  v_accvgpr_write_b32 a225, v17
  v_accvgpr_write_b32 a226, v18
  v_accvgpr_write_b32 a227, v19
  v_accvgpr_write_b32 a228, v20
  v_accvgpr_write_b32 a229, v21
  v_accvgpr_write_b32 a230, v22
  v_accvgpr_write_b32 a231, v23
  v_accvgpr_write_b32 a232, v24
  v_accvgpr_write_b32 a233, v25
  v_accvgpr_write_b32 a234, v26
  v_accvgpr_write_b32 a235, v27
  v_accvgpr_write_b32 a236, v28
  v_accvgpr_write_b32 a237, v29
  v_accvgpr_write_b32 a238, v30
  v_accvgpr_write_b32 a239, v31
  s_waitcnt vmcnt(0)
  v_perm_b32 v16, v146, v144, s56
  v_perm_b32 v17, v150, v148, s56
  v_perm_b32 v18, v154, v152, s56
  v_perm_b32 v19, v158, v156, s56
  v_perm_b32 v20, v146, v144, s57
  v_perm_b32 v21, v150, v148, s57
  v_perm_b32 v22, v154, v152, s57
  v_perm_b32 v23, v158, v156, s57
  v_perm_b32 v24, v147, v145, s56
  v_perm_b32 v25, v151, v149, s56
  v_perm_b32 v26, v155, v153, s56
  v_perm_b32 v27, v159, v157, s56
  v_perm_b32 v28, v147, v145, s57
  v_perm_b32 v29, v151, v149, s57
  v_perm_b32 v30, v155, v153, s57
  v_perm_b32 v31, v159, v157, s57
  v_accvgpr_write_b32 a240, v16
  v_accvgpr_write_b32 a241, v17
  v_accvgpr_write_b32 a242, v18
  v_accvgpr_write_b32 a243, v19
  v_accvgpr_write_b32 a244, v20
  v_accvgpr_write_b32 a245, v21
  v_accvgpr_write_b32 a246, v22
  v_accvgpr_write_b32 a247, v23
  v_accvgpr_write_b32 a248, v24
  v_accvgpr_write_b32 a249, v25
  v_accvgpr_write_b32 a250, v26
  v_accvgpr_write_b32 a251, v27
  v_accvgpr_write_b32 a252, v28
  v_accvgpr_write_b32 a253, v29
  v_accvgpr_write_b32 a254, v30
  v_accvgpr_write_b32 a255, v31
  s_waitcnt vmcnt(0)
  v_readfirstlane_b32 s62, v14
  s_cmp_lg_u32 s62, 0
  s_cbranch_scc1 g1r_41
  s_mov_b32 s60, 0
sp_42:
  global_load_dword v14, v13, s[24:25] offset:192 sc1
  s_add_u32 s60, s60, 1
  s_waitcnt vmcnt(0)
  v_readfirstlane_b32 s62, v14
  s_cmp_lg_u32 s62, 0
  s_cbranch_scc1 sp_43
  s_cmp_ge_u32 s60, 400000
  s_cbranch_scc1 k_end
  s_sleep 2
  s_branch sp_42
sp_43:
g1r_41:
  s_lshl_b32 s62, s30, 11
  s_and_b32 s63, s31, 15
  s_lshl_b32 s63, s63, 7
  s_add_u32 s62, s62, s63
  s_lshl_b32 s63, s28, 5
  s_add_u32 s62, s62, s63
  s_sub_u32 s63, s31, 16
  s_cmp_ge_u32 s63, 32
  s_cselect_b32 s63, 8, s63
  s_cselect_b32 s58, 8, 16
  s_and_b32 s63, s63, s58
  s_add_u32 s62, s62, s63
  s_add_u32 s62, s62, 89128960
  v_mov_b32 v13, s62
  s_lshl_b32 s62, s30, 4
  s_sub_u32 s62, s62, 1
  s_mov_b32 s61, 0
  s_mov_b32 s43, 0
  v_mov_b32 v11, v10
  s_barrier
  s_cmp_eq_u32 s32, 2
  s_cbranch_scc1 g1v_44
  ds_read_b128 v[128:131], v11 offset:0
  ds_read_b128 v[132:135], v11 offset:16384
  ds_read_b128 v[136:139], v11 offset:1024
  ds_read_b128 v[140:143], v11 offset:17408
  ds_read_b128 v[144:147], v11 offset:2048
  ds_read_b128 v[148:151], v11 offset:18432
g1l_45:
  s_waitcnt lgkmcnt(4)
  v_mfma_f32_16x16x32_bf16 v[64:67], a[0:3], v[128:131], 0
  ds_read_b128 v[152:155], v11 offset:3072
  v_mfma_f32_16x16x32_bf16 v[68:71], a[4:7], v[128:131], 0
  ds_read_b128 v[156:159], v11 offset:19456
  v_mfma_f32_16x16x32_bf16 v[72:75], a[8:11], v[128:131], 0
  v_mfma_f32_16x16x32_bf16 v[76:79], a[12:15], v[128:131], 0
  v_mfma_f32_16x16x32_bf16 v[80:83], a[0:3], v[132:135], 0
  v_mfma_f32_16x16x32_bf16 v[84:87], a[4:7], v[132:135], 0
  v_mfma_f32_16x16x32_bf16 v[88:91], a[8:11], v[132:135], 0
  v_mfma_f32_16x16x32_bf16 v[92:95], a[12:15], v[132:135], 0
  s_waitcnt lgkmcnt(4)
  v_mfma_f32_16x16x32_bf16 v[64:67], a[16:19], v[136:139], v[64:67]
  ds_read_b128 v[128:131], v11 offset:4096
  v_mfma_f32_16x16x32_bf16 v[68:71], a[20:23], v[136:139], v[68:71]
  ds_read_b128 v[132:135], v11 offset:20480
  v_mfma_f32_16x16x32_bf16 v[72:75], a[24:27], v[136:139], v[72:75]
  v_pk_mul_f32 v[96:97], v[96:97], s[44:45]
  v_mfma_f32_16x16x32_bf16 v[76:79], a[28:31], v[136:139], v[76:79]
  v_pk_mul_f32 v[98:99], v[98:99], s[44:45]
  v_mfma_f32_16x16x32_bf16 v[80:83], a[16:19], v[140:143], v[80:83]
  v_pk_mul_f32 v[100:101], v[100:101], s[44:45]
  v_mfma_f32_16x16x32_bf16 v[84:87], a[20:23], v[140:143], v[84:87]
  v_pk_mul_f32 v[102:103], v[102:103], s[44:45]
  v_mfma_f32_16x16x32_bf16 v[88:91], a[24:27], v[140:143], v[88:91]
  v_pk_mul_f32 v[104:105], v[104:105], s[44:45]
  v_mfma_f32_16x16x32_bf16 v[92:95], a[28:31], v[140:143], v[92:95]
  v_pk_mul_f32 v[106:107], v[106:107], s[44:45]
  s_waitcnt lgkmcnt(4)
  v_mfma_f32_16x16x32_bf16 v[64:67], a[32:35], v[144:147], v[64:67]
  ds_read_b128 v[136:139], v11 offset:5120
  v_mfma_f32_16x16x32_bf16 v[68:71], a[36:39], v[144:147], v[68:71]
  ds_read_b128 v[140:143], v11 offset:21504
  v_mfma_f32_16x16x32_bf16 v[72:75], a[40:43], v[144:147], v[72:75]
  v_pk_mul_f32 v[108:109], v[108:109], s[44:45]
  v_mfma_f32_16x16x32_bf16 v[76:79], a[44:47], v[144:147], v[76:79]
  v_pk_mul_f32 v[110:111], v[110:111], s[44:45]
  v_mfma_f32_16x16x32_bf16 v[80:83], a[32:35], v[148:151], v[80:83]
  v_pk_mul_f32 v[112:113], v[112:113], s[44:45]
  v_mfma_f32_16x16x32_bf16 v[84:87], a[36:39], v[148:151], v[84:87]
  v_pk_mul_f32 v[114:115], v[114:115], s[44:45]
  v_mfma_f32_16x16x32_bf16 v[88:91], a[40:43], v[148:151], v[88:91]
  v_pk_mul_f32 v[116:117], v[116:117], s[44:45]
  v_mfma_f32_16x16x32_bf16 v[92:95], a[44:47], v[148:151], v[92:95]
  v_pk_mul_f32 v[118:119], v[118:119], s[44:45]
  s_waitcnt lgkmcnt(4)
  v_mfma_f32_16x16x32_bf16 v[64:67], a[48:51], v[152:155], v[64:67]
  ds_read_b128 v[144:147], v11 offset:6144
  v_mfma_f32_16x16x32_bf16 v[68:71], a[52:55], v[152:155], v[68:71]
  ds_read_b128 v[148:151], v11 offset:22528
  v_mfma_f32_16x16x32_bf16 v[72:75], a[56:59], v[152:155], v[72:75]
  v_pk_mul_f32 v[120:121], v[120:121], s[44:45]
  v_mfma_f32_16x16x32_bf16 v[76:79], a[60:63], v[152:155], v[76:79]
  v_pk_mul_f32 v[122:123], v[122:123], s[44:45]
  v_mfma_f32_16x16x32_bf16 v[80:83], a[48:51], v[156:159], v[80:83]
  v_pk_mul_f32 v[124:125], v[124:125], s[44:45]
  v_mfma_f32_16x16x32_bf16 v[84:87], a[52:55], v[156:159], v[84:87]
  v_pk_mul_f32 v[126:127], v[126:127], s[44:45]
  v_mfma_f32_16x16x32_bf16 v[88:91], a[56:59], v[156:159], v[88:91]
  v_cvt_pk_bf16_f32 v160, v96, v100
  v_mfma_f32_16x16x32_bf16 v[92:95], a[60:63], v[156:159], v[92:95]
  v_cvt_pk_bf16_f32 v161, v104, v108
  s_waitcnt lgkmcnt(4)
  v_mfma_f32_16x16x32_bf16 v[64:67], a[64:67], v[128:131], v[64:67]
  ds_read_b128 v[152:155], v11 offset:7168
  v_mfma_f32_16x16x32_bf16 v[68:71], a[68:71], v[128:131], v[68:71]
  ds_read_b128 v[156:159], v11 offset:23552
  v_mfma_f32_16x16x32_bf16 v[72:75], a[72:75], v[128:131], v[72:75]
  v_cvt_pk_bf16_f32 v162, v97, v101
  v_mfma_f32_16x16x32_bf16 v[76:79], a[76:79], v[128:131], v[76:79]
  v_cvt_pk_bf16_f32 v163, v105, v109
  v_mfma_f32_16x16x32_bf16 v[80:83], a[64:67], v[132:135], v[80:83]
  global_store_dwordx4 v4, v[160:163], s[46:47] sc1
  v_mfma_f32_16x16x32_bf16 v[84:87], a[68:71], v[132:135], v[84:87]
  v_cvt_pk_bf16_f32 v164, v112, v116
  v_mfma_f32_16x16x32_bf16 v[88:91], a[72:75], v[132:135], v[88:91]
  v_cvt_pk_bf16_f32 v165, v120, v124
  v_mfma_f32_16x16x32_bf16 v[92:95], a[76:79], v[132:135], v[92:95]
  v_cvt_pk_bf16_f32 v166, v113, v117
  s_waitcnt lgkmcnt(4)
  v_mfma_f32_16x16x32_bf16 v[64:67], a[80:83], v[136:139], v[64:67]
  ds_read_b128 v[128:131], v11 offset:8192
  v_mfma_f32_16x16x32_bf16 v[68:71], a[84:87], v[136:139], v[68:71]
  ds_read_b128 v[132:135], v11 offset:24576
  v_mfma_f32_16x16x32_bf16 v[72:75], a[88:91], v[136:139], v[72:75]
  v_cvt_pk_bf16_f32 v167, v121, v125
  v_mfma_f32_16x16x32_bf16 v[76:79], a[92:95], v[136:139], v[76:79]
  global_store_dwordx4 v5, v[164:167], s[46:47] sc1
  v_mfma_f32_16x16x32_bf16 v[80:83], a[80:83], v[140:143], v[80:83]
  v_cvt_pk_bf16_f32 v168, v98, v102
  v_mfma_f32_16x16x32_bf16 v[84:87], a[84:87], v[140:143], v[84:87]
  v_cvt_pk_bf16_f32 v169, v106, v110
  v_mfma_f32_16x16x32_bf16 v[88:91], a[88:91], v[140:143], v[88:91]
  v_cvt_pk_bf16_f32 v170, v99, v103
  v_mfma_f32_16x16x32_bf16 v[92:95], a[92:95], v[140:143], v[92:95]
  v_cvt_pk_bf16_f32 v171, v107, v111
  s_waitcnt lgkmcnt(4)
  v_mfma_f32_16x16x32_bf16 v[64:67], a[96:99], v[144:147], v[64:67]
  ds_read_b128 v[136:139], v11 offset:9216
  v_mfma_f32_16x16x32_bf16 v[68:71], a[100:103], v[144:147], v[68:71]
  ds_read_b128 v[140:143], v11 offset:25600
  v_mfma_f32_16x16x32_bf16 v[72:75], a[104:107], v[144:147], v[72:75]
  global_store_dwordx4 v6, v[168:171], s[46:47] sc1
  v_mfma_f32_16x16x32_bf16 v[76:79], a[108:111], v[144:147], v[76:79]
  v_cvt_pk_bf16_f32 v172, v114, v118
  v_mfma_f32_16x16x32_bf16 v[80:83], a[96:99], v[148:151], v[80:83]
  v_cvt_pk_bf16_f32 v173, v122, v126
  v_mfma_f32_16x16x32_bf16 v[84:87], a[100:103], v[148:151], v[84:87]
  v_cvt_pk_bf16_f32 v174, v115, v119
  v_mfma_f32_16x16x32_bf16 v[88:91], a[104:107], v[148:151], v[88:91]
  v_cvt_pk_bf16_f32 v175, v123, v127
  v_mfma_f32_16x16x32_bf16 v[92:95], a[108:111], v[148:151], v[92:95]
  global_store_dwordx4 v7, v[172:175], s[46:47] sc1
  s_waitcnt lgkmcnt(4)
  v_mfma_f32_16x16x32_bf16 v[64:67], a[112:115], v[152:155], v[64:67]
  ds_read_b128 v[144:147], v11 offset:10240
  v_mfma_f32_16x16x32_bf16 v[68:71], a[116:119], v[152:155], v[68:71]
  ds_read_b128 v[148:151], v11 offset:26624
  v_mfma_f32_16x16x32_bf16 v[72:75], a[120:123], v[152:155], v[72:75]
  s_add_u32 s46, s46, s43
  s_addc_u32 s47, s47, 0
  v_mfma_f32_16x16x32_bf16 v[76:79], a[124:127], v[152:155], v[76:79]
  s_mov_b32 s43, s42
  v_mfma_f32_16x16x32_bf16 v[80:83], a[112:115], v[156:159], v[80:83]
  v_mfma_f32_16x16x32_bf16 v[84:87], a[116:119], v[156:159], v[84:87]
  v_mfma_f32_16x16x32_bf16 v[88:91], a[120:123], v[156:159], v[88:91]
  v_mfma_f32_16x16x32_bf16 v[92:95], a[124:127], v[156:159], v[92:95]
  s_waitcnt lgkmcnt(4)
  v_mfma_f32_16x16x32_bf16 v[64:67], a[128:131], v[128:131], v[64:67]
  ds_read_b128 v[152:155], v11 offset:11264
  v_mfma_f32_16x16x32_bf16 v[68:71], a[132:135], v[128:131], v[68:71]
  ds_read_b128 v[156:159], v11 offset:27648
  v_mfma_f32_16x16x32_bf16 v[72:75], a[136:139], v[128:131], v[72:75]
  v_mfma_f32_16x16x32_bf16 v[76:79], a[140:143], v[128:131], v[76:79]
  v_mfma_f32_16x16x32_bf16 v[80:83], a[128:131], v[132:135], v[80:83]
  v_mfma_f32_16x16x32_bf16 v[84:87], a[132:135], v[132:135], v[84:87]
  v_mfma_f32_16x16x32_bf16 v[88:91], a[136:139], v[132:135], v[88:91]
  v_mfma_f32_16x16x32_bf16 v[92:95], a[140:143], v[132:135], v[92:95]
  s_waitcnt lgkmcnt(4)
  v_mfma_f32_16x16x32_bf16 v[64:67], a[144:147], v[136:139], v[64:67]
  ds_read_b128 v[128:131], v11 offset:12288
  v_mfma_f32_16x16x32_bf16 v[68:71], a[148:151], v[136:139], v[68:71]
  ds_read_b128 v[132:135], v11 offset:28672
  v_mfma_f32_16x16x32_bf16 v[72:75], a[152:155], v[136:139], v[72:75]
  v_mfma_f32_16x16x32_bf16 v[76:79], a[156:159], v[136:139], v[76:79]
  v_mfma_f32_16x16x32_bf16 v[80:83], a[144:147], v[140:143], v[80:83]
  v_mfma_f32_16x16x32_bf16 v[84:87], a[148:151], v[140:143], v[84:87]
  v_mfma_f32_16x16x32_bf16 v[88:91], a[152:155], v[140:143], v[88:91]
  v_mfma_f32_16x16x32_bf16 v[92:95], a[156:159], v[140:143], v[92:95]
  s_waitcnt lgkmcnt(4)
  v_mfma_f32_16x16x32_bf16 v[64:67], a[160:163], v[144:147], v[64:67]
  ds_read_b128 v[136:139], v11 offset:13312
  v_mfma_f32_16x16x32_bf16 v[68:71], a[164:167], v[144:147], v[68:71]
  ds_read_b128 v[140:143], v11 offset:29696
  v_mfma_f32_16x16x32_bf16 v[72:75], a[168:171], v[144:147], v[72:75]
  v_mfma_f32_16x16x32_bf16 v[76:79], a[172:175], v[144:147], v[76:79]
  v_mfma_f32_16x16x32_bf16 v[80:83], a[160:163], v[148:151], v[80:83]
  v_mfma_f32_16x16x32_bf16 v[84:87], a[164:167], v[148:151], v[84:87]
  v_mfma_f32_16x16x32_bf16 v[88:91], a[168:171], v[148:151], v[88:91]
  v_mfma_f32_16x16x32_bf16 v[92:95], a[172:175], v[148:151], v[92:95]
  s_waitcnt lgkmcnt(4)
  v_mfma_f32_16x16x32_bf16 v[64:67], a[176:179], v[152:155], v[64:67]
  ds_read_b128 v[144:147], v11 offset:14336
  v_mfma_f32_16x16x32_bf16 v[68:71], a[180:183], v[152:155], v[68:71]
  ds_read_b128 v[148:151], v11 offset:30720
  v_mfma_f32_16x16x32_bf16 v[72:75], a[184:187], v[152:155], v[72:75]
  s_add_u32 s61, s61, 1
  s_lshl_b32 s63, s61, 15
  s_and_b32 s63, s63, 0x18000
  v_mfma_f32_16x16x32_bf16 v[76:79], a[188:191], v[152:155], v[76:79]
  v_add_u32 v12, s63, v10
  v_mfma_f32_16x16x32_bf16 v[80:83], a[176:179], v[156:159], v[80:83]
  s_add_u32 s63, s61, 1
  s_lshl_b32 s63, s63, 15
  s_and_b32 s63, s63, 0x18000
  s_add_u32 s63, s63, s55
  v_mfma_f32_16x16x32_bf16 v[84:87], a[180:183], v[156:159], v[84:87]
  v_mfma_f32_16x16x32_bf16 v[88:91], a[184:187], v[156:159], v[88:91]
  v_mfma_f32_16x16x32_bf16 v[92:95], a[188:191], v[156:159], v[92:95]
  s_waitcnt lgkmcnt(4)
  v_mfma_f32_16x16x32_bf16 v[64:67], a[192:195], v[128:131], v[64:67]
  ds_read_b128 v[152:155], v11 offset:15360
  v_mfma_f32_16x16x32_bf16 v[68:71], a[196:199], v[128:131], v[68:71]
  ds_read_b128 v[156:159], v11 offset:31744
  s_waitcnt vmcnt(4)
  s_barrier
  s_cmp_ge_u32 s61, 15
  s_cselect_b32 s50, 0, s50
  v_mfma_f32_16x16x32_bf16 v[72:75], a[200:203], v[128:131], v[72:75]
  s_mov_b32 m0, s63
  v_mfma_f32_16x16x32_bf16 v[76:79], a[204:207], v[128:131], v[76:79]
  buffer_load_dwordx4 v9, s[48:51], s54 offen offset:0 lds
  s_add_u32 m0, s63, 960
  v_mfma_f32_16x16x32_bf16 v[80:83], a[192:195], v[132:135], v[80:83]
  buffer_load_dwordx4 v9, s[48:51], s54 offen offset:64 lds
  s_add_u32 m0, s63, 1920
  v_mfma_f32_16x16x32_bf16 v[84:87], a[196:199], v[132:135], v[84:87]
  buffer_load_dwordx4 v9, s[48:51], s54 offen offset:128 lds
  s_add_u32 m0, s63, 2880
  v_mfma_f32_16x16x32_bf16 v[88:91], a[200:203], v[132:135], v[88:91]
  buffer_load_dwordx4 v9, s[48:51], s54 offen offset:192 lds
  s_add_u32 m0, s63, 3840
  v_mfma_f32_16x16x32_bf16 v[92:95], a[204:207], v[132:135], v[92:95]
  buffer_load_dwordx4 v9, s[48:51], s54 offen offset:256 lds
  s_add_u32 m0, s63, 4800
  s_waitcnt lgkmcnt(4)
  v_mfma_f32_16x16x32_bf16 v[64:67], a[208:211], v[136:139], v[64:67]
  ds_read_b128 v[128:131], v12 offset:0
  v_mfma_f32_16x16x32_bf16 v[68:71], a[212:215], v[136:139], v[68:71]
  ds_read_b128 v[132:135], v12 offset:16384
  v_mfma_f32_16x16x32_bf16 v[72:75], a[216:219], v[136:139], v[72:75]
  buffer_load_dwordx4 v9, s[48:51], s54 offen offset:320 lds
  s_add_u32 m0, s63, 5760
  v_mfma_f32_16x16x32_bf16 v[76:79], a[220:223], v[136:139], v[76:79]
  buffer_load_dwordx4 v9, s[48:51], s54 offen offset:384 lds
  s_add_u32 m0, s63, 6720
  v_mfma_f32_16x16x32_bf16 v[80:83], a[208:211], v[140:143], v[80:83]
  buffer_load_dwordx4 v9, s[48:51], s54 offen offset:448 lds
  s_add_u32 s54, s54, 0x8000
  v_mfma_f32_16x16x32_bf16 v[84:87], a[212:215], v[140:143], v[84:87]
  v_mfma_f32_16x16x32_bf16 v[88:91], a[216:219], v[140:143], v[88:91]
  v_mfma_f32_16x16x32_bf16 v[92:95], a[220:223], v[140:143], v[92:95]
  s_waitcnt lgkmcnt(4)
  v_mfma_f32_16x16x32_bf16 v[64:67], a[224:227], v[144:147], v[64:67]
  ds_read_b128 v[136:139], v12 offset:1024
  v_mfma_f32_16x16x32_bf16 v[68:71], a[228:231], v[144:147], v[68:71]
  ds_read_b128 v[140:143], v12 offset:17408
  v_mfma_f32_16x16x32_bf16 v[72:75], a[232:235], v[144:147], v[72:75]
  v_mfma_f32_16x16x32_bf16 v[76:79], a[236:239], v[144:147], v[76:79]
  v_mfma_f32_16x16x32_bf16 v[80:83], a[224:227], v[148:151], v[80:83]
  v_mfma_f32_16x16x32_bf16 v[84:87], a[228:231], v[148:151], v[84:87]
  v_mfma_f32_16x16x32_bf16 v[88:91], a[232:235], v[148:151], v[88:91]
  v_mfma_f32_16x16x32_bf16 v[92:95], a[236:239], v[148:151], v[92:95]
  s_waitcnt lgkmcnt(4)
  v_mfma_f32_16x16x32_bf16 v[64:67], a[240:243], v[152:155], v[64:67]
  ds_read_b128 v[144:147], v12 offset:2048
  v_mfma_f32_16x16x32_bf16 v[68:71], a[244:247], v[152:155], v[68:71]
  ds_read_b128 v[148:151], v12 offset:18432
  v_mfma_f32_16x16x32_bf16 v[72:75], a[248:251], v[152:155], v[72:75]
  v_mov_b32 v11, v12
  v_mfma_f32_16x16x32_bf16 v[76:79], a[252:255], v[152:155], v[76:79]
  s_add_u32 s63, s62, s61
  v_mfma_f32_16x16x32_bf16 v[80:83], a[240:243], v[156:159], v[80:83]
  v_mov_b32 v14, s63
  v_mfma_f32_16x16x32_bf16 v[84:87], a[244:247], v[156:159], v[84:87]
  s_waitcnt vmcnt(8)
  global_store_dword v13, v14, s[26:27] sc1
  v_mfma_f32_16x16x32_bf16 v[88:91], a[248:251], v[156:159], v[88:91]
  v_mfma_f32_16x16x32_bf16 v[92:95], a[252:255], v[156:159], v[92:95]
  s_waitcnt lgkmcnt(4)
  v_mfma_f32_16x16x32_bf16 v[96:99], a[0:3], v[128:131], 0
  ds_read_b128 v[152:155], v11 offset:3072
  v_mfma_f32_16x16x32_bf16 v[100:103], a[4:7], v[128:131], 0
  ds_read_b128 v[156:159], v11 offset:19456
  v_mfma_f32_16x16x32_bf16 v[104:107], a[8:11], v[128:131], 0
  v_mfma_f32_16x16x32_bf16 v[108:111], a[12:15], v[128:131], 0
  v_mfma_f32_16x16x32_bf16 v[112:115], a[0:3], v[132:135], 0
  v_mfma_f32_16x16x32_bf16 v[116:119], a[4:7], v[132:135], 0
  v_mfma_f32_16x16x32_bf16 v[120:123], a[8:11], v[132:135], 0
  v_mfma_f32_16x16x32_bf16 v[124:127], a[12:15], v[132:135], 0
  s_waitcnt lgkmcnt(4)
  v_mfma_f32_16x16x32_bf16 v[96:99], a[16:19], v[136:139], v[96:99]
  ds_read_b128 v[128:131], v11 offset:4096
  v_mfma_f32_16x16x32_bf16 v[100:103], a[20:23], v[136:139], v[100:103]
  ds_read_b128 v[132:135], v11 offset:20480
  v_mfma_f32_16x16x32_bf16 v[104:107], a[24:27], v[136:139], v[104:107]
  v_pk_mul_f32 v[64:65], v[64:65], s[44:45]
  v_mfma_f32_16x16x32_bf16 v[108:111], a[28:31], v[136:139], v[108:111]
  v_pk_mul_f32 v[66:67], v[66:67], s[44:45]
  v_mfma_f32_16x16x32_bf16 v[112:115], a[16:19], v[140:143], v[112:115]
  v_pk_mul_f32 v[68:69], v[68:69], s[44:45]
  v_mfma_f32_16x16x32_bf16 v[116:119], a[20:23], v[140:143], v[116:119]
  v_pk_mul_f32 v[70:71], v[70:71], s[44:45]
  v_mfma_f32_16x16x32_bf16 v[120:123], a[24:27], v[140:143], v[120:123]
  v_pk_mul_f32 v[72:73], v[72:73], s[44:45]
  v_mfma_f32_16x16x32_bf16 v[124:127], a[28:31], v[140:143], v[124:127]
  v_pk_mul_f32 v[74:75], v[74:75], s[44:45]
  s_waitcnt lgkmcnt(4)
  v_mfma_f32_16x16x32_bf16 v[96:99], a[32:35], v[144:147], v[96:99]
  ds_read_b128 v[136:139], v11 offset:5120
  v_mfma_f32_16x16x32_bf16 v[100:103], a[36:39], v[144:147], v[100:103]
  ds_read_b128 v[140:143], v11 offset:21504
  v_mfma_f32_16x16x32_bf16 v[104:107], a[40:43], v[144:147], v[104:107]
  v_pk_mul_f32 v[76:77], v[76:77], s[44:45]
  v_mfma_f32_16x16x32_bf16 v[108:111], a[44:47], v[144:147], v[108:111]
  v_pk_mul_f32 v[78:79], v[78:79], s[44:45]
  v_mfma_f32_16x16x32_bf16 v[112:115], a[32:35], v[148:151], v[112:115]
  v_pk_mul_f32 v[80:81], v[80:81], s[44:45]
  v_mfma_f32_16x16x32_bf16 v[116:119], a[36:39], v[148:151], v[116:119]
  v_pk_mul_f32 v[82:83], v[82:83], s[44:45]
  v_mfma_f32_16x16x32_bf16 v[120:123], a[40:43], v[148:151], v[120:123]
  v_pk_mul_f32 v[84:85], v[84:85], s[44:45]
  v_mfma_f32_16x16x32_bf16 v[124:127], a[44:47], v[148:151], v[124:127]
  v_pk_mul_f32 v[86:87], v[86:87], s[44:45]
  s_waitcnt lgkmcnt(4)
  v_mfma_f32_16x16x32_bf16 v[96:99], a[48:51], v[152:155], v[96:99]
  ds_read_b128 v[144:147], v11 offset:6144
  v_mfma_f32_16x16x32_bf16 v[100:103], a[52:55], v[152:155], v[100:103]
  ds_read_b128 v[148:151], v11 offset:22528
  v_mfma_f32_16x16x32_bf16 v[104:107], a[56:59], v[152:155], v[104:107]
  v_pk_mul_f32 v[88:89], v[88:89], s[44:45]
  v_mfma_f32_16x16x32_bf16 v[108:111], a[60:63], v[152:155], v[108:111]
  v_pk_mul_f32 v[90:91], v[90:91], s[44:45]
  v_mfma_f32_16x16x32_bf16 v[112:115], a[48:51], v[156:159], v[112:115]
  v_pk_mul_f32 v[92:93], v[92:93], s[44:45]
  v_mfma_f32_16x16x32_bf16 v[116:119], a[52:55], v[156:159], v[116:119]
  v_pk_mul_f32 v[94:95], v[94:95], s[44:45]
  v_mfma_f32_16x16x32_bf16 v[120:123], a[56:59], v[156:159], v[120:123]
  v_cvt_pk_bf16_f32 v160, v64, v68
  v_mfma_f32_16x16x32_bf16 v[124:127], a[60:63], v[156:159], v[124:127]
  v_cvt_pk_bf16_f32 v161, v72, v76
  s_waitcnt lgkmcnt(4)
  v_mfma_f32_16x16x32_bf16 v[96:99], a[64:67], v[128:131], v[96:99]
  ds_read_b128 v[152:155], v11 offset:7168
  v_mfma_f32_16x16x32_bf16 v[100:103], a[68:71], v[128:131], v[100:103]
  ds_read_b128 v[156:159], v11 offset:23552
  v_mfma_f32_16x16x32_bf16 v[104:107], a[72:75], v[128:131], v[104:107]
  v_cvt_pk_bf16_f32 v162, v65, v69
  v_mfma_f32_16x16x32_bf16 v[108:111], a[76:79], v[128:131], v[108:111]
  v_cvt_pk_bf16_f32 v163, v73, v77
  v_mfma_f32_16x16x32_bf16 v[112:115], a[64:67], v[132:135], v[112:115]
  global_store_dwordx4 v4, v[160:163], s[46:47] sc1
  v_mfma_f32_16x16x32_bf16 v[116:119], a[68:71], v[132:135], v[116:119]
  v_cvt_pk_bf16_f32 v164, v80, v84
  v_mfma_f32_16x16x32_bf16 v[120:123], a[72:75], v[132:135], v[120:123]
  v_cvt_pk_bf16_f32 v165, v88, v92
  v_mfma_f32_16x16x32_bf16 v[124:127], a[76:79], v[132:135], v[124:127]
  v_cvt_pk_bf16_f32 v166, v81, v85
  s_waitcnt lgkmcnt(4)
  v_mfma_f32_16x16x32_bf16 v[96:99], a[80:83], v[136:139], v[96:99]
  ds_read_b128 v[128:131], v11 offset:8192
  v_mfma_f32_16x16x32_bf16 v[100:103], a[84:87], v[136:139], v[100:103]
  ds_read_b128 v[132:135], v11 offset:24576
  v_mfma_f32_16x16x32_bf16 v[104:107], a[88:91], v[136:139], v[104:107]
  v_cvt_pk_bf16_f32 v167, v89, v93
  v_mfma_f32_16x16x32_bf16 v[108:111], a[92:95], v[136:139], v[108:111]
  global_store_dwordx4 v5, v[164:167], s[46:47] sc1
  v_mfma_f32_16x16x32_bf16 v[112:115], a[80:83], v[140:143], v[112:115]
  v_cvt_pk_bf16_f32 v168, v66, v70
  v_mfma_f32_16x16x32_bf16 v[116:119], a[84:87], v[140:143], v[116:119]
  v_cvt_pk_bf16_f32 v169, v74, v78
  v_mfma_f32_16x16x32_bf16 v[120:123], a[88:91], v[140:143], v[120:123]
  v_cvt_pk_bf16_f32 v170, v67, v71
  v_mfma_f32_16x16x32_bf16 v[124:127], a[92:95], v[140:143], v[124:127]
  v_cvt_pk_bf16_f32 v171, v75, v79
  s_waitcnt lgkmcnt(4)
  v_mfma_f32_16x16x32_bf16 v[96:99], a[96:99], v[144:147], v[96:99]
  ds_read_b128 v[136:139], v11 offset:9216
  v_mfma_f32_16x16x32_bf16 v[100:103], a[100:103], v[144:147], v[100:103]
  ds_read_b128 v[140:143], v11 offset:25600
  v_mfma_f32_16x16x32_bf16 v[104:107], a[104:107], v[144:147], v[104:107]
  global_store_dwordx4 v6, v[168:171], s[46:47] sc1
  v_mfma_f32_16x16x32_bf16 v[108:111], a[108:111], v[144:147], v[108:111]
  v_cvt_pk_bf16_f32 v172, v82, v86
  v_mfma_f32_16x16x32_bf16 v[112:115], a[96:99], v[148:151], v[112:115]
  v_cvt_pk_bf16_f32 v173, v90, v94
  v_mfma_f32_16x16x32_bf16 v[116:119], a[100:103], v[148:151], v[116:119]
  v_cvt_pk_bf16_f32 v174, v83, v87
  v_mfma_f32_16x16x32_bf16 v[120:123], a[104:107], v[148:151], v[120:123]
  v_cvt_pk_bf16_f32 v175, v91, v95
  v_mfma_f32_16x16x32_bf16 v[124:127], a[108:111], v[148:151], v[124:127]
  global_store_dwordx4 v7, v[172:175], s[46:47] sc1
  s_waitcnt lgkmcnt(4)
  v_mfma_f32_16x16x32_bf16 v[96:99], a[112:115], v[152:155], v[96:99]
  ds_read_b128 v[144:147], v11 offset:10240
  v_mfma_f32_16x16x32_bf16 v[100:103], a[116:119], v[152:155], v[100:103]
  ds_read_b128 v[148:151], v11 offset:26624
  v_mfma_f32_16x16x32_bf16 v[104:107], a[120:123], v[152:155], v[104:107]
  s_add_u32 s46, s46, s43
  s_addc_u32 s47, s47, 0
  v_mfma_f32_16x16x32_bf16 v[108:111], a[124:127], v[152:155], v[108:111]
  s_mov_b32 s43, s42
  v_mfma_f32_16x16x32_bf16 v[112:115], a[112:115], v[156:159], v[112:115]
  v_mfma_f32_16x16x32_bf16 v[116:119], a[116:119], v[156:159], v[116:119]
  v_mfma_f32_16x16x32_bf16 v[120:123], a[120:123], v[156:159], v[120:123]
  v_mfma_f32_16x16x32_bf16 v[124:127], a[124:127], v[156:159], v[124:127]
  s_waitcnt lgkmcnt(4)
  v_mfma_f32_16x16x32_bf16 v[96:99], a[128:131], v[128:131], v[96:99]
  ds_read_b128 v[152:155], v11 offset:11264
  v_mfma_f32_16x16x32_bf16 v[100:103], a[132:135], v[128:131], v[100:103]
  ds_read_b128 v[156:159], v11 offset:27648
  v_mfma_f32_16x16x32_bf16 v[104:107], a[136:139], v[128:131], v[104:107]
  v_mfma_f32_16x16x32_bf16 v[108:111], a[140:143], v[128:131], v[108:111]
  v_mfma_f32_16x16x32_bf16 v[112:115], a[128:131], v[132:135], v[112:115]
  v_mfma_f32_16x16x32_bf16 v[116:119], a[132:135], v[132:135], v[116:119]
  v_mfma_f32_16x16x32_bf16 v[120:123], a[136:139], v[132:135], v[120:123]
  v_mfma_f32_16x16x32_bf16 v[124:127], a[140:143], v[132:135], v[124:127]
  s_waitcnt lgkmcnt(4)
  v_mfma_f32_16x16x32_bf16 v[96:99], a[144:147], v[136:139], v[96:99]
  ds_read_b128 v[128:131], v11 offset:12288
  v_mfma_f32_16x16x32_bf16 v[100:103], a[148:151], v[136:139], v[100:103]
  ds_read_b128 v[132:135], v11 offset:28672
  v_mfma_f32_16x16x32_bf16 v[104:107], a[152:155], v[136:139], v[104:107]
  v_mfma_f32_16x16x32_bf16 v[108:111], a[156:159], v[136:139], v[108:111]
  v_mfma_f32_16x16x32_bf16 v[112:115], a[144:147], v[140:143], v[112:115]
  v_mfma_f32_16x16x32_bf16 v[116:119], a[148:151], v[140:143], v[116:119]
  v_mfma_f32_16x16x32_bf16 v[120:123], a[152:155], v[140:143], v[120:123]
  v_mfma_f32_16x16x32_bf16 v[124:127], a[156:159], v[140:143], v[124:127]
  s_waitcnt lgkmcnt(4)
  v_mfma_f32_16x16x32_bf16 v[96:99], a[160:163], v[144:147], v[96:99]
  ds_read_b128 v[136:139], v11 offset:13312
  v_mfma_f32_16x16x32_bf16 v[100:103], a[164:167], v[144:147], v[100:103]
  ds_read_b128 v[140:143], v11 offset:29696
  v_mfma_f32_16x16x32_bf16 v[104:107], a[168:171], v[144:147], v[104:107]
  v_mfma_f32_16x16x32_bf16 v[108:111], a[172:175], v[144:147], v[108:111]
  v_mfma_f32_16x16x32_bf16 v[112:115], a[160:163], v[148:151], v[112:115]
  v_mfma_f32_16x16x32_bf16 v[116:119], a[164:167], v[148:151], v[116:119]
  v_mfma_f32_16x16x32_bf16 v[120:123], a[168:171], v[148:151], v[120:123]
  v_mfma_f32_16x16x32_bf16 v[124:127], a[172:175], v[148:151], v[124:127]
  s_waitcnt lgkmcnt(4)
  v_mfma_f32_16x16x32_bf16 v[96:99], a[176:179], v[152:155], v[96:99]
  ds_read_b128 v[144:147], v11 offset:14336
  v_mfma_f32_16x16x32_bf16 v[100:103], a[180:183], v[152:155], v[100:103]
  ds_read_b128 v[148:151], v11 offset:30720
  v_mfma_f32_16x16x32_bf16 v[104:107], a[184:187], v[152:155], v[104:107]
  s_add_u32 s61, s61, 1
  s_lshl_b32 s63, s61, 15
  s_and_b32 s63, s63, 0x18000
  v_mfma_f32_16x16x32_bf16 v[108:111], a[188:191], v[152:155], v[108:111]
  v_add_u32 v12, s63, v10
  v_mfma_f32_16x16x32_bf16 v[112:115], a[176:179], v[156:159], v[112:115]
  s_add_u32 s63, s61, 1
  s_lshl_b32 s63, s63, 15
  s_and_b32 s63, s63, 0x18000
  s_add_u32 s63, s63, s55
  v_mfma_f32_16x16x32_bf16 v[116:119], a[180:183], v[156:159], v[116:119]
  v_mfma_f32_16x16x32_bf16 v[120:123], a[184:187], v[156:159], v[120:123]
  v_mfma_f32_16x16x32_bf16 v[124:127], a[188:191], v[156:159], v[124:127]
  s_waitcnt lgkmcnt(4)
  v_mfma_f32_16x16x32_bf16 v[96:99], a[192:195], v[128:131], v[96:99]
  ds_read_b128 v[152:155], v11 offset:15360
  v_mfma_f32_16x16x32_bf16 v[100:103], a[196:199], v[128:131], v[100:103]
  ds_read_b128 v[156:159], v11 offset:31744
  s_waitcnt vmcnt(4)
  s_barrier
  s_cmp_ge_u32 s61, 15
  s_cselect_b32 s50, 0, s50
  v_mfma_f32_16x16x32_bf16 v[104:107], a[200:203], v[128:131], v[104:107]
  s_mov_b32 m0, s63
  v_mfma_f32_16x16x32_bf16 v[108:111], a[204:207], v[128:131], v[108:111]
  buffer_load_dwordx4 v9, s[48:51], s54 offen offset:0 lds
  s_add_u32 m0, s63, 960
  v_mfma_f32_16x16x32_bf16 v[112:115], a[192:195], v[132:135], v[112:115]
  buffer_load_dwordx4 v9, s[48:51], s54 offen offset:64 lds
  s_add_u32 m0, s63, 1920
  v_mfma_f32_16x16x32_bf16 v[116:119], a[196:199], v[132:135], v[116:119]
  buffer_load_dwordx4 v9, s[48:51], s54 offen offset:128 lds
  s_add_u32 m0, s63, 2880
  v_mfma_f32_16x16x32_bf16 v[120:123], a[200:203], v[132:135], v[120:123]
  buffer_load_dwordx4 v9, s[48:51], s54 offen offset:192 lds
  s_add_u32 m0, s63, 3840
  v_mfma_f32_16x16x32_bf16 v[124:127], a[204:207], v[132:135], v[124:127]
  buffer_load_dwordx4 v9, s[48:51], s54 offen offset:256 lds
  s_add_u32 m0, s63, 4800
  s_waitcnt lgkmcnt(4)
  v_mfma_f32_16x16x32_bf16 v[96:99], a[208:211], v[136:139], v[96:99]
  ds_read_b128 v[128:131], v12 offset:0
  v_mfma_f32_16x16x32_bf16 v[100:103], a[212:215], v[136:139], v[100:103]
  ds_read_b128 v[132:135], v12 offset:16384
  v_mfma_f32_16x16x32_bf16 v[104:107], a[216:219], v[136:139], v[104:107]
  buffer_load_dwordx4 v9, s[48:51], s54 offen offset:320 lds
  s_add_u32 m0, s63, 5760
  v_mfma_f32_16x16x32_bf16 v[108:111], a[220:223], v[136:139], v[108:111]
  buffer_load_dwordx4 v9, s[48:51], s54 offen offset:384 lds
  s_add_u32 m0, s63, 6720
  v_mfma_f32_16x16x32_bf16 v[112:115], a[208:211], v[140:143], v[112:115]
  buffer_load_dwordx4 v9, s[48:51], s54 offen offset:448 lds
  s_add_u32 s54, s54, 0x8000
  v_mfma_f32_16x16x32_bf16 v[116:119], a[212:215], v[140:143], v[116:119]
  v_mfma_f32_16x16x32_bf16 v[120:123], a[216:219], v[140:143], v[120:123]
  v_mfma_f32_16x16x32_bf16 v[124:127], a[220:223], v[140:143], v[124:127]
  s_waitcnt lgkmcnt(4)
  v_mfma_f32_16x16x32_bf16 v[96:99], a[224:227], v[144:147], v[96:99]
  ds_read_b128 v[136:139], v12 offset:1024
  v_mfma_f32_16x16x32_bf16 v[100:103], a[228:231], v[144:147], v[100:103]
  ds_read_b128 v[140:143], v12 offset:17408
  v_mfma_f32_16x16x32_bf16 v[104:107], a[232:235], v[144:147], v[104:107]
  v_mfma_f32_16x16x32_bf16 v[108:111], a[236:239], v[144:147], v[108:111]
  v_mfma_f32_16x16x32_bf16 v[112:115], a[224:227], v[148:151], v[112:115]
  v_mfma_f32_16x16x32_bf16 v[116:119], a[228:231], v[148:151], v[116:119]
  v_mfma_f32_16x16x32_bf16 v[120:123], a[232:235], v[148:151], v[120:123]
  v_mfma_f32_16x16x32_bf16 v[124:127], a[236:239], v[148:151], v[124:127]
  s_waitcnt lgkmcnt(4)
  v_mfma_f32_16x16x32_bf16 v[96:99], a[240:243], v[152:155], v[96:99]
  ds_read_b128 v[144:147], v12 offset:2048
  v_mfma_f32_16x16x32_bf16 v[100:103], a[244:247], v[152:155], v[100:103]
  ds_read_b128 v[148:151], v12 offset:18432
  v_mfma_f32_16x16x32_bf16 v[104:107], a[248:251], v[152:155], v[104:107]
  v_mov_b32 v11, v12
  v_mfma_f32_16x16x32_bf16 v[108:111], a[252:255], v[152:155], v[108:111]
  s_add_u32 s63, s62, s61
  v_mfma_f32_16x16x32_bf16 v[112:115], a[240:243], v[156:159], v[112:115]
  v_mov_b32 v14, s63
  v_mfma_f32_16x16x32_bf16 v[116:119], a[244:247], v[156:159], v[116:119]
  s_waitcnt vmcnt(8)
  global_store_dword v13, v14, s[26:27] sc1
  v_mfma_f32_16x16x32_bf16 v[120:123], a[248:251], v[156:159], v[120:123]
  v_mfma_f32_16x16x32_bf16 v[124:127], a[252:255], v[156:159], v[124:127]
  s_cmp_lt_u32 s61, 16
  s_cbranch_scc1 g1l_45
  s_nop 7
  v_pk_mul_f32 v[96:97], v[96:97], s[44:45]
  v_pk_mul_f32 v[98:99], v[98:99], s[44:45]
  v_pk_mul_f32 v[100:101], v[100:101], s[44:45]
  v_pk_mul_f32 v[102:103], v[102:103], s[44:45]
  v_pk_mul_f32 v[104:105], v[104:105], s[44:45]
  v_pk_mul_f32 v[106:107], v[106:107], s[44:45]
  v_pk_mul_f32 v[108:109], v[108:109], s[44:45]
  v_pk_mul_f32 v[110:111], v[110:111], s[44:45]
  v_pk_mul_f32 v[112:113], v[112:113], s[44:45]
  v_pk_mul_f32 v[114:115], v[114:115], s[44:45]
  v_pk_mul_f32 v[116:117], v[116:117], s[44:45]
  v_pk_mul_f32 v[118:119], v[118:119], s[44:45]
  v_pk_mul_f32 v[120:121], v[120:121], s[44:45]
  v_pk_mul_f32 v[122:123], v[122:123], s[44:45]
  v_pk_mul_f32 v[124:125], v[124:125], s[44:45]
  v_pk_mul_f32 v[126:127], v[126:127], s[44:45]
  v_cvt_pk_bf16_f32 v160, v96, v100
  v_cvt_pk_bf16_f32 v161, v104, v108
  v_cvt_pk_bf16_f32 v162, v97, v101
  v_cvt_pk_bf16_f32 v163, v105, v109
  global_store_dwordx4 v4, v[160:163], s[46:47] sc1
  v_cvt_pk_bf16_f32 v164, v112, v116
  v_cvt_pk_bf16_f32 v165, v120, v124
  v_cvt_pk_bf16_f32 v166, v113, v117
  v_cvt_pk_bf16_f32 v167, v121, v125
  global_store_dwordx4 v5, v[164:167], s[46:47] sc1
  v_cvt_pk_bf16_f32 v168, v98, v102
  v_cvt_pk_bf16_f32 v169, v106, v110
  v_cvt_pk_bf16_f32 v170, v99, v103
  v_cvt_pk_bf16_f32 v171, v107, v111
  global_store_dwordx4 v6, v[168:171], s[46:47] sc1
  v_cvt_pk_bf16_f32 v172, v114, v118
  v_cvt_pk_bf16_f32 v173, v122, v126
  v_cvt_pk_bf16_f32 v174, v115, v119
  v_cvt_pk_bf16_f32 v175, v123, v127
  global_store_dwordx4 v7, v[172:175], s[46:47] sc1
  s_add_u32 s46, s46, s43
  s_addc_u32 s47, s47, 0
  s_mov_b32 s43, s42
  s_waitcnt vmcnt(0) lgkmcnt(0)
  s_add_u32 s63, s62, 17
  v_mov_b32 v14, s63
  global_store_dword v13, v14, s[26:27] sc1
  s_branch k_g1d
g1v_44:
  ds_read_b128 v[128:131], v11 offset:0
  ds_read_b128 v[132:135], v11 offset:16384
  ds_read_b128 v[136:139], v11 offset:1024
  ds_read_b128 v[140:143], v11 offset:17408
  ds_read_b128 v[144:147], v11 offset:2048
  ds_read_b128 v[148:151], v11 offset:18432
g1l_49:
  s_waitcnt lgkmcnt(4)
  v_mfma_f32_16x16x32_bf16 v[64:67], v[128:131], a[0:3], 0
  ds_read_b128 v[152:155], v11 offset:3072
  v_mfma_f32_16x16x32_bf16 v[68:71], v[128:131], a[4:7], 0
  ds_read_b128 v[156:159], v11 offset:19456
  v_mfma_f32_16x16x32_bf16 v[72:75], v[128:131], a[8:11], 0
  v_mfma_f32_16x16x32_bf16 v[76:79], v[128:131], a[12:15], 0
  v_mfma_f32_16x16x32_bf16 v[80:83], v[132:135], a[0:3], 0
  v_mfma_f32_16x16x32_bf16 v[84:87], v[132:135], a[4:7], 0
  v_mfma_f32_16x16x32_bf16 v[88:91], v[132:135], a[8:11], 0
  v_mfma_f32_16x16x32_bf16 v[92:95], v[132:135], a[12:15], 0
  s_waitcnt lgkmcnt(4)
  v_mfma_f32_16x16x32_bf16 v[64:67], v[136:139], a[16:19], v[64:67]
  ds_read_b128 v[128:131], v11 offset:4096
  v_mfma_f32_16x16x32_bf16 v[68:71], v[136:139], a[20:23], v[68:71]
  ds_read_b128 v[132:135], v11 offset:20480
  v_mfma_f32_16x16x32_bf16 v[72:75], v[136:139], a[24:27], v[72:75]
  v_cvt_pk_bf16_f32 v160, v96, v97
  v_mfma_f32_16x16x32_bf16 v[76:79], v[136:139], a[28:31], v[76:79]
  v_cvt_pk_bf16_f32 v161, v98, v99
  v_mfma_f32_16x16x32_bf16 v[80:83], v[140:143], a[16:19], v[80:83]
  v_cvt_pk_bf16_f32 v162, v112, v113
  v_mfma_f32_16x16x32_bf16 v[84:87], v[140:143], a[20:23], v[84:87]
  v_cvt_pk_bf16_f32 v163, v114, v115
  v_mfma_f32_16x16x32_bf16 v[88:91], v[140:143], a[24:27], v[88:91]
  global_store_dwordx4 v4, v[160:163], s[46:47] sc1
  v_mfma_f32_16x16x32_bf16 v[92:95], v[140:143], a[28:31], v[92:95]
  v_cvt_pk_bf16_f32 v164, v100, v101
  s_waitcnt lgkmcnt(4)
  v_mfma_f32_16x16x32_bf16 v[64:67], v[144:147], a[32:35], v[64:67]
  ds_read_b128 v[136:139], v11 offset:5120
  v_mfma_f32_16x16x32_bf16 v[68:71], v[144:147], a[36:39], v[68:71]
  ds_read_b128 v[140:143], v11 offset:21504
  v_mfma_f32_16x16x32_bf16 v[72:75], v[144:147], a[40:43], v[72:75]
  v_cvt_pk_bf16_f32 v165, v102, v103
  v_mfma_f32_16x16x32_bf16 v[76:79], v[144:147], a[44:47], v[76:79]
  v_cvt_pk_bf16_f32 v166, v116, v117
  v_mfma_f32_16x16x32_bf16 v[80:83], v[148:151], a[32:35], v[80:83]
  v_cvt_pk_bf16_f32 v167, v118, v119
  v_mfma_f32_16x16x32_bf16 v[84:87], v[148:151], a[36:39], v[84:87]
  global_store_dwordx4 v5, v[164:167], s[46:47] sc1
  v_mfma_f32_16x16x32_bf16 v[88:91], v[148:151], a[40:43], v[88:91]
  v_cvt_pk_bf16_f32 v168, v104, v105
  v_mfma_f32_16x16x32_bf16 v[92:95], v[148:151], a[44:47], v[92:95]
  v_cvt_pk_bf16_f32 v169, v106, v107
  s_waitcnt lgkmcnt(4)
  v_mfma_f32_16x16x32_bf16 v[64:67], v[152:155], a[48:51], v[64:67]
  ds_read_b128 v[144:147], v11 offset:6144
  v_mfma_f32_16x16x32_bf16 v[68:71], v[152:155], a[52:55], v[68:71]
  ds_read_b128 v[148:151], v11 offset:22528
  v_mfma_f32_16x16x32_bf16 v[72:75], v[152:155], a[56:59], v[72:75]
  v_cvt_pk_bf16_f32 v170, v120, v121
  v_mfma_f32_16x16x32_bf16 v[76:79], v[152:155], a[60:63], v[76:79]
  v_cvt_pk_bf16_f32 v171, v122, v123
  v_mfma_f32_16x16x32_bf16 v[80:83], v[156:159], a[48:51], v[80:83]
  global_store_dwordx4 v6, v[168:171], s[46:47] sc1
  v_mfma_f32_16x16x32_bf16 v[84:87], v[156:159], a[52:55], v[84:87]
  v_cvt_pk_bf16_f32 v172, v108, v109
  v_mfma_f32_16x16x32_bf16 v[88:91], v[156:159], a[56:59], v[88:91]
  v_cvt_pk_bf16_f32 v173, v110, v111
  v_mfma_f32_16x16x32_bf16 v[92:95], v[156:159], a[60:63], v[92:95]
  v_cvt_pk_bf16_f32 v174, v124, v125
  s_waitcnt lgkmcnt(4)
  v_mfma_f32_16x16x32_bf16 v[64:67], v[128:131], a[64:67], v[64:67]
  ds_read_b128 v[152:155], v11 offset:7168
  v_mfma_f32_16x16x32_bf16 v[68:71], v[128:131], a[68:71], v[68:71]
  ds_read_b128 v[156:159], v11 offset:23552
  v_mfma_f32_16x16x32_bf16 v[72:75], v[128:131], a[72:75], v[72:75]
  v_cvt_pk_bf16_f32 v175, v126, v127
  v_mfma_f32_16x16x32_bf16 v[76:79], v[128:131], a[76:79], v[76:79]
  global_store_dwordx4 v7, v[172:175], s[46:47] sc1
  v_mfma_f32_16x16x32_bf16 v[80:83], v[132:135], a[64:67], v[80:83]
  s_add_u32 s46, s46, s43
  s_addc_u32 s47, s47, 0
  v_mfma_f32_16x16x32_bf16 v[84:87], v[132:135], a[68:71], v[84:87]
  s_mov_b32 s43, s42
  v_mfma_f32_16x16x32_bf16 v[88:91], v[132:135], a[72:75], v[88:91]
  v_mfma_f32_16x16x32_bf16 v[92:95], v[132:135], a[76:79], v[92:95]
  s_waitcnt lgkmcnt(4)
  v_mfma_f32_16x16x32_bf16 v[64:67], v[136:139], a[80:83], v[64:67]
  ds_read_b128 v[128:131], v11 offset:8192
  v_mfma_f32_16x16x32_bf16 v[68:71], v[136:139], a[84:87], v[68:71]
  ds_read_b128 v[132:135], v11 offset:24576
  v_mfma_f32_16x16x32_bf16 v[72:75], v[136:139], a[88:91], v[72:75]
  v_mfma_f32_16x16x32_bf16 v[76:79], v[136:139], a[92:95], v[76:79]
  v_mfma_f32_16x16x32_bf16 v[80:83], v[140:143], a[80:83], v[80:83]
  v_mfma_f32_16x16x32_bf16 v[84:87], v[140:143], a[84:87], v[84:87]
  v_mfma_f32_16x16x32_bf16 v[88:91], v[140:143], a[88:91], v[88:91]
  v_mfma_f32_16x16x32_bf16 v[92:95], v[140:143], a[92:95], v[92:95]
  s_waitcnt lgkmcnt(4)
  v_mfma_f32_16x16x32_bf16 v[64:67], v[144:147], a[96:99], v[64:67]
  ds_read_b128 v[136:139], v11 offset:9216
  v_mfma_f32_16x16x32_bf16 v[68:71], v[144:147], a[100:103], v[68:71]
  ds_read_b128 v[140:143], v11 offset:25600
  v_mfma_f32_16x16x32_bf16 v[72:75], v[144:147], a[104:107], v[72:75]
  v_mfma_f32_16x16x32_bf16 v[76:79], v[144:147], a[108:111], v[76:79]
  v_mfma_f32_16x16x32_bf16 v[80:83], v[148:151], a[96:99], v[80:83]
  v_mfma_f32_16x16x32_bf16 v[84:87], v[148:151], a[100:103], v[84:87]
  v_mfma_f32_16x16x32_bf16 v[88:91], v[148:151], a[104:107], v[88:91]
  v_mfma_f32_16x16x32_bf16 v[92:95], v[148:151], a[108:111], v[92:95]
  s_waitcnt lgkmcnt(4)
  v_mfma_f32_16x16x32_bf16 v[64:67], v[152:155], a[112:115], v[64:67]
  ds_read_b128 v[144:147], v11 offset:10240
  v_mfma_f32_16x16x32_bf16 v[68:71], v[152:155], a[116:119], v[68:71]
  ds_read_b128 v[148:151], v11 offset:26624
  v_mfma_f32_16x16x32_bf16 v[72:75], v[152:155], a[120:123], v[72:75]
  v_mfma_f32_16x16x32_bf16 v[76:79], v[152:155], a[124:127], v[76:79]
  v_mfma_f32_16x16x32_bf16 v[80:83], v[156:159], a[112:115], v[80:83]
  v_mfma_f32_16x16x32_bf16 v[84:87], v[156:159], a[116:119], v[84:87]
  v_mfma_f32_16x16x32_bf16 v[88:91], v[156:159], a[120:123], v[88:91]
  v_mfma_f32_16x16x32_bf16 v[92:95], v[156:159], a[124:127], v[92:95]
  s_waitcnt lgkmcnt(4)
  v_mfma_f32_16x16x32_bf16 v[64:67], v[128:131], a[128:131], v[64:67]
  ds_read_b128 v[152:155], v11 offset:11264
  v_mfma_f32_16x16x32_bf16 v[68:71], v[128:131], a[132:135], v[68:71]
  ds_read_b128 v[156:159], v11 offset:27648
  v_mfma_f32_16x16x32_bf16 v[72:75], v[128:131], a[136:139], v[72:75]
  v_mfma_f32_16x16x32_bf16 v[76:79], v[128:131], a[140:143], v[76:79]
  v_mfma_f32_16x16x32_bf16 v[80:83], v[132:135], a[128:131], v[80:83]
  v_mfma_f32_16x16x32_bf16 v[84:87], v[132:135], a[132:135], v[84:87]
  v_mfma_f32_16x16x32_bf16 v[88:91], v[132:135], a[136:139], v[88:91]
  v_mfma_f32_16x16x32_bf16 v[92:95], v[132:135], a[140:143], v[92:95]
  s_waitcnt lgkmcnt(4)
  v_mfma_f32_16x16x32_bf16 v[64:67], v[136:139], a[144:147], v[64:67]
  ds_read_b128 v[128:131], v11 offset:12288
  v_mfma_f32_16x16x32_bf16 v[68:71], v[136:139], a[148:151], v[68:71]
  ds_read_b128 v[132:135], v11 offset:28672
  v_mfma_f32_16x16x32_bf16 v[72:75], v[136:139], a[152:155], v[72:75]
  v_mfma_f32_16x16x32_bf16 v[76:79], v[136:139], a[156:159], v[76:79]
  v_mfma_f32_16x16x32_bf16 v[80:83], v[140:143], a[144:147], v[80:83]
  v_mfma_f32_16x16x32_bf16 v[84:87], v[140:143], a[148:151], v[84:87]
  v_mfma_f32_16x16x32_bf16 v[88:91], v[140:143], a[152:155], v[88:91]
  v_mfma_f32_16x16x32_bf16 v[92:95], v[140:143], a[156:159], v[92:95]
  s_waitcnt lgkmcnt(4)
  v_mfma_f32_16x16x32_bf16 v[64:67], v[144:147], a[160:163], v[64:67]
  ds_read_b128 v[136:139], v11 offset:13312
  v_mfma_f32_16x16x32_bf16 v[68:71], v[144:147], a[164:167], v[68:71]
  ds_read_b128 v[140:143], v11 offset:29696
  v_mfma_f32_16x16x32_bf16 v[72:75], v[144:147], a[168:171], v[72:75]
  v_mfma_f32_16x16x32_bf16 v[76:79], v[144:147], a[172:175], v[76:79]
  v_mfma_f32_16x16x32_bf16 v[80:83], v[148:151], a[160:163], v[80:83]
  v_mfma_f32_16x16x32_bf16 v[84:87], v[148:151], a[164:167], v[84:87]
  v_mfma_f32_16x16x32_bf16 v[88:91], v[148:151], a[168:171], v[88:91]
  v_mfma_f32_16x16x32_bf16 v[92:95], v[148:151], a[172:175], v[92:95]
  s_waitcnt lgkmcnt(4)
  v_mfma_f32_16x16x32_bf16 v[64:67], v[152:155], a[176:179], v[64:67]
  ds_read_b128 v[144:147], v11 offset:14336
  v_mfma_f32_16x16x32_bf16 v[68:71], v[152:155], a[180:183], v[68:71]
  ds_read_b128 v[148:151], v11 offset:30720
  v_mfma_f32_16x16x32_bf16 v[72:75], v[152:155], a[184:187], v[72:75]
  s_add_u32 s61, s61, 1
  s_lshl_b32 s63, s61, 15
  s_and_b32 s63, s63, 0x18000
  v_mfma_f32_16x16x32_bf16 v[76:79], v[152:155], a[188:191], v[76:79]
  v_add_u32 v12, s63, v10
  v_mfma_f32_16x16x32_bf16 v[80:83], v[156:159], a[176:179], v[80:83]
  s_add_u32 s63, s61, 1
  s_lshl_b32 s63, s63, 15
  s_and_b32 s63, s63, 0x18000
  s_add_u32 s63, s63, s55
  v_mfma_f32_16x16x32_bf16 v[84:87], v[156:159], a[180:183], v[84:87]
  v_mfma_f32_16x16x32_bf16 v[88:91], v[156:159], a[184:187], v[88:91]
  v_mfma_f32_16x16x32_bf16 v[92:95], v[156:159], a[188:191], v[92:95]
  s_waitcnt lgkmcnt(4)
  v_mfma_f32_16x16x32_bf16 v[64:67], v[128:131], a[192:195], v[64:67]
  ds_read_b128 v[152:155], v11 offset:15360
  v_mfma_f32_16x16x32_bf16 v[68:71], v[128:131], a[196:199], v[68:71]
  ds_read_b128 v[156:159], v11 offset:31744
  s_waitcnt vmcnt(4)
  s_barrier
  s_cmp_ge_u32 s61, 15
  s_cselect_b32 s50, 0, s50
  v_mfma_f32_16x16x32_bf16 v[72:75], v[128:131], a[200:203], v[72:75]
  s_mov_b32 m0, s63
  v_mfma_f32_16x16x32_bf16 v[76:79], v[128:131], a[204:207], v[76:79]
  buffer_load_dwordx4 v9, s[48:51], s54 offen offset:0 lds
  s_add_u32 m0, s63, 960
  v_mfma_f32_16x16x32_bf16 v[80:83], v[132:135], a[192:195], v[80:83]
  buffer_load_dwordx4 v9, s[48:51], s54 offen offset:64 lds
  s_add_u32 m0, s63, 1920
  v_mfma_f32_16x16x32_bf16 v[84:87], v[132:135], a[196:199], v[84:87]
  buffer_load_dwordx4 v9, s[48:51], s54 offen offset:128 lds
  s_add_u32 m0, s63, 2880
  v_mfma_f32_16x16x32_bf16 v[88:91], v[132:135], a[200:203], v[88:91]
  buffer_load_dwordx4 v9, s[48:51], s54 offen offset:192 lds
  s_add_u32 m0, s63, 3840
  v_mfma_f32_16x16x32_bf16 v[92:95], v[132:135], a[204:207], v[92:95]
  buffer_load_dwordx4 v9, s[48:51], s54 offen offset:256 lds
  s_add_u32 m0, s63, 4800
  s_waitcnt lgkmcnt(4)
  v_mfma_f32_16x16x32_bf16 v[64:67], v[136:139], a[208:211], v[64:67]
  ds_read_b128 v[128:131], v12 offset:0
  v_mfma_f32_16x16x32_bf16 v[68:71], v[136:139], a[212:215], v[68:71]
  ds_read_b128 v[132:135], v12 offset:16384
  v_mfma_f32_16x16x32_bf16 v[72:75], v[136:139], a[216:219], v[72:75]
  buffer_load_dwordx4 v9, s[48:51], s54 offen offset:320 lds
  s_add_u32 m0, s63, 5760
  v_mfma_f32_16x16x32_bf16 v[76:79], v[136:139], a[220:223], v[76:79]
  buffer_load_dwordx4 v9, s[48:51], s54 offen offset:384 lds
  s_add_u32 m0, s63, 6720
  v_mfma_f32_16x16x32_bf16 v[80:83], v[140:143], a[208:211], v[80:83]
  buffer_load_dwordx4 v9, s[48:51], s54 offen offset:448 lds
  s_add_u32 s54, s54, 0x8000
  v_mfma_f32_16x16x32_bf16 v[84:87], v[140:143], a[212:215], v[84:87]
  v_mfma_f32_16x16x32_bf16 v[88:91], v[140:143], a[216:219], v[88:91]
  v_mfma_f32_16x16x32_bf16 v[92:95], v[140:143], a[220:223], v[92:95]
  s_waitcnt lgkmcnt(4)
  v_mfma_f32_16x16x32_bf16 v[64:67], v[144:147], a[224:227], v[64:67]
  ds_read_b128 v[136:139], v12 offset:1024
  v_mfma_f32_16x16x32_bf16 v[68:71], v[144:147], a[228:231], v[68:71]
  ds_read_b128 v[140:143], v12 offset:17408
  v_mfma_f32_16x16x32_bf16 v[72:75], v[144:147], a[232:235], v[72:75]
  v_mfma_f32_16x16x32_bf16 v[76:79], v[144:147], a[236:239], v[76:79]
  v_mfma_f32_16x16x32_bf16 v[80:83], v[148:151], a[224:227], v[80:83]
  v_mfma_f32_16x16x32_bf16 v[84:87], v[148:151], a[228:231], v[84:87]
  v_mfma_f32_16x16x32_bf16 v[88:91], v[148:151], a[232:235], v[88:91]
  v_mfma_f32_16x16x32_bf16 v[92:95], v[148:151], a[236:239], v[92:95]
  s_waitcnt lgkmcnt(4)
  v_mfma_f32_16x16x32_bf16 v[64:67], v[152:155], a[240:243], v[64:67]
  ds_read_b128 v[144:147], v12 offset:2048
  v_mfma_f32_16x16x32_bf16 v[68:71], v[152:155], a[244:247], v[68:71]
  ds_read_b128 v[148:151], v12 offset:18432
  v_mfma_f32_16x16x32_bf16 v[72:75], v[152:155], a[248:251], v[72:75]
  v_mov_b32 v11, v12
  v_mfma_f32_16x16x32_bf16 v[76:79], v[152:155], a[252:255], v[76:79]
  s_add_u32 s63, s62, s61
  v_mfma_f32_16x16x32_bf16 v[80:83], v[156:159], a[240:243], v[80:83]
  v_mov_b32 v14, s63
  v_mfma_f32_16x16x32_bf16 v[84:87], v[156:159], a[244:247], v[84:87]
  s_waitcnt vmcnt(8)
  global_store_dword v13, v14, s[26:27] sc1
  v_mfma_f32_16x16x32_bf16 v[88:91], v[156:159], a[248:251], v[88:91]
  v_mfma_f32_16x16x32_bf16 v[92:95], v[156:159], a[252:255], v[92:95]
  s_waitcnt lgkmcnt(4)
  v_mfma_f32_16x16x32_bf16 v[96:99], v[128:131], a[0:3], 0
  ds_read_b128 v[152:155], v11 offset:3072
  v_mfma_f32_16x16x32_bf16 v[100:103], v[128:131], a[4:7], 0
  ds_read_b128 v[156:159], v11 offset:19456
  v_mfma_f32_16x16x32_bf16 v[104:107], v[128:131], a[8:11], 0
  v_mfma_f32_16x16x32_bf16 v[108:111], v[128:131], a[12:15], 0
  v_mfma_f32_16x16x32_bf16 v[112:115], v[132:135], a[0:3], 0
  v_mfma_f32_16x16x32_bf16 v[116:119], v[132:135], a[4:7], 0
  v_mfma_f32_16x16x32_bf16 v[120:123], v[132:135], a[8:11], 0
  v_mfma_f32_16x16x32_bf16 v[124:127], v[132:135], a[12:15], 0
  s_waitcnt lgkmcnt(4)
  v_mfma_f32_16x16x32_bf16 v[96:99], v[136:139], a[16:19], v[96:99]
  ds_read_b128 v[128:131], v11 offset:4096
  v_mfma_f32_16x16x32_bf16 v[100:103], v[136:139], a[20:23], v[100:103]
  ds_read_b128 v[132:135], v11 offset:20480
  v_mfma_f32_16x16x32_bf16 v[104:107], v[136:139], a[24:27], v[104:107]
  v_cvt_pk_bf16_f32 v160, v64, v65
  v_mfma_f32_16x16x32_bf16 v[108:111], v[136:139], a[28:31], v[108:111]
  v_cvt_pk_bf16_f32 v161, v66, v67
  v_mfma_f32_16x16x32_bf16 v[112:115], v[140:143], a[16:19], v[112:115]
  v_cvt_pk_bf16_f32 v162, v80, v81
  v_mfma_f32_16x16x32_bf16 v[116:119], v[140:143], a[20:23], v[116:119]
  v_cvt_pk_bf16_f32 v163, v82, v83
  v_mfma_f32_16x16x32_bf16 v[120:123], v[140:143], a[24:27], v[120:123]
  global_store_dwordx4 v4, v[160:163], s[46:47] sc1
  v_mfma_f32_16x16x32_bf16 v[124:127], v[140:143], a[28:31], v[124:127]
  v_cvt_pk_bf16_f32 v164, v68, v69
  s_waitcnt lgkmcnt(4)
  v_mfma_f32_16x16x32_bf16 v[96:99], v[144:147], a[32:35], v[96:99]
  ds_read_b128 v[136:139], v11 offset:5120
  v_mfma_f32_16x16x32_bf16 v[100:103], v[144:147], a[36:39], v[100:103]
  ds_read_b128 v[140:143], v11 offset:21504
  v_mfma_f32_16x16x32_bf16 v[104:107], v[144:147], a[40:43], v[104:107]
  v_cvt_pk_bf16_f32 v165, v70, v71
  v_mfma_f32_16x16x32_bf16 v[108:111], v[144:147], a[44:47], v[108:111]
  v_cvt_pk_bf16_f32 v166, v84, v85
  v_mfma_f32_16x16x32_bf16 v[112:115], v[148:151], a[32:35], v[112:115]
  v_cvt_pk_bf16_f32 v167, v86, v87
  v_mfma_f32_16x16x32_bf16 v[116:119], v[148:151], a[36:39], v[116:119]
  global_store_dwordx4 v5, v[164:167], s[46:47] sc1
  v_mfma_f32_16x16x32_bf16 v[120:123], v[148:151], a[40:43], v[120:123]
  v_cvt_pk_bf16_f32 v168, v72, v73
  v_mfma_f32_16x16x32_bf16 v[124:127], v[148:151], a[44:47], v[124:127]
  v_cvt_pk_bf16_f32 v169, v74, v75
  s_waitcnt lgkmcnt(4)
  v_mfma_f32_16x16x32_bf16 v[96:99], v[152:155], a[48:51], v[96:99]
  ds_read_b128 v[144:147], v11 offset:6144
  v_mfma_f32_16x16x32_bf16 v[100:103], v[152:155], a[52:55], v[100:103]
  ds_read_b128 v[148:151], v11 offset:22528
  v_mfma_f32_16x16x32_bf16 v[104:107], v[152:155], a[56:59], v[104:107]
  v_cvt_pk_bf16_f32 v170, v88, v89
  v_mfma_f32_16x16x32_bf16 v[108:111], v[152:155], a[60:63], v[108:111]
  v_cvt_pk_bf16_f32 v171, v90, v91
  v_mfma_f32_16x16x32_bf16 v[112:115], v[156:159], a[48:51], v[112:115]
  global_store_dwordx4 v6, v[168:171], s[46:47] sc1
  v_mfma_f32_16x16x32_bf16 v[116:119], v[156:159], a[52:55], v[116:119]
  v_cvt_pk_bf16_f32 v172, v76, v77
  v_mfma_f32_16x16x32_bf16 v[120:123], v[156:159], a[56:59], v[120:123]
  v_cvt_pk_bf16_f32 v173, v78, v79
  v_mfma_f32_16x16x32_bf16 v[124:127], v[156:159], a[60:63], v[124:127]
  v_cvt_pk_bf16_f32 v174, v92, v93
  s_waitcnt lgkmcnt(4)
  v_mfma_f32_16x16x32_bf16 v[96:99], v[128:131], a[64:67], v[96:99]
  ds_read_b128 v[152:155], v11 offset:7168
  v_mfma_f32_16x16x32_bf16 v[100:103], v[128:131], a[68:71], v[100:103]
  ds_read_b128 v[156:159], v11 offset:23552
  v_mfma_f32_16x16x32_bf16 v[104:107], v[128:131], a[72:75], v[104:107]
  v_cvt_pk_bf16_f32 v175, v94, v95
  v_mfma_f32_16x16x32_bf16 v[108:111], v[128:131], a[76:79], v[108:111]
  global_store_dwordx4 v7, v[172:175], s[46:47] sc1
  v_mfma_f32_16x16x32_bf16 v[112:115], v[132:135], a[64:67], v[112:115]
  s_add_u32 s46, s46, s43
  s_addc_u32 s47, s47, 0
  v_mfma_f32_16x16x32_bf16 v[116:119], v[132:135], a[68:71], v[116:119]
  s_mov_b32 s43, s42
  v_mfma_f32_16x16x32_bf16 v[120:123], v[132:135], a[72:75], v[120:123]
  v_mfma_f32_16x16x32_bf16 v[124:127], v[132:135], a[76:79], v[124:127]
  s_waitcnt lgkmcnt(4)
  v_mfma_f32_16x16x32_bf16 v[96:99], v[136:139], a[80:83], v[96:99]
  ds_read_b128 v[128:131], v11 offset:8192
  v_mfma_f32_16x16x32_bf16 v[100:103], v[136:139], a[84:87], v[100:103]
  ds_read_b128 v[132:135], v11 offset:24576
  v_mfma_f32_16x16x32_bf16 v[104:107], v[136:139], a[88:91], v[104:107]
  v_mfma_f32_16x16x32_bf16 v[108:111], v[136:139], a[92:95], v[108:111]
  v_mfma_f32_16x16x32_bf16 v[112:115], v[140:143], a[80:83], v[112:115]
  v_mfma_f32_16x16x32_bf16 v[116:119], v[140:143], a[84:87], v[116:119]
  v_mfma_f32_16x16x32_bf16 v[120:123], v[140:143], a[88:91], v[120:123]
  v_mfma_f32_16x16x32_bf16 v[124:127], v[140:143], a[92:95], v[124:127]
  s_waitcnt lgkmcnt(4)
  v_mfma_f32_16x16x32_bf16 v[96:99], v[144:147], a[96:99], v[96:99]
  ds_read_b128 v[136:139], v11 offset:9216
  v_mfma_f32_16x16x32_bf16 v[100:103], v[144:147], a[100:103], v[100:103]
  ds_read_b128 v[140:143], v11 offset:25600
  v_mfma_f32_16x16x32_bf16 v[104:107], v[144:147], a[104:107], v[104:107]
  v_mfma_f32_16x16x32_bf16 v[108:111], v[144:147], a[108:111], v[108:111]
  v_mfma_f32_16x16x32_bf16 v[112:115], v[148:151], a[96:99], v[112:115]
  v_mfma_f32_16x16x32_bf16 v[116:119], v[148:151], a[100:103], v[116:119]
  v_mfma_f32_16x16x32_bf16 v[120:123], v[148:151], a[104:107], v[120:123]
  v_mfma_f32_16x16x32_bf16 v[124:127], v[148:151], a[108:111], v[124:127]
  s_waitcnt lgkmcnt(4)
  v_mfma_f32_16x16x32_bf16 v[96:99], v[152:155], a[112:115], v[96:99]
  ds_read_b128 v[144:147], v11 offset:10240
  v_mfma_f32_16x16x32_bf16 v[100:103], v[152:155], a[116:119], v[100:103]
  ds_read_b128 v[148:151], v11 offset:26624
  v_mfma_f32_16x16x32_bf16 v[104:107], v[152:155], a[120:123], v[104:107]
  v_mfma_f32_16x16x32_bf16 v[108:111], v[152:155], a[124:127], v[108:111]
  v_mfma_f32_16x16x32_bf16 v[112:115], v[156:159], a[112:115], v[112:115]
  v_mfma_f32_16x16x32_bf16 v[116:119], v[156:159], a[116:119], v[116:119]
  v_mfma_f32_16x16x32_bf16 v[120:123], v[156:159], a[120:123], v[120:123]
  v_mfma_f32_16x16x32_bf16 v[124:127], v[156:159], a[124:127], v[124:127]
  s_waitcnt lgkmcnt(4)
  v_mfma_f32_16x16x32_bf16 v[96:99], v[128:131], a[128:131], v[96:99]
  ds_read_b128 v[152:155], v11 offset:11264
  v_mfma_f32_16x16x32_bf16 v[100:103], v[128:131], a[132:135], v[100:103]
  ds_read_b128 v[156:159], v11 offset:27648
  v_mfma_f32_16x16x32_bf16 v[104:107], v[128:131], a[136:139], v[104:107]
  v_mfma_f32_16x16x32_bf16 v[108:111], v[128:131], a[140:143], v[108:111]
  v_mfma_f32_16x16x32_bf16 v[112:115], v[132:135], a[128:131], v[112:115]
  v_mfma_f32_16x16x32_bf16 v[116:119], v[132:135], a[132:135], v[116:119]
  v_mfma_f32_16x16x32_bf16 v[120:123], v[132:135], a[136:139], v[120:123]
  v_mfma_f32_16x16x32_bf16 v[124:127], v[132:135], a[140:143], v[124:127]
  s_waitcnt lgkmcnt(4)
  v_mfma_f32_16x16x32_bf16 v[96:99], v[136:139], a[144:147], v[96:99]
  ds_read_b128 v[128:131], v11 offset:12288
  v_mfma_f32_16x16x32_bf16 v[100:103], v[136:139], a[148:151], v[100:103]
  ds_read_b128 v[132:135], v11 offset:28672
  v_mfma_f32_16x16x32_bf16 v[104:107], v[136:139], a[152:155], v[104:107]
  v_mfma_f32_16x16x32_bf16 v[108:111], v[136:139], a[156:159], v[108:111]
  v_mfma_f32_16x16x32_bf16 v[112:115], v[140:143], a[144:147], v[112:115]
  v_mfma_f32_16x16x32_bf16 v[116:119], v[140:143], a[148:151], v[116:119]
  v_mfma_f32_16x16x32_bf16 v[120:123], v[140:143], a[152:155], v[120:123]
  v_mfma_f32_16x16x32_bf16 v[124:127], v[140:143], a[156:159], v[124:127]
  s_waitcnt lgkmcnt(4)
  v_mfma_f32_16x16x32_bf16 v[96:99], v[144:147], a[160:163], v[96:99]
  ds_read_b128 v[136:139], v11 offset:13312
  v_mfma_f32_16x16x32_bf16 v[100:103], v[144:147], a[164:167], v[100:103]
  ds_read_b128 v[140:143], v11 offset:29696
  v_mfma_f32_16x16x32_bf16 v[104:107], v[144:147], a[168:171], v[104:107]
  v_mfma_f32_16x16x32_bf16 v[108:111], v[144:147], a[172:175], v[108:111]
  v_mfma_f32_16x16x32_bf16 v[112:115], v[148:151], a[160:163], v[112:115]
  v_mfma_f32_16x16x32_bf16 v[116:119], v[148:151], a[164:167], v[116:119]
  v_mfma_f32_16x16x32_bf16 v[120:123], v[148:151], a[168:171], v[120:123]
  v_mfma_f32_16x16x32_bf16 v[124:127], v[148:151], a[172:175], v[124:127]
  s_waitcnt lgkmcnt(4)
  v_mfma_f32_16x16x32_bf16 v[96:99], v[152:155], a[176:179], v[96:99]
  ds_read_b128 v[144:147], v11 offset:14336
  v_mfma_f32_16x16x32_bf16 v[100:103], v[152:155], a[180:183], v[100:103]
  ds_read_b128 v[148:151], v11 offset:30720
  v_mfma_f32_16x16x32_bf16 v[104:107], v[152:155], a[184:187], v[104:107]
  s_add_u32 s61, s61, 1
  s_lshl_b32 s63, s61, 15
  s_and_b32 s63, s63, 0x18000
  v_mfma_f32_16x16x32_bf16 v[108:111], v[152:155], a[188:191], v[108:111]
  v_add_u32 v12, s63, v10
  v_mfma_f32_16x16x32_bf16 v[112:115], v[156:159], a[176:179], v[112:115]
  s_add_u32 s63, s61, 1
  s_lshl_b32 s63, s63, 15
  s_and_b32 s63, s63, 0x18000
  s_add_u32 s63, s63, s55
  v_mfma_f32_16x16x32_bf16 v[116:119], v[156:159], a[180:183], v[116:119]
  v_mfma_f32_16x16x32_bf16 v[120:123], v[156:159], a[184:187], v[120:123]
  v_mfma_f32_16x16x32_bf16 v[124:127], v[156:159], a[188:191], v[124:127]
  s_waitcnt lgkmcnt(4)
  v_mfma_f32_16x16x32_bf16 v[96:99], v[128:131], a[192:195], v[96:99]
  ds_read_b128 v[152:155], v11 offset:15360
  v_mfma_f32_16x16x32_bf16 v[100:103], v[128:131], a[196:199], v[100:103]
  ds_read_b128 v[156:159], v11 offset:31744
  s_waitcnt vmcnt(4)
  s_barrier
  s_cmp_ge_u32 s61, 15
  s_cselect_b32 s50, 0, s50
  v_mfma_f32_16x16x32_bf16 v[104:107], v[128:131], a[200:203], v[104:107]
  s_mov_b32 m0, s63
  v_mfma_f32_16x16x32_bf16 v[108:111], v[128:131], a[204:207], v[108:111]
  buffer_load_dwordx4 v9, s[48:51], s54 offen offset:0 lds
  s_add_u32 m0, s63, 960
  v_mfma_f32_16x16x32_bf16 v[112:115], v[132:135], a[192:195], v[112:115]
  buffer_load_dwordx4 v9, s[48:51], s54 offen offset:64 lds
  s_add_u32 m0, s63, 1920
  v_mfma_f32_16x16x32_bf16 v[116:119], v[132:135], a[196:199], v[116:119]
  buffer_load_dwordx4 v9, s[48:51], s54 offen offset:128 lds
  s_add_u32 m0, s63, 2880
  v_mfma_f32_16x16x32_bf16 v[120:123], v[132:135], a[200:203], v[120:123]
  buffer_load_dwordx4 v9, s[48:51], s54 offen offset:192 lds
  s_add_u32 m0, s63, 3840
  v_mfma_f32_16x16x32_bf16 v[124:127], v[132:135], a[204:207], v[124:127]
  buffer_load_dwordx4 v9, s[48:51], s54 offen offset:256 lds
  s_add_u32 m0, s63, 4800
  s_waitcnt lgkmcnt(4)
  v_mfma_f32_16x16x32_bf16 v[96:99], v[136:139], a[208:211], v[96:99]
  ds_read_b128 v[128:131], v12 offset:0
  v_mfma_f32_16x16x32_bf16 v[100:103], v[136:139], a[212:215], v[100:103]
  ds_read_b128 v[132:135], v12 offset:16384
  v_mfma_f32_16x16x32_bf16 v[104:107], v[136:139], a[216:219], v[104:107]
  buffer_load_dwordx4 v9, s[48:51], s54 offen offset:320 lds
  s_add_u32 m0, s63, 5760
  v_mfma_f32_16x16x32_bf16 v[108:111], v[136:139], a[220:223], v[108:111]
  buffer_load_dwordx4 v9, s[48:51], s54 offen offset:384 lds
  s_add_u32 m0, s63, 6720
  v_mfma_f32_16x16x32_bf16 v[112:115], v[140:143], a[208:211], v[112:115]
  buffer_load_dwordx4 v9, s[48:51], s54 offen offset:448 lds
  s_add_u32 s54, s54, 0x8000
  v_mfma_f32_16x16x32_bf16 v[116:119], v[140:143], a[212:215], v[116:119]
  v_mfma_f32_16x16x32_bf16 v[120:123], v[140:143], a[216:219], v[120:123]
  v_mfma_f32_16x16x32_bf16 v[124:127], v[140:143], a[220:223], v[124:127]
  s_waitcnt lgkmcnt(4)
  v_mfma_f32_16x16x32_bf16 v[96:99], v[144:147], a[224:227], v[96:99]
  ds_read_b128 v[136:139], v12 offset:1024
  v_mfma_f32_16x16x32_bf16 v[100:103], v[144:147], a[228:231], v[100:103]
  ds_read_b128 v[140:143], v12 offset:17408
  v_mfma_f32_16x16x32_bf16 v[104:107], v[144:147], a[232:235], v[104:107]
  v_mfma_f32_16x16x32_bf16 v[108:111], v[144:147], a[236:239], v[108:111]
  v_mfma_f32_16x16x32_bf16 v[112:115], v[148:151], a[224:227], v[112:115]
  v_mfma_f32_16x16x32_bf16 v[116:119], v[148:151], a[228:231], v[116:119]
  v_mfma_f32_16x16x32_bf16 v[120:123], v[148:151], a[232:235], v[120:123]
  v_mfma_f32_16x16x32_bf16 v[124:127], v[148:151], a[236:239], v[124:127]
  s_waitcnt lgkmcnt(4)
  v_mfma_f32_16x16x32_bf16 v[96:99], v[152:155], a[240:243], v[96:99]
  ds_read_b128 v[144:147], v12 offset:2048
  v_mfma_f32_16x16x32_bf16 v[100:103], v[152:155], a[244:247], v[100:103]
  ds_read_b128 v[148:151], v12 offset:18432
  v_mfma_f32_16x16x32_bf16 v[104:107], v[152:155], a[248:251], v[104:107]
  v_mov_b32 v11, v12
  v_mfma_f32_16x16x32_bf16 v[108:111], v[152:155], a[252:255], v[108:111]
  s_add_u32 s63, s62, s61
  v_mfma_f32_16x16x32_bf16 v[112:115], v[156:159], a[240:243], v[112:115]
  v_mov_b32 v14, s63
  v_mfma_f32_16x16x32_bf16 v[116:119], v[156:159], a[244:247], v[116:119]
  s_waitcnt vmcnt(8)
  global_store_dword v13, v14, s[26:27] sc1
  v_mfma_f32_16x16x32_bf16 v[120:123], v[156:159], a[248:251], v[120:123]
  v_mfma_f32_16x16x32_bf16 v[124:127], v[156:159], a[252:255], v[124:127]
  s_cmp_lt_u32 s61, 16
  s_cbranch_scc1 g1l_49
  s_nop 7
  v_cvt_pk_bf16_f32 v160, v96, v97
  v_cvt_pk_bf16_f32 v161, v98, v99
  v_cvt_pk_bf16_f32 v162, v112, v113
  v_cvt_pk_bf16_f32 v163, v114, v115
  global_store_dwordx4 v4, v[160:163], s[46:47] sc1
  v_cvt_pk_bf16_f32 v164, v100, v101
  v_cvt_pk_bf16_f32 v165, v102, v103
  v_cvt_pk_bf16_f32 v166, v116, v117
  v_cvt_pk_bf16_f32 v167, v118, v119
  global_store_dwordx4 v5, v[164:167], s[46:47] sc1
  v_cvt_pk_bf16_f32 v168, v104, v105
  v_cvt_pk_bf16_f32 v169, v106, v107
  v_cvt_pk_bf16_f32 v170, v120, v121
  v_cvt_pk_bf16_f32 v171, v122, v123
  global_store_dwordx4 v6, v[168:171], s[46:47] sc1
  v_cvt_pk_bf16_f32 v172, v108, v109
  v_cvt_pk_bf16_f32 v173, v110, v111
  v_cvt_pk_bf16_f32 v174, v124, v125
  v_cvt_pk_bf16_f32 v175, v126, v127
  global_store_dwordx4 v7, v[172:175], s[46:47] sc1
  s_add_u32 s46, s46, s43
  s_addc_u32 s47, s47, 0
  s_mov_b32 s43, s42
  s_waitcnt vmcnt(0) lgkmcnt(0)
  s_add_u32 s63, s62, 17
  v_mov_b32 v14, s63
  global_store_dword v13, v14, s[26:27] sc1
  s_branch k_g1d
k_g1d:
  s_lshl_b32 s30, s30, 7
  s_add_u32 s30, s30, 21504
  s_cmp_ge_u32 s31, 48
  s_cselect_b32 s31, 22016, s30
  s_waitcnt vmcnt(0)
  s_barrier
  s_cmp_lg_u32 s28, 0
  s_cbranch_scc1 sg_53
  s_add_u32 s30, s31, 89128960
  v_mov_b32 v4, s30
  v_mov_b32 v5, 1
  s_mov_b64 exec, 1
  global_atomic_add v4, v5, s[26:27] sc1
  s_mov_b64 exec, -1
sg_53:
  s_branch k_worker
k_w2:
  v_mov_b32 v6, 163824
  s_cmp_lg_u32 s28, 0
  s_cbranch_scc1 bc_54
  s_mov_b64 exec, 1
  v_mov_b32 v7, 0
  global_load_ushort v4, v7, s[24:25] sc1
  s_waitcnt vmcnt(0)
  v_readfirstlane_b32 s30, v4
  s_cmp_ge_u32 s30, 32
  s_cbranch_scc1 rs_55
  v_mov_b32 v5, 0x10001
  global_atomic_add v4, v7, v5, s[24:25] sc0 sc1
  s_waitcnt vmcnt(0)
  v_and_b32 v4, 0xffff, v4
rs_55:
  v_mov_b32 v5, s29
  ds_write_b64 v6, v[4:5]
  s_mov_b64 exec, -1
  s_waitcnt lgkmcnt(0)
bc_54:
  s_barrier
  ds_read_b64 v[4:5], v6
  s_waitcnt lgkmcnt(0)
  v_readfirstlane_b32 s29, v4
  v_readfirstlane_b32 s62, v5
  s_barrier
  s_mov_b32 s99, s62
  s_cmp_lt_u32 s29, 32
  s_cbranch_scc1 k_team
k_w3:
  s_mov_b32 s29, s99
  s_cmp_ge_u32 s29, 480
  s_cbranch_scc1 k_roles
  v_mov_b32 v13, 0
  s_mov_b32 s60, 0
sp_56:
  global_load_dword v14, v13, s[24:25] offset:192 sc1
  s_add_u32 s60, s60, 1
  s_waitcnt vmcnt(0)
  v_readfirstlane_b32 s62, v14
  s_cmp_lg_u32 s62, 0
  s_cbranch_scc1 sp_57
  s_cmp_ge_u32 s60, 400000
  s_cbranch_scc1 k_end
  s_sleep 2
  s_branch sp_56
sp_57:
  v_mov_b32 v13, 22016
  v_add_u32 v13, 89128960, v13
  s_mov_b32 s60, 0
sp_58:
  global_load_dword v14, v13, s[26:27] sc1
  s_add_u32 s60, s60, 1
  s_waitcnt vmcnt(0)
  v_readfirstlane_b32 s62, v14
  s_cmp_ge_u32 s62, 32
  s_cbranch_scc1 sp_59
  s_cmp_ge_u32 s60, 400000
  s_cbranch_scc1 k_end
  s_sleep 2
  s_branch sp_58
sp_59:
  s_sub_u32 s29, s29, 224
  s_and_b32 s30, s29, 31
  s_lshl_b32 s30, s30, 3
  s_lshr_b32 s29, s29, 5
  s_add_u32 s29, s29, s30
  s_lshr_b32 s30, s29, 3
  s_and_b32 s31, s29, 7
  s_lshl_b32 s31, s31, 8
  s_lshl_b32 s32, s28, 6
  s_add_u32 s31, s31, s32
  s_lshl_b32 s33, s30, 16
  s_add_u32 s34, s33, 73400320
  s_add_u32 s35, s33, 75497472
  s_add_u32 s33, s33, 71303168
  v_and_b32 v4, 31, v1
  v_lshrrev_b32 v5, 5, v1
  v_and_b32 v6, 7, v4
  v_bfe_u32 v7, v4, 3, 1
  v_lshl_add_u32 v6, v7, 4, v6
  v_lshrrev_b32 v7, 4, v4
  v_lshl_add_u32 v6, v7, 3, v6
  v_lshlrev_b32 v6, 5, v6
  v_lshl_add_u32 v6, v5, 4, v6
  v_lshlrev_b32 v7, 4, v1
  v_add_u32 v8, s31, v4
  v_lshlrev_b32 v9, 5, v8
  v_lshl_add_u32 v9, v5, 4, v9
  v_lshlrev_b32 v10, 2, v8
  s_lshl_b32 s32, s28, 10
  s_add_u32 s34, s34, s32
  s_add_u32 s35, s35, s32
  s_barrier
  s_mov_b32 s36, s26
  s_mov_b32 s37, s27
  s_mov_b32 s38, 268435456
  s_mov_b32 s39, 0x20000
  s_add_u32 s40, s26, s33
  s_addc_u32 s41, s27, 0
  s_add_u32 s42, s26, 85983232
  s_addc_u32 s43, s27, 0
  global_load_dwordx4 v[16:19], v9, s[40:41] sc1
  global_load_dwordx4 v[20:23], v9, s[40:41] offset:1024 sc1
  global_load_dword v12, v10, s[42:43] sc1
  global_load_dword v13, v10, s[42:43] offset:128 sc1
  s_add_u32 m0, s32, 0
  s_nop 0
  buffer_load_dwordx4 v6, s[36:39], s34 offen sc1 lds
  s_add_u32 m0, s32, 65536
  s_add_u32 s34, s34, 4096
  buffer_load_dwordx4 v7, s[36:39], s35 offen sc1 lds
  s_add_u32 s35, s35, 4096
  s_add_u32 m0, s32, 4096
  s_nop 0
  buffer_load_dwordx4 v6, s[36:39], s34 offen sc1 lds
  s_add_u32 m0, s32, 69632
  s_add_u32 s34, s34, 4096
  buffer_load_dwordx4 v7, s[36:39], s35 offen sc1 lds
  s_add_u32 s35, s35, 4096
  s_add_u32 m0, s32, 8192
  s_nop 0
  buffer_load_dwordx4 v6, s[36:39], s34 offen sc1 lds
  s_add_u32 m0, s32, 73728
  s_add_u32 s34, s34, 4096
  buffer_load_dwordx4 v7, s[36:39], s35 offen sc1 lds
  s_add_u32 s35, s35, 4096
  s_add_u32 m0, s32, 12288
  s_nop 0
  buffer_load_dwordx4 v6, s[36:39], s34 offen sc1 lds
  s_add_u32 m0, s32, 77824
  s_add_u32 s34, s34, 4096
  buffer_load_dwordx4 v7, s[36:39], s35 offen sc1 lds
  s_add_u32 s35, s35, 4096
  s_add_u32 m0, s32, 16384
  s_nop 0
  buffer_load_dwordx4 v6, s[36:39], s34 offen sc1 lds
  s_add_u32 m0, s32, 81920
  s_add_u32 s34, s34, 4096
  buffer_load_dwordx4 v7, s[36:39], s35 offen sc1 lds
  s_add_u32 s35, s35, 4096
  s_add_u32 m0, s32, 20480
  s_nop 0
  buffer_load_dwordx4 v6, s[36:39], s34 offen sc1 lds
  s_add_u32 m0, s32, 86016
  s_add_u32 s34, s34, 4096
  buffer_load_dwordx4 v7, s[36:39], s35 offen sc1 lds
  s_add_u32 s35, s35, 4096
  s_add_u32 m0, s32, 24576
  s_nop 0
  buffer_load_dwordx4 v6, s[36:39], s34 offen sc1 lds
  s_add_u32 m0, s32, 90112
  s_add_u32 s34, s34, 4096
  buffer_load_dwordx4 v7, s[36:39], s35 offen sc1 lds
  s_add_u32 s35, s35, 4096
  s_add_u32 m0, s32, 28672
  s_nop 0
  buffer_load_dwordx4 v6, s[36:39], s34 offen sc1 lds
  s_add_u32 m0, s32, 94208
  s_add_u32 s34, s34, 4096
  buffer_load_dwordx4 v7, s[36:39], s35 offen sc1 lds
  s_add_u32 s35, s35, 4096
  s_add_u32 m0, s32, 32768
  s_nop 0
  buffer_load_dwordx4 v6, s[36:39], s34 offen sc1 lds
  s_add_u32 m0, s32, 98304
  s_add_u32 s34, s34, 4096
  buffer_load_dwordx4 v7, s[36:39], s35 offen sc1 lds
  s_add_u32 s35, s35, 4096
  s_add_u32 m0, s32, 36864
  s_nop 0
  buffer_load_dwordx4 v6, s[36:39], s34 offen sc1 lds
  s_add_u32 m0, s32, 102400
  s_add_u32 s34, s34, 4096
  buffer_load_dwordx4 v7, s[36:39], s35 offen sc1 lds
  s_add_u32 s35, s35, 4096
  s_add_u32 m0, s32, 40960
  s_nop 0
  buffer_load_dwordx4 v6, s[36:39], s34 offen sc1 lds
  s_add_u32 m0, s32, 106496
  s_add_u32 s34, s34, 4096
  buffer_load_dwordx4 v7, s[36:39], s35 offen sc1 lds
  s_add_u32 s35, s35, 4096
  s_add_u32 m0, s32, 45056
  s_nop 0
  buffer_load_dwordx4 v6, s[36:39], s34 offen sc1 lds
  s_add_u32 m0, s32, 110592
  s_add_u32 s34, s34, 4096
  buffer_load_dwordx4 v7, s[36:39], s35 offen sc1 lds
  s_add_u32 s35, s35, 4096
  s_add_u32 m0, s32, 49152
  s_nop 0
  buffer_load_dwordx4 v6, s[36:39], s34 offen sc1 lds
  s_add_u32 m0, s32, 114688
  s_add_u32 s34, s34, 4096
  buffer_load_dwordx4 v7, s[36:39], s35 offen sc1 lds
  s_add_u32 s35, s35, 4096
  s_add_u32 m0, s32, 53248
  s_nop 0
  buffer_load_dwordx4 v6, s[36:39], s34 offen sc1 lds
  s_add_u32 m0, s32, 118784
  s_add_u32 s34, s34, 4096
  buffer_load_dwordx4 v7, s[36:39], s35 offen sc1 lds
  s_add_u32 s35, s35, 4096
  s_add_u32 m0, s32, 57344
  s_nop 0
  buffer_load_dwordx4 v6, s[36:39], s34 offen sc1 lds
  s_add_u32 m0, s32, 122880
  s_add_u32 s34, s34, 4096
  buffer_load_dwordx4 v7, s[36:39], s35 offen sc1 lds
  s_add_u32 s35, s35, 4096
  s_add_u32 m0, s32, 61440
  s_nop 0
  buffer_load_dwordx4 v6, s[36:39], s34 offen sc1 lds
  s_add_u32 m0, s32, 126976
  s_add_u32 s34, s34, 4096
  buffer_load_dwordx4 v7, s[36:39], s35 offen sc1 lds
  s_add_u32 s35, s35, 4096
  v_lshlrev_b32 v14, 8, v5
  v_and_b32 v15, 15, v1
  v_lshl_add_u32 v14, v15, 4, v14
  v_add_u32 v14, 0x10000, v14
  s_mov_b32 s44, 0xffff
  s_mov_b32 s45, 0xffff
  s_mov_b32 s46, 0x41200000
  v_mov_b32 v152, 0x3f803f80
  v_mov_b32 v153, 0x3f803f80
  v_mov_b32 v154, 0x3f803f80
  v_mov_b32 v155, 0x3f803f80
  v_mov_b32 v156, 0x3f803f80
  v_mov_b32 v157, 0x3f803f80
  v_mov_b32 v158, 0x3f803f80
  v_mov_b32 v159, 0x3f803f80
  v_mov_b32 v160, 0x3f803f80
  v_mov_b32 v161, 0x3f803f80
  v_mov_b32 v162, 0x3f803f80
  v_mov_b32 v163, 0x3f803f80
  v_mov_b32 v164, 0x3f803f80
  v_mov_b32 v165, 0x3f803f80
  v_mov_b32 v166, 0x3f803f80
  v_mov_b32 v167, 0x3f803f80
  v_mov_b32 v96, 0
  v_mov_b32 v97, 0
  v_mov_b32 v98, 0
  v_mov_b32 v99, 0
  v_mov_b32 v100, 0
  v_mov_b32 v101, 0
  v_mov_b32 v102, 0
  v_mov_b32 v103, 0
  v_mov_b32 v104, 0
  v_mov_b32 v105, 0
  v_mov_b32 v106, 0
  v_mov_b32 v107, 0
  v_mov_b32 v108, 0
  v_mov_b32 v109, 0
  v_mov_b32 v110, 0
  v_mov_b32 v111, 0
  v_mov_b32 v112, 0
  v_mov_b32 v113, 0
  v_mov_b32 v114, 0
  v_mov_b32 v115, 0
  v_mov_b32 v116, 0
  v_mov_b32 v117, 0
  v_mov_b32 v118, 0
  v_mov_b32 v119, 0
  v_mov_b32 v120, 0
  v_mov_b32 v121, 0
  v_mov_b32 v122, 0
  v_mov_b32 v123, 0
  v_mov_b32 v124, 0
  v_mov_b32 v125, 0
  v_mov_b32 v126, 0
  v_mov_b32 v127, 0
  s_waitcnt vmcnt(0)
  s_barrier
  ds_read_b128 v[144:147], v7 offset:0
  s_mov_b64 exec, s[44:45]
  ds_read_b128 v[152:155], v14 offset:0
  ds_read_b128 v[156:159], v14 offset:512
  s_mov_b64 exec, -1
  s_waitcnt lgkmcnt(0)
  v_mfma_f32_32x32x16_bf16 v[64:79], v[144:147], v[16:19], 0
  v_mfma_f32_32x32x16_bf16 v[80:95], v[144:147], v[20:23], 0
  s_nop 7
  s_nop 7
  v_max3_f32 v15, v64, v65, v66
  v_max3_f32 v15, v15, v67, v68
  v_max3_f32 v15, v15, v69, v70
  v_max3_f32 v15, v15, v71, v72
  v_max3_f32 v15, v15, v73, v74
  v_max3_f32 v15, v15, v75, v76
  v_max3_f32 v15, v15, v77, v78
  v_max_f32 v15, v15, v79
  v_mov_b32 v11, v15
  s_nop 1
  v_permlane32_swap_b32 v11, v15
  v_max_f32 v15, v11, v15
  v_sub_f32 v32, 0, v15
  v_sub_f32 v33, 0, v15
  v_sub_f32 v34, 0, v15
  v_sub_f32 v35, 0, v15
  v_sub_f32 v36, 0, v15
  v_sub_f32 v37, 0, v15
  v_sub_f32 v38, 0, v15
  v_sub_f32 v39, 0, v15
  v_sub_f32 v40, 0, v15
  v_sub_f32 v41, 0, v15
  v_sub_f32 v42, 0, v15
  v_sub_f32 v43, 0, v15
  v_sub_f32 v44, 0, v15
  v_sub_f32 v45, 0, v15
  v_sub_f32 v46, 0, v15
  v_sub_f32 v47, 0, v15
  v_max3_f32 v15, v80, v81, v82
  v_max3_f32 v15, v15, v83, v84
  v_max3_f32 v15, v15, v85, v86
  v_max3_f32 v15, v15, v87, v88
  v_max3_f32 v15, v15, v89, v90
  v_max3_f32 v15, v15, v91, v92
  v_max3_f32 v15, v15, v93, v94
  v_max_f32 v15, v15, v95
  v_mov_b32 v11, v15
  s_nop 1
  v_permlane32_swap_b32 v11, v15
  v_max_f32 v15, v11, v15
  v_sub_f32 v48, 0, v15
  v_sub_f32 v49, 0, v15
  v_sub_f32 v50, 0, v15
  v_sub_f32 v51, 0, v15
  v_sub_f32 v52, 0, v15
  v_sub_f32 v53, 0, v15
  v_sub_f32 v54, 0, v15
  v_sub_f32 v55, 0, v15
  v_sub_f32 v56, 0, v15
  v_sub_f32 v57, 0, v15
  v_sub_f32 v58, 0, v15
  v_sub_f32 v59, 0, v15
  v_sub_f32 v60, 0, v15
  v_sub_f32 v61, 0, v15
  v_sub_f32 v62, 0, v15
  v_sub_f32 v63, 0, v15
  s_nop 1
  v_mfma_f32_32x32x16_bf16 v[64:79], v[144:147], v[16:19], v[32:47]
  s_mov_b32 s47, 0
  s_nop 7
  s_nop 7
aal_60:
  v_mfma_f32_32x32x16_bf16 v[80:95], v[144:147], v[20:23], v[48:63]
  ds_read_b128 v[148:151], v7 offset:1024
  v_max3_f32 v15, v64, v65, v66
  v_max3_f32 v15, v15, v67, v68
  v_max3_f32 v15, v15, v69, v70
  v_max3_f32 v15, v15, v71, v72
  v_max3_f32 v15, v15, v73, v74
  v_max3_f32 v15, v15, v75, v76
  v_max3_f32 v15, v15, v77, v78
  v_max_f32 v15, v15, v79
  v_cmp_lt_f32 vcc, s46, v15
  s_mov_b64 exec, s[44:45]
  ds_read_b128 v[160:163], v14 offset:1024
  ds_read_b128 v[164:167], v14 offset:1536
  s_mov_b64 exec, -1
  s_cbranch_vccnz aas_61
aab_62:
  v_exp_f32 v64, v64
  v_exp_f32 v65, v65
  v_exp_f32 v66, v66
  v_exp_f32 v67, v67
  v_exp_f32 v68, v68
  v_exp_f32 v69, v69
  v_exp_f32 v70, v70
  v_exp_f32 v71, v71
  v_cvt_pk_bf16_f32 v128, v64, v65
  v_cvt_pk_bf16_f32 v129, v66, v67
  v_cvt_pk_bf16_f32 v130, v68, v69
  v_cvt_pk_bf16_f32 v131, v70, v71
  v_exp_f32 v72, v72
  v_exp_f32 v73, v73
  v_exp_f32 v74, v74
  v_exp_f32 v75, v75
  v_exp_f32 v76, v76
  v_exp_f32 v77, v77
  v_exp_f32 v78, v78
  v_exp_f32 v79, v79
  v_mfma_f32_32x32x16_bf16 v[96:111], v[152:155], v[128:131], v[96:111]
  v_cvt_pk_bf16_f32 v132, v72, v73
  v_cvt_pk_bf16_f32 v133, v74, v75
  v_cvt_pk_bf16_f32 v134, v76, v77
  v_cvt_pk_bf16_f32 v135, v78, v79
  s_waitcnt lgkmcnt(2)
  v_mfma_f32_32x32x16_bf16 v[64:79], v[148:151], v[16:19], v[32:47]
  v_mfma_f32_32x32x16_bf16 v[96:111], v[156:159], v[132:135], v[96:111]
  v_max3_f32 v15, v80, v81, v82
  v_max3_f32 v15, v15, v83, v84
  v_max3_f32 v15, v15, v85, v86
  v_max3_f32 v15, v15, v87, v88
  v_max3_f32 v15, v15, v89, v90
  v_max3_f32 v15, v15, v91, v92
  v_max3_f32 v15, v15, v93, v94
  v_max_f32 v15, v15, v95
  v_cmp_lt_f32 vcc, s46, v15
  s_nop 0
  s_cbranch_vccnz aas_63
aab_64:
  v_exp_f32 v80, v80
  v_exp_f32 v81, v81
  v_exp_f32 v82, v82
  v_exp_f32 v83, v83
  v_exp_f32 v84, v84
  v_exp_f32 v85, v85
  v_exp_f32 v86, v86
  v_exp_f32 v87, v87
  v_cvt_pk_bf16_f32 v136, v80, v81
  v_cvt_pk_bf16_f32 v137, v82, v83
  v_cvt_pk_bf16_f32 v138, v84, v85
  v_cvt_pk_bf16_f32 v139, v86, v87
  v_exp_f32 v88, v88
  v_exp_f32 v89, v89
  v_exp_f32 v90, v90
  v_exp_f32 v91, v91
  v_exp_f32 v92, v92
  v_exp_f32 v93, v93
  v_exp_f32 v94, v94
  v_exp_f32 v95, v95
  v_mfma_f32_32x32x16_bf16 v[112:127], v[152:155], v[136:139], v[112:127]
  v_cvt_pk_bf16_f32 v140, v88, v89
  v_cvt_pk_bf16_f32 v141, v90, v91
  v_cvt_pk_bf16_f32 v142, v92, v93
  v_cvt_pk_bf16_f32 v143, v94, v95
  s_waitcnt lgkmcnt(0)
  s_nop 0
  v_mfma_f32_32x32x16_bf16 v[112:127], v[156:159], v[140:143], v[112:127]
  v_mfma_f32_32x32x16_bf16 v[80:95], v[148:151], v[20:23], v[48:63]
  ds_read_b128 v[144:147], v7 offset:2048
  v_max3_f32 v15, v64, v65, v66
  v_max3_f32 v15, v15, v67, v68
  v_max3_f32 v15, v15, v69, v70
  v_max3_f32 v15, v15, v71, v72
  v_max3_f32 v15, v15, v73, v74
  v_max3_f32 v15, v15, v75, v76
  v_max3_f32 v15, v15, v77, v78
  v_max_f32 v15, v15, v79
  v_cmp_lt_f32 vcc, s46, v15
  s_mov_b64 exec, s[44:45]
  ds_read_b128 v[152:155], v14 offset:2048
  ds_read_b128 v[156:159], v14 offset:2560
  s_mov_b64 exec, -1
  s_cbranch_vccnz aas_65
aab_66:
  v_exp_f32 v64, v64
  v_exp_f32 v65, v65
  v_exp_f32 v66, v66
  v_exp_f32 v67, v67
  v_exp_f32 v68, v68
  v_exp_f32 v69, v69
  v_exp_f32 v70, v70
  v_exp_f32 v71, v71
  v_cvt_pk_bf16_f32 v128, v64, v65
  v_cvt_pk_bf16_f32 v129, v66, v67
  v_cvt_pk_bf16_f32 v130, v68, v69
  v_cvt_pk_bf16_f32 v131, v70, v71
  v_exp_f32 v72, v72
  v_exp_f32 v73, v73
  v_exp_f32 v74, v74
  v_exp_f32 v75, v75
  v_exp_f32 v76, v76
  v_exp_f32 v77, v77
  v_exp_f32 v78, v78
  v_exp_f32 v79, v79
  v_mfma_f32_32x32x16_bf16 v[96:111], v[160:163], v[128:131], v[96:111]
  v_cvt_pk_bf16_f32 v132, v72, v73
  v_cvt_pk_bf16_f32 v133, v74, v75
  v_cvt_pk_bf16_f32 v134, v76, v77
  v_cvt_pk_bf16_f32 v135, v78, v79
  s_waitcnt lgkmcnt(2)
  v_mfma_f32_32x32x16_bf16 v[64:79], v[144:147], v[16:19], v[32:47]
  v_mfma_f32_32x32x16_bf16 v[96:111], v[164:167], v[132:135], v[96:111]
  v_max3_f32 v15, v80, v81, v82
  v_max3_f32 v15, v15, v83, v84
  v_max3_f32 v15, v15, v85, v86
  v_max3_f32 v15, v15, v87, v88
  v_max3_f32 v15, v15, v89, v90
  v_max3_f32 v15, v15, v91, v92
  v_max3_f32 v15, v15, v93, v94
  v_max_f32 v15, v15, v95
  v_cmp_lt_f32 vcc, s46, v15
  s_nop 0
  s_cbranch_vccnz aas_67
aab_68:
  v_exp_f32 v80, v80
  v_exp_f32 v81, v81
  v_exp_f32 v82, v82
  v_exp_f32 v83, v83
  v_exp_f32 v84, v84
  v_exp_f32 v85, v85
  v_exp_f32 v86, v86
  v_exp_f32 v87, v87
  v_cvt_pk_bf16_f32 v136, v80, v81
  v_cvt_pk_bf16_f32 v137, v82, v83
  v_cvt_pk_bf16_f32 v138, v84, v85
  v_cvt_pk_bf16_f32 v139, v86, v87
  v_exp_f32 v88, v88
  v_exp_f32 v89, v89
  v_exp_f32 v90, v90
  v_exp_f32 v91, v91
  v_exp_f32 v92, v92
  v_exp_f32 v93, v93
  v_exp_f32 v94, v94
  v_exp_f32 v95, v95
  v_mfma_f32_32x32x16_bf16 v[112:127], v[160:163], v[136:139], v[112:127]
  v_cvt_pk_bf16_f32 v140, v88, v89
  v_cvt_pk_bf16_f32 v141, v90, v91
  v_cvt_pk_bf16_f32 v142, v92, v93
  v_cvt_pk_bf16_f32 v143, v94, v95
  s_waitcnt lgkmcnt(0)
  s_nop 0
  v_mfma_f32_32x32x16_bf16 v[112:127], v[164:167], v[140:143], v[112:127]
  v_add_u32 v7, 2048, v7
  v_add_u32 v14, 2048, v14
  s_add_u32 s47, s47, 1
  s_cmp_lt_u32 s47, 32
  s_cbranch_scc1 aal_60
  s_lshr_b32 s32, s30, 1
  s_add_u32 s32, s32, 128
  s_lshl_b32 s32, s32, 10
  s_add_u32 s32, s32, 50331648
  s_and_b32 s33, s30, 1
  s_lshl_b32 s33, s33, 9
  s_add_u32 s32, s32, s33
  v_lshrrev_b32 v9, 4, v8
  s_mov_b32 s33, 147456
  v_mul_lo_u32 v9, v9, s33
  v_lshl_add_u32 v9, v2, 4, v9
  v_lshl_add_u32 v9, v5, 8, v9
  v_add_u32 v10, 294912, v9
  s_nop 7
  s_add_u32 s40, s26, s32
  s_addc_u32 s41, s27, 0
  v_rcp_f32 v15, v104
  s_nop 0
  v_mul_f32 v15, v15, v12
  v_mul_f32 v96, v96, v15
  v_mul_f32 v97, v97, v15
  v_mul_f32 v98, v98, v15
  v_mul_f32 v99, v99, v15
  v_mul_f32 v100, v100, v15
  v_mul_f32 v101, v101, v15
  v_mul_f32 v102, v102, v15
  v_mul_f32 v103, v103, v15
  v_cvt_pk_bf16_f32 v128, v96, v97
  v_cvt_pk_bf16_f32 v129, v98, v99
  v_cvt_pk_bf16_f32 v130, v100, v101
  v_cvt_pk_bf16_f32 v131, v102, v103
  global_store_dwordx4 v9, v[128:131], s[40:41] sc1
  v_rcp_f32 v15, v120
  s_nop 0
  v_mul_f32 v15, v15, v13
  v_mul_f32 v112, v112, v15
  v_mul_f32 v113, v113, v15
  v_mul_f32 v114, v114, v15
  v_mul_f32 v115, v115, v15
  v_mul_f32 v116, v116, v15
  v_mul_f32 v117, v117, v15
  v_mul_f32 v118, v118, v15
  v_mul_f32 v119, v119, v15
  v_cvt_pk_bf16_f32 v136, v112, v113
  v_cvt_pk_bf16_f32 v137, v114, v115
  v_cvt_pk_bf16_f32 v138, v116, v117
  v_cvt_pk_bf16_f32 v139, v118, v119
  global_store_dwordx4 v10, v[136:139], s[40:41] sc1
  s_waitcnt vmcnt(0) lgkmcnt(0)
  s_branch k_ad
aas_61:
  s_nop 7
  s_nop 7
  v_mov_b32 v11, v15
  s_nop 1
  v_permlane32_swap_b32 v11, v15
  v_max_f32 v15, v11, v15
  v_max_f32 v15, 0, v15
  v_sub_f32 v11, 0, v15
  v_exp_f32 v11, v11
  v_sub_f32 v64, v64, v15
  v_sub_f32 v32, v32, v15
  v_mul_f32 v96, v96, v11
  v_sub_f32 v65, v65, v15
  v_sub_f32 v33, v33, v15
  v_mul_f32 v97, v97, v11
  v_sub_f32 v66, v66, v15
  v_sub_f32 v34, v34, v15
  v_mul_f32 v98, v98, v11
  v_sub_f32 v67, v67, v15
  v_sub_f32 v35, v35, v15
  v_mul_f32 v99, v99, v11
  v_sub_f32 v68, v68, v15
  v_sub_f32 v36, v36, v15
  v_mul_f32 v100, v100, v11
  v_sub_f32 v69, v69, v15
  v_sub_f32 v37, v37, v15
  v_mul_f32 v101, v101, v11
  v_sub_f32 v70, v70, v15
  v_sub_f32 v38, v38, v15
  v_mul_f32 v102, v102, v11
  v_sub_f32 v71, v71, v15
  v_sub_f32 v39, v39, v15
  v_mul_f32 v103, v103, v11
  v_sub_f32 v72, v72, v15
  v_sub_f32 v40, v40, v15
  v_mul_f32 v104, v104, v11
  v_sub_f32 v73, v73, v15
  v_sub_f32 v41, v41, v15
  v_mul_f32 v105, v105, v11
  v_sub_f32 v74, v74, v15
  v_sub_f32 v42, v42, v15
  v_mul_f32 v106, v106, v11
  v_sub_f32 v75, v75, v15
  v_sub_f32 v43, v43, v15
  v_mul_f32 v107, v107, v11
  v_sub_f32 v76, v76, v15
  v_sub_f32 v44, v44, v15
  v_mul_f32 v108, v108, v11
  v_sub_f32 v77, v77, v15
  v_sub_f32 v45, v45, v15
  v_mul_f32 v109, v109, v11
  v_sub_f32 v78, v78, v15
  v_sub_f32 v46, v46, v15
  v_mul_f32 v110, v110, v11
  v_sub_f32 v79, v79, v15
  v_sub_f32 v47, v47, v15
  v_mul_f32 v111, v111, v11
  s_branch aab_62
aas_63:
  s_nop 7
  s_nop 7
  v_mov_b32 v11, v15
  s_nop 1
  v_permlane32_swap_b32 v11, v15
  v_max_f32 v15, v11, v15
  v_max_f32 v15, 0, v15
  v_sub_f32 v11, 0, v15
  v_exp_f32 v11, v11
  v_sub_f32 v80, v80, v15
  v_sub_f32 v48, v48, v15
  v_mul_f32 v112, v112, v11
  v_sub_f32 v81, v81, v15
  v_sub_f32 v49, v49, v15
  v_mul_f32 v113, v113, v11
  v_sub_f32 v82, v82, v15
  v_sub_f32 v50, v50, v15
  v_mul_f32 v114, v114, v11
  v_sub_f32 v83, v83, v15
  v_sub_f32 v51, v51, v15
  v_mul_f32 v115, v115, v11
  v_sub_f32 v84, v84, v15
  v_sub_f32 v52, v52, v15
  v_mul_f32 v116, v116, v11
  v_sub_f32 v85, v85, v15
  v_sub_f32 v53, v53, v15
  v_mul_f32 v117, v117, v11
  v_sub_f32 v86, v86, v15
  v_sub_f32 v54, v54, v15
  v_mul_f32 v118, v118, v11
  v_sub_f32 v87, v87, v15
  v_sub_f32 v55, v55, v15
  v_mul_f32 v119, v119, v11
  v_sub_f32 v88, v88, v15
  v_sub_f32 v56, v56, v15
  v_mul_f32 v120, v120, v11
  v_sub_f32 v89, v89, v15
  v_sub_f32 v57, v57, v15
  v_mul_f32 v121, v121, v11
  v_sub_f32 v90, v90, v15
  v_sub_f32 v58, v58, v15
  v_mul_f32 v122, v122, v11
  v_sub_f32 v91, v91, v15
  v_sub_f32 v59, v59, v15
  v_mul_f32 v123, v123, v11
  v_sub_f32 v92, v92, v15
  v_sub_f32 v60, v60, v15
  v_mul_f32 v124, v124, v11
  v_sub_f32 v93, v93, v15
  v_sub_f32 v61, v61, v15
  v_mul_f32 v125, v125, v11
  v_sub_f32 v94, v94, v15
  v_sub_f32 v62, v62, v15
  v_mul_f32 v126, v126, v11
  v_sub_f32 v95, v95, v15
  v_sub_f32 v63, v63, v15
  v_mul_f32 v127, v127, v11
  s_branch aab_64
aas_65:
  s_nop 7
  s_nop 7
  v_mov_b32 v11, v15
  s_nop 1
  v_permlane32_swap_b32 v11, v15
  v_max_f32 v15, v11, v15
  v_max_f32 v15, 0, v15
  v_sub_f32 v11, 0, v15
  v_exp_f32 v11, v11
  v_sub_f32 v64, v64, v15
  v_sub_f32 v32, v32, v15
  v_mul_f32 v96, v96, v11
  v_sub_f32 v65, v65, v15
  v_sub_f32 v33, v33, v15
  v_mul_f32 v97, v97, v11
  v_sub_f32 v66, v66, v15
  v_sub_f32 v34, v34, v15
  v_mul_f32 v98, v98, v11
  v_sub_f32 v67, v67, v15
  v_sub_f32 v35, v35, v15
  v_mul_f32 v99, v99, v11
  v_sub_f32 v68, v68, v15
  v_sub_f32 v36, v36, v15
  v_mul_f32 v100, v100, v11
  v_sub_f32 v69, v69, v15
  v_sub_f32 v37, v37, v15
  v_mul_f32 v101, v101, v11
  v_sub_f32 v70, v70, v15
  v_sub_f32 v38, v38, v15
  v_mul_f32 v102, v102, v11
  v_sub_f32 v71, v71, v15
  v_sub_f32 v39, v39, v15
  v_mul_f32 v103, v103, v11
  v_sub_f32 v72, v72, v15
  v_sub_f32 v40, v40, v15
  v_mul_f32 v104, v104, v11
  v_sub_f32 v73, v73, v15
  v_sub_f32 v41, v41, v15
  v_mul_f32 v105, v105, v11
  v_sub_f32 v74, v74, v15
  v_sub_f32 v42, v42, v15
  v_mul_f32 v106, v106, v11
  v_sub_f32 v75, v75, v15
  v_sub_f32 v43, v43, v15
  v_mul_f32 v107, v107, v11
  v_sub_f32 v76, v76, v15
  v_sub_f32 v44, v44, v15
  v_mul_f32 v108, v108, v11
  v_sub_f32 v77, v77, v15
  v_sub_f32 v45, v45, v15
  v_mul_f32 v109, v109, v11
  v_sub_f32 v78, v78, v15
  v_sub_f32 v46, v46, v15
  v_mul_f32 v110, v110, v11
  v_sub_f32 v79, v79, v15
  v_sub_f32 v47, v47, v15
  v_mul_f32 v111, v111, v11
  s_branch aab_66
aas_67:
  s_nop 7
  s_nop 7
  v_mov_b32 v11, v15
  s_nop 1
  v_permlane32_swap_b32 v11, v15
  v_max_f32 v15, v11, v15
  v_max_f32 v15, 0, v15
  v_sub_f32 v11, 0, v15
  v_exp_f32 v11, v11
  v_sub_f32 v80, v80, v15
  v_sub_f32 v48, v48, v15
  v_mul_f32 v112, v112, v11
  v_sub_f32 v81, v81, v15
  v_sub_f32 v49, v49, v15
  v_mul_f32 v113, v113, v11
  v_sub_f32 v82, v82, v15
  v_sub_f32 v50, v50, v15
  v_mul_f32 v114, v114, v11
  v_sub_f32 v83, v83, v15
  v_sub_f32 v51, v51, v15
  v_mul_f32 v115, v115, v11
  v_sub_f32 v84, v84, v15
  v_sub_f32 v52, v52, v15
  v_mul_f32 v116, v116, v11
  v_sub_f32 v85, v85, v15
  v_sub_f32 v53, v53, v15
  v_mul_f32 v117, v117, v11
  v_sub_f32 v86, v86, v15
  v_sub_f32 v54, v54, v15
  v_mul_f32 v118, v118, v11
  v_sub_f32 v87, v87, v15
  v_sub_f32 v55, v55, v15
  v_mul_f32 v119, v119, v11
  v_sub_f32 v88, v88, v15
  v_sub_f32 v56, v56, v15
  v_mul_f32 v120, v120, v11
  v_sub_f32 v89, v89, v15
  v_sub_f32 v57, v57, v15
  v_mul_f32 v121, v121, v11
  v_sub_f32 v90, v90, v15
  v_sub_f32 v58, v58, v15
  v_mul_f32 v122, v122, v11
  v_sub_f32 v91, v91, v15
  v_sub_f32 v59, v59, v15
  v_mul_f32 v123, v123, v11
  v_sub_f32 v92, v92, v15
  v_sub_f32 v60, v60, v15
  v_mul_f32 v124, v124, v11
  v_sub_f32 v93, v93, v15
  v_sub_f32 v61, v61, v15
  v_mul_f32 v125, v125, v11
  v_sub_f32 v94, v94, v15
  v_sub_f32 v62, v62, v15
  v_mul_f32 v126, v126, v11
  v_sub_f32 v95, v95, v15
  v_sub_f32 v63, v63, v15
  v_mul_f32 v127, v127, v11
  s_branch aab_68
k_ad:
  s_and_b32 s49, s29, 7
  s_lshl_b32 s49, s49, 7
  s_add_u32 s49, s49, 20480
  v_mov_b32 v6, 163824
  s_cmp_lg_u32 s28, 0
  s_cbranch_scc1 bc_69
  s_mov_b64 exec, 1
  v_mov_b32 v4, 0xffff
  s_sub_u32 s30, s3, 1
  s_cbranch_scc1 hm_70
  s_lshl_b32 s31, s30, 7
  s_add_u32 s31, s31, 89151488
  v_mov_b32 v8, s31
  v_mov_b32 v9, 1
  v_mov_b32 v5, s30
  global_atomic_add v4, v8, v9, s[26:27] sc0 sc1
  s_waitcnt vmcnt(0)
  v_and_b32 v4, 0xffff, v4
hm_70:
  ds_write_b64 v6, v[4:5]
  s_mov_b64 exec, -1
  s_waitcnt lgkmcnt(0)
bc_69:
  s_barrier
  ds_read_b64 v[4:5], v6
  s_waitcnt lgkmcnt(0)
  v_readfirstlane_b32 s29, v4
  v_readfirstlane_b32 s62, v5
  s_barrier
  s_waitcnt vmcnt(0)
  s_barrier
  s_cmp_lg_u32 s28, 0
  s_cbranch_scc1 sg_71
  s_add_u32 s30, s49, 89128960
  v_mov_b32 v4, s30
  v_mov_b32 v5, 1
  s_mov_b64 exec, 1
  global_atomic_add v4, v5, s[26:27] sc1
  s_mov_b64 exec, -1
sg_71:
  s_cmp_lt_u32 s29, 24
  s_cbranch_scc1 k_have
  s_branch k_worker
k_roles:
  v_mov_b32 v13, 0
  s_mov_b32 s60, 0
sp_72:
  global_load_dword v14, v13, s[24:25] offset:192 sc1
  s_add_u32 s60, s60, 1
  s_waitcnt vmcnt(0)
  v_readfirstlane_b32 s62, v14
  s_cmp_lg_u32 s62, 0
  s_cbranch_scc1 sp_73
  s_cmp_ge_u32 s60, 400000
  s_cbranch_scc1 k_end
  s_sleep 2
  s_branch sp_72
sp_73:
  v_mov_b32 v6, 163824
  s_cmp_lg_u32 s28, 0
  s_cbranch_scc1 bc_74
  s_mov_b64 exec, 1
  v_mov_b32 v4, 0xffff
  s_sub_u32 s30, s3, 1
  s_cbranch_scc1 hm_77
  s_lshl_b32 s31, s30, 7
  s_add_u32 s31, s31, 89151488
  v_mov_b32 v8, s31
  v_mov_b32 v9, 1
  v_mov_b32 v5, s30
  global_atomic_add v4, v8, v9, s[26:27] sc0 sc1
  s_waitcnt vmcnt(0)
  v_and_b32 v4, 0xffff, v4
hm_77:
  s_nop 1
  v_readfirstlane_b32 s30, v4
  s_cmp_lt_u32 s30, 24
  s_cbranch_scc1 pk_76
  s_mov_b64 exec, 0xffff
  s_mov_b32 s63, 0
  v_subrev_u32 v14, 8, v2
  v_min_u32 v14, 6, v14
  v_add_u32 v14, 16, v14
  v_cmp_gt_u32 vcc, 8, v2
  v_mov_b32 v9, 24
  v_cndmask_b32 v14, v14, v2, vcc
  v_cndmask_b32_e64 v9, v9, 32, vcc
  v_lshlrev_b32 v14, 7, v14
  v_add_u32 v15, 89149440, v14
pk_75:
  s_mov_b64 exec, 0xffff
  v_mov_b32 v4, 0xffff
  s_mov_b32 s61, 0
sp_78:
  global_load_dword v14, v15, s[26:27] sc1
  s_add_u32 s61, s61, 1
  s_waitcnt vmcnt(0)
  v_and_b32 v13, 0xffff, v14
  v_cmp_ge_u32 vcc, v13, v9
  s_add_u32 s30, s63, 8
  v_readlane_b32 s55, v14, s30
  s_and_b32 s54, vcc_lo, 0xffff
  s_cmp_ge_u32 s54, 0xff00
  s_cbranch_scc1 pk_76
  s_and_b32 s30, s54, 0xff
  s_cmp_eq_u32 s30, 0xff
  s_cbranch_scc1 sp_79
  s_cmp_ge_u32 s61, 400000
  s_cbranch_scc1 pk_76
  s_sleep 2
  s_branch sp_78
sp_79:
  s_lshr_b32 s31, s54, 8
  s_ff0_i32_b32 s31, s31
  s_add_u32 s30, s31, 8
  v_readlane_b32 s32, v15, s30
  s_mov_b64 exec, 1
  v_mov_b32 v7, 0x10001
  v_mov_b32 v8, s32
  v_mov_b32 v5, s31
  global_atomic_add v4, v8, v7, s[26:27] sc0 sc1
  s_waitcnt vmcnt(0)
  v_and_b32 v4, 0xffff, v4
  s_nop 1
  v_readfirstlane_b32 s32, v4
  s_cmp_ge_u32 s32, 24
  s_cbranch_scc1 pk_75
pk_76:
  s_mov_b64 exec, 1
  ds_write_b64 v6, v[4:5]
  s_mov_b64 exec, -1
  s_waitcnt lgkmcnt(0)
bc_74:
  s_barrier
  ds_read_b64 v[4:5], v6
  s_waitcnt lgkmcnt(0)
  v_readfirstlane_b32 s29, v4
  v_readfirstlane_b32 s62, v5
  s_barrier
  s_cmp_ge_u32 s29, 24
  s_cbranch_scc1 k_end
k_have:
  v_mbcnt_lo_u32_b32 v1, -1, 0
  v_mbcnt_hi_u32_b32 v1, -1, v1
  v_and_b32 v2, 15, v1
  v_lshrrev_b32 v3, 4, v1
  s_mov_b32 s50, s62
  s_mov_b32 s63, s62
  s_cmp_ge_u32 s29, 8
  s_cbranch_scc1 k_orole
  v_lshlrev_b32 v4, 4, v1
  v_lshrrev_b32 v5, 2, v2
  v_lshlrev_b32 v5, 8, v5
  v_lshl_add_u32 v5, v3, 6, v5
  v_and_b32 v6, 1, v2
  v_lshl_add_u32 v5, v6, 2, v5
  v_lshlrev_b32 v6, 2, v2
  v_lshlrev_b32 v7, 2, v3
  v_mov_b32 v8, 0xf149f2ca
  v_add_u32 v9, 0, v7
  v_cmp_gt_u32 vcc, v9, v2
  s_nop 1
  v_cndmask_b32 v140, 0, v8, vcc
  v_mov_b32 v180, 0x3f803f80
  v_add_u32 v9, 1, v7
  v_cmp_gt_u32 vcc, v9, v2
  s_nop 1
  v_cndmask_b32 v141, 0, v8, vcc
  v_mov_b32 v181, 0x3f803f80
  v_add_u32 v9, 2, v7
  v_cmp_gt_u32 vcc, v9, v2
  s_nop 1
  v_cndmask_b32 v142, 0, v8, vcc
  v_mov_b32 v182, 0x3f803f80
  v_add_u32 v9, 3, v7
  v_cmp_gt_u32 vcc, v9, v2
  s_nop 1
  v_cndmask_b32 v143, 0, v8, vcc
  v_mov_b32 v183, 0x3f803f80
  v_mov_b32 v173, 0
  v_mov_b32 v174, 0
  v_mov_b32 v177, 0
  v_mov_b32 v178, 0
  v_subrev_u32 v14, 8, v2
  v_min_u32 v14, 6, v14
  v_add_u32 v14, 16, v14
  v_cmp_gt_u32 vcc, 8, v2
  v_mov_b32 v9, 24
  v_cndmask_b32 v14, v14, v2, vcc
  v_cndmask_b32_e64 v9, v9, 32, vcc
  v_lshlrev_b32 v14, 7, v14
  v_add_u32 v15, 89149440, v14
  s_lshl_b32 s51, s29, 2
  s_add_u32 s51, s51, s28
  s_mov_b32 s52, -1
  v_mov_b32 v13, 22016
  v_add_u32 v13, 89128960, v13
  s_mov_b32 s60, 0
sp_80:
  global_load_dword v14, v13, s[26:27] sc1
  s_add_u32 s60, s60, 1
  s_waitcnt vmcnt(0)
  v_readfirstlane_b32 s62, v14
  s_cmp_ge_u32 s62, 32
  s_cbranch_scc1 sp_81
  s_cmp_ge_u32 s60, 400000
  s_cbranch_scc1 k_end
  s_sleep 2
  s_branch sp_80
sp_81:
k_xl:
  s_lshr_b32 s30, s50, 4
  s_cmp_eq_u32 s30, s52
  s_cbranch_scc1 k_x1
  s_mov_b32 s52, s30
  s_lshl_b32 s30, s30, 7
  s_add_u32 s30, s30, 21504
  v_mov_b32 v13, s30
  v_add_u32 v13, 89128960, v13
  s_mov_b32 s60, 0
sp_82:
  global_load_dword v14, v13, s[26:27] sc1
  s_add_u32 s60, s60, 1
  s_waitcnt vmcnt(0)
  v_readfirstlane_b32 s62, v14
  s_cmp_ge_u32 s62, 48
  s_cbranch_scc1 sp_83
  s_cmp_ge_u32 s60, 400000
  s_cbranch_scc1 k_end
  s_sleep 2
  s_branch sp_82
sp_83:
k_x1:
  global_load_dword v14, v15, s[26:27] sc1
  s_lshl_b32 s30, s50, 5
  s_add_u32 s30, s30, s51
  s_lshl_b32 s31, s30, 13
  s_add_u32 s32, s31, 4096
  s_add_u32 s33, s31, 16781312
  s_add_u32 s34, s31, 33558528
  s_lshr_b32 s35, s30, 5
  s_lshl_b32 s31, s35, 7
  s_add_u32 s31, s31, 85983232
  s_add_u32 s36, s26, s32
  s_addc_u32 s37, s27, 0
  s_add_u32 s38, s26, s33
  s_addc_u32 s39, s27, 0
  s_add_u32 s40, s26, s34
  s_addc_u32 s41, s27, 0
  s_add_u32 s42, s26, s31
  s_addc_u32 s43, s27, 0
  global_load_dwordx4 v[48:51], v4, s[38:39] offset:-4096 sc1
  global_load_dwordx4 v[16:19], v4, s[36:37] offset:-4096 sc1
  global_load_dwordx4 v[52:55], v4, s[38:39] offset:-3072 sc1
  global_load_dwordx4 v[20:23], v4, s[36:37] offset:-3072 sc1
  global_load_dwordx4 v[56:59], v4, s[38:39] offset:-2048 sc1
  global_load_dwordx4 v[24:27], v4, s[36:37] offset:-2048 sc1
  global_load_dwordx4 v[60:63], v4, s[38:39] offset:-1024 sc1
  global_load_dwordx4 v[28:31], v4, s[36:37] offset:-1024 sc1
  global_load_dwordx4 v[64:67], v4, s[38:39] offset:0 sc1
  global_load_dwordx4 v[32:35], v4, s[36:37] offset:0 sc1
  global_load_dwordx4 v[68:71], v4, s[38:39] offset:1024 sc1
  global_load_dwordx4 v[36:39], v4, s[36:37] offset:1024 sc1
  global_load_dwordx4 v[72:75], v4, s[38:39] offset:2048 sc1
  global_load_dwordx4 v[40:43], v4, s[36:37] offset:2048 sc1
  global_load_dwordx4 v[76:79], v4, s[38:39] offset:3072 sc1
  global_load_dwordx4 v[44:47], v4, s[36:37] offset:3072 sc1
  global_load_dwordx4 v[80:83], v4, s[40:41] offset:-4096 sc1
  global_load_dwordx4 v[84:87], v4, s[40:41] offset:-3072 sc1
  global_load_dwordx4 v[88:91], v4, s[40:41] offset:-2048 sc1
  global_load_dwordx4 v[92:95], v4, s[40:41] offset:-1024 sc1
  global_load_dwordx4 v[96:99], v4, s[40:41] offset:0 sc1
  global_load_dwordx4 v[100:103], v4, s[40:41] offset:1024 sc1
  global_load_dwordx4 v[104:107], v4, s[40:41] offset:2048 sc1
  global_load_dwordx4 v[108:111], v4, s[40:41] offset:3072 sc1
  global_load_dword v136, v6, s[42:43] offset:0 sc1
  global_load_dword v137, v6, s[42:43] offset:64 sc1
  s_lshl_b32 s31, s30, 12
  s_add_u32 s31, s31, 77594624
  s_mul_i32 s32, s35, 294912
  s_and_b32 s33, s30, 31
  s_lshl_b32 s33, s33, 12
  s_add_u32 s32, s32, s33
  s_add_u32 s32, s32, 50331648
  s_add_u32 s33, s32, 147456
  s_add_u32 s44, s26, s31
  s_addc_u32 s45, s27, 0
  s_add_u32 s46, s26, s32
  s_addc_u32 s47, s27, 0
  s_add_u32 s48, s26, s33
  s_addc_u32 s49, s27, 0
  s_waitcnt vmcnt(22)
  v_mfma_f32_16x16x32_bf16 v[144:147], v[48:51], v[16:19], v[140:143]
  v_mfma_f32_16x16x32_bf16 v[148:151], v[48:51], v[20:23], 0
  v_mfma_f32_16x16x32_bf16 v[152:155], v[52:55], v[20:23], v[140:143]
  s_waitcnt vmcnt(18)
  v_mfma_f32_16x16x32_bf16 v[144:147], v[56:59], v[24:27], v[144:147]
  v_mfma_f32_16x16x32_bf16 v[148:151], v[56:59], v[28:31], v[148:151]
  v_mfma_f32_16x16x32_bf16 v[152:155], v[60:63], v[28:31], v[152:155]
  s_waitcnt vmcnt(14)
  v_mfma_f32_16x16x32_bf16 v[144:147], v[64:67], v[32:35], v[144:147]
  v_mfma_f32_16x16x32_bf16 v[148:151], v[64:67], v[36:39], v[148:151]
  v_mfma_f32_16x16x32_bf16 v[152:155], v[68:71], v[36:39], v[152:155]
  s_waitcnt vmcnt(10)
  v_mfma_f32_16x16x32_bf16 v[144:147], v[72:75], v[40:43], v[144:147]
  v_mfma_f32_16x16x32_bf16 v[148:151], v[72:75], v[44:47], v[148:151]
  v_mfma_f32_16x16x32_bf16 v[152:155], v[76:79], v[44:47], v[152:155]
  v_and_b32 v13, 0xffff, v14
  v_cmp_ge_u32 vcc, v13, v9
  s_add_u32 s30, s63, 8
  v_readlane_b32 s55, v14, s30
  s_and_b32 s54, vcc_lo, 0xffff
  s_lshl_b32 s31, s51, 7
  s_add_u32 s31, s31, 89137152
  v_and_b32 v13, 3, v1
  v_lshl_add_u32 v13, v13, 5, s31
  s_mov_b32 s60, 0
sp_84:
  global_load_dword v14, v13, s[26:27] sc1
  s_add_u32 s60, s60, 1
  s_waitcnt vmcnt(0)
  v_cmp_ge_u32 vcc, s50, v14
  s_nop 1
  s_cmp_eq_u64 vcc, 0
  s_cbranch_scc1 sp_85
  s_cmp_ge_u32 s60, 400000
  s_cbranch_scc1 k_end
  s_sleep 1
  s_branch sp_84
sp_85:
  global_load_dword v112, v5, s[44:45] offset:8 sc1
  global_load_dword v113, v5, s[44:45] offset:24 sc1
  global_load_dword v114, v5, s[44:45] offset:40 sc1
  global_load_dword v115, v5, s[44:45] offset:56 sc1
  global_load_dword v116, v5, s[44:45] offset:1032 sc1
  global_load_dword v117, v5, s[44:45] offset:1048 sc1
  global_load_dword v118, v5, s[44:45] offset:1064 sc1
  global_load_dword v119, v5, s[44:45] offset:1080 sc1
  global_load_dword v120, v5, s[44:45] offset:2056 sc1
  global_load_dword v121, v5, s[44:45] offset:2072 sc1
  global_load_dword v122, v5, s[44:45] offset:2088 sc1
  global_load_dword v123, v5, s[44:45] offset:2104 sc1
  global_load_dword v124, v5, s[44:45] offset:3080 sc1
  global_load_dword v125, v5, s[44:45] offset:3096 sc1
  global_load_dword v126, v5, s[44:45] offset:3112 sc1
  global_load_dword v127, v5, s[44:45] offset:3128 sc1
  global_load_dwordx2 v[128:129], v4, s[44:45] offset:0 sc1
  global_load_dwordx2 v[130:131], v4, s[44:45] offset:1024 sc1
  global_load_dwordx2 v[132:133], v4, s[44:45] offset:2048 sc1
  global_load_dwordx2 v[134:135], v4, s[44:45] offset:3072 sc1
  s_lshl_b32 s30, s50, 5
  s_add_u32 s30, s30, s51
  s_lshl_b32 s30, s30, 2
  s_sub_u32 s55, s55, 24
  s_cmp_ge_u32 s55, 65512
  s_cbranch_scc1 k_xs
  s_waitcnt vmcnt(16)
  v_mfma_f32_16x16x32_bf16 v[156:159], v[112:115], v[16:19], 0
  v_mfma_f32_16x16x32_bf16 v[160:163], v[112:115], v[20:23], 0
  s_waitcnt vmcnt(12)
  v_mfma_f32_16x16x32_bf16 v[156:159], v[116:119], v[24:27], v[156:159]
  v_mfma_f32_16x16x32_bf16 v[160:163], v[116:119], v[28:31], v[160:163]
  s_waitcnt vmcnt(8)
  v_mfma_f32_16x16x32_bf16 v[156:159], v[120:123], v[32:35], v[156:159]
  v_mfma_f32_16x16x32_bf16 v[160:163], v[120:123], v[36:39], v[160:163]
  s_waitcnt vmcnt(4)
  v_mfma_f32_16x16x32_bf16 v[156:159], v[124:127], v[40:43], v[156:159]
  v_mfma_f32_16x16x32_bf16 v[160:163], v[124:127], v[44:47], v[160:163]
  v_max3_f32 v10, v144, v145, v146
  v_max3_f32 v12, v148, v149, v150
  v_max3_f32 v13, v151, v152, v153
  v_max3_f32 v12, v12, v154, v155
  v_max_f32 v10, v10, v147
  v_max_f32 v12, v12, v13
  v_sub_f32 v136, 1.0, v136
  v_sub_f32 v137, 1.0, v137
  v_max3_f32 v10, v10, v156, v157
  v_max3_f32 v12, v12, v160, v161
  v_mov_b32 v11, v10
  v_mov_b32 v13, v12
  s_nop 0
  v_permlane16_swap_b32 v10, v11
  v_permlane16_swap_b32 v12, v13
  v_max_f32 v10, v10, v11
  v_max_f32 v12, v12, v13
  v_mov_b32 v11, v10
  v_mov_b32 v13, v12
  s_nop 0
  v_permlane32_swap_b32 v10, v11
  v_permlane32_swap_b32 v12, v13
  v_max_f32 v10, v10, v11
  v_max_f32 v12, v12, v13
  v_pk_add_f32 v[144:145], v[144:145], v[10:11] op_sel_hi:[1,0] neg_lo:[0,1] neg_hi:[0,1]
  v_pk_add_f32 v[146:147], v[146:147], v[10:11] op_sel_hi:[1,0] neg_lo:[0,1] neg_hi:[0,1]
  v_pk_add_f32 v[156:157], v[156:157], v[10:11] op_sel_hi:[1,0] neg_lo:[0,1] neg_hi:[0,1]
  v_pk_add_f32 v[148:149], v[148:149], v[12:13] op_sel_hi:[1,0] neg_lo:[0,1] neg_hi:[0,1]
  v_pk_add_f32 v[150:151], v[150:151], v[12:13] op_sel_hi:[1,0] neg_lo:[0,1] neg_hi:[0,1]
  v_pk_add_f32 v[152:153], v[152:153], v[12:13] op_sel_hi:[1,0] neg_lo:[0,1] neg_hi:[0,1]
  v_pk_add_f32 v[154:155], v[154:155], v[12:13] op_sel_hi:[1,0] neg_lo:[0,1] neg_hi:[0,1]
  v_pk_add_f32 v[160:161], v[160:161], v[12:13] op_sel_hi:[1,0] neg_lo:[0,1] neg_hi:[0,1]
  v_exp_f32 v144, v144
  v_exp_f32 v145, v145
  v_exp_f32 v146, v146
  v_exp_f32 v147, v147
  v_exp_f32 v156, v156
  v_exp_f32 v157, v157
  v_exp_f32 v148, v148
  v_exp_f32 v149, v149
  v_exp_f32 v150, v150
  v_exp_f32 v151, v151
  v_exp_f32 v152, v152
  v_exp_f32 v153, v153
  v_exp_f32 v154, v154
  v_exp_f32 v155, v155
  v_exp_f32 v160, v160
  v_exp_f32 v161, v161
  v_cvt_pk_bf16_f32 v164, v144, v145
  v_cvt_pk_bf16_f32 v165, v146, v147
  v_cvt_pk_bf16_f32 v172, v156, v157
  v_cvt_pk_bf16_f32 v175, v156, v157
  v_cvt_pk_bf16_f32 v168, v148, v149
  v_cvt_pk_bf16_f32 v169, v150, v151
  v_cvt_pk_bf16_f32 v170, v152, v153
  v_cvt_pk_bf16_f32 v171, v154, v155
  v_cvt_pk_bf16_f32 v176, v160, v161
  v_cvt_pk_bf16_f32 v179, v160, v161
  s_waitcnt vmcnt(0)
  v_mfma_f32_16x16x16bf16_1k v[248:251], v[180:181], v[164:165], 0
  v_mfma_f32_16x16x32_bf16 v[252:255], v[180:183], v[168:171], 0
  v_mfma_f32_16x16x16bf16_1k v[248:251], v[180:181], v[172:173], v[248:251]
  v_mfma_f32_16x16x16bf16_1k v[252:255], v[180:181], v[176:177], v[252:255]
  v_mfma_f32_16x16x16bf16_1k v[184:187], v[80:81], v[164:165], 0
  v_mfma_f32_16x16x16bf16_1k v[188:191], v[84:85], v[164:165], 0
  v_mfma_f32_16x16x16bf16_1k v[192:195], v[88:89], v[164:165], 0
  v_mfma_f32_16x16x16bf16_1k v[196:199], v[92:93], v[164:165], 0
  v_mfma_f32_16x16x16bf16_1k v[200:203], v[96:97], v[164:165], 0
  v_mfma_f32_16x16x16bf16_1k v[204:207], v[100:101], v[164:165], 0
  v_mfma_f32_16x16x16bf16_1k v[208:211], v[104:105], v[164:165], 0
  v_mfma_f32_16x16x16bf16_1k v[212:215], v[108:109], v[164:165], 0
  v_rcp_f32 v10, v248
  v_rcp_f32 v12, v252
  v_mfma_f32_16x16x16bf16_1k v[184:187], v[128:129], v[172:173], v[184:187]
  v_mfma_f32_16x16x16bf16_1k v[188:191], v[128:129], v[174:175], v[188:191]
  v_mfma_f32_16x16x16bf16_1k v[192:195], v[130:131], v[172:173], v[192:195]
  v_mfma_f32_16x16x16bf16_1k v[196:199], v[130:131], v[174:175], v[196:199]
  v_mfma_f32_16x16x16bf16_1k v[200:203], v[132:133], v[172:173], v[200:203]
  v_mfma_f32_16x16x16bf16_1k v[204:207], v[132:133], v[174:175], v[204:207]
  v_mfma_f32_16x16x16bf16_1k v[208:211], v[134:135], v[172:173], v[208:211]
  v_mfma_f32_16x16x16bf16_1k v[212:215], v[134:135], v[174:175], v[212:215]
  v_mul_f32 v10, v10, v136
  v_mul_f32 v12, v12, v137
  v_mfma_f32_16x16x32_bf16 v[216:219], v[80:83], v[168:171], 0
  v_mfma_f32_16x16x32_bf16 v[220:223], v[84:87], v[168:171], 0
  v_mfma_f32_16x16x32_bf16 v[224:227], v[88:91], v[168:171], 0
  v_pk_mul_f32 v[184:185], v[184:185], v[10:11] op_sel_hi:[1,0]
  v_pk_mul_f32 v[186:187], v[186:187], v[10:11] op_sel_hi:[1,0]
  v_mfma_f32_16x16x32_bf16 v[228:231], v[92:95], v[168:171], 0
  v_pk_mul_f32 v[188:189], v[188:189], v[10:11] op_sel_hi:[1,0]
  v_pk_mul_f32 v[190:191], v[190:191], v[10:11] op_sel_hi:[1,0]
  v_mfma_f32_16x16x32_bf16 v[232:235], v[96:99], v[168:171], 0
  v_pk_mul_f32 v[192:193], v[192:193], v[10:11] op_sel_hi:[1,0]
  v_pk_mul_f32 v[194:195], v[194:195], v[10:11] op_sel_hi:[1,0]
  v_mfma_f32_16x16x32_bf16 v[236:239], v[100:103], v[168:171], 0
  v_pk_mul_f32 v[196:197], v[196:197], v[10:11] op_sel_hi:[1,0]
  v_pk_mul_f32 v[198:199], v[198:199], v[10:11] op_sel_hi:[1,0]
  v_mfma_f32_16x16x32_bf16 v[240:243], v[104:107], v[168:171], 0
  v_cvt_pk_bf16_f32 v16, v184, v188
  v_cvt_pk_bf16_f32 v17, v192, v196
  v_mfma_f32_16x16x32_bf16 v[244:247], v[108:111], v[168:171], 0
  v_cvt_pk_bf16_f32 v18, v185, v189
  v_cvt_pk_bf16_f32 v19, v193, v197
  v_mfma_f32_16x16x16bf16_1k v[216:219], v[128:129], v[176:177], v[216:219]
  global_store_dwordx4 v4, v[16:19], s[46:47] offset:0
  v_cvt_pk_bf16_f32 v20, v186, v190
  v_mfma_f32_16x16x16bf16_1k v[220:223], v[128:129], v[178:179], v[220:223]
  v_cvt_pk_bf16_f32 v21, v194, v198
  v_cvt_pk_bf16_f32 v22, v187, v191
  v_mfma_f32_16x16x16bf16_1k v[224:227], v[130:131], v[176:177], v[224:227]
  v_cvt_pk_bf16_f32 v23, v195, v199
  global_store_dwordx4 v4, v[20:23], s[46:47] offset:1024
  v_mfma_f32_16x16x16bf16_1k v[228:231], v[130:131], v[178:179], v[228:231]
  v_pk_mul_f32 v[200:201], v[200:201], v[10:11] op_sel_hi:[1,0]
  v_pk_mul_f32 v[202:203], v[202:203], v[10:11] op_sel_hi:[1,0]
  v_mfma_f32_16x16x16bf16_1k v[232:235], v[132:133], v[176:177], v[232:235]
  v_pk_mul_f32 v[204:205], v[204:205], v[10:11] op_sel_hi:[1,0]
  v_pk_mul_f32 v[206:207], v[206:207], v[10:11] op_sel_hi:[1,0]
  v_mfma_f32_16x16x16bf16_1k v[236:239], v[132:133], v[178:179], v[236:239]
  v_pk_mul_f32 v[208:209], v[208:209], v[10:11] op_sel_hi:[1,0]
  v_pk_mul_f32 v[210:211], v[210:211], v[10:11] op_sel_hi:[1,0]
  v_mfma_f32_16x16x16bf16_1k v[240:243], v[134:135], v[176:177], v[240:243]
  v_pk_mul_f32 v[212:213], v[212:213], v[10:11] op_sel_hi:[1,0]
  v_pk_mul_f32 v[214:215], v[214:215], v[10:11] op_sel_hi:[1,0]
  v_mfma_f32_16x16x16bf16_1k v[244:247], v[134:135], v[178:179], v[244:247]
  v_cvt_pk_bf16_f32 v24, v200, v204
  v_cvt_pk_bf16_f32 v25, v208, v212
  v_cvt_pk_bf16_f32 v26, v201, v205
  v_cvt_pk_bf16_f32 v27, v209, v213
  global_store_dwordx4 v4, v[24:27], s[46:47] offset:2048
  v_cvt_pk_bf16_f32 v28, v202, v206
  v_cvt_pk_bf16_f32 v29, v210, v214
  v_cvt_pk_bf16_f32 v30, v203, v207
  v_cvt_pk_bf16_f32 v31, v211, v215
  global_store_dwordx4 v4, v[28:31], s[46:47] offset:3072
  v_pk_mul_f32 v[216:217], v[216:217], v[12:13] op_sel_hi:[1,0]
  v_pk_mul_f32 v[218:219], v[218:219], v[12:13] op_sel_hi:[1,0]
  v_pk_mul_f32 v[220:221], v[220:221], v[12:13] op_sel_hi:[1,0]
  v_pk_mul_f32 v[222:223], v[222:223], v[12:13] op_sel_hi:[1,0]
  v_pk_mul_f32 v[224:225], v[224:225], v[12:13] op_sel_hi:[1,0]
  v_pk_mul_f32 v[226:227], v[226:227], v[12:13] op_sel_hi:[1,0]
  v_pk_mul_f32 v[228:229], v[228:229], v[12:13] op_sel_hi:[1,0]
  v_pk_mul_f32 v[230:231], v[230:231], v[12:13] op_sel_hi:[1,0]
  v_cvt_pk_bf16_f32 v32, v216, v220
  v_cvt_pk_bf16_f32 v33, v224, v228
  v_cvt_pk_bf16_f32 v34, v217, v221
  v_cvt_pk_bf16_f32 v35, v225, v229
  global_store_dwordx4 v4, v[32:35], s[48:49] offset:0
  v_cvt_pk_bf16_f32 v36, v218, v222
  v_cvt_pk_bf16_f32 v37, v226, v230
  v_cvt_pk_bf16_f32 v38, v219, v223
  v_cvt_pk_bf16_f32 v39, v227, v231
  global_store_dwordx4 v4, v[36:39], s[48:49] offset:1024
  v_pk_mul_f32 v[232:233], v[232:233], v[12:13] op_sel_hi:[1,0]
  v_pk_mul_f32 v[234:235], v[234:235], v[12:13] op_sel_hi:[1,0]
  v_pk_mul_f32 v[236:237], v[236:237], v[12:13] op_sel_hi:[1,0]
  v_pk_mul_f32 v[238:239], v[238:239], v[12:13] op_sel_hi:[1,0]
  v_pk_mul_f32 v[240:241], v[240:241], v[12:13] op_sel_hi:[1,0]
  v_pk_mul_f32 v[242:243], v[242:243], v[12:13] op_sel_hi:[1,0]
  v_pk_mul_f32 v[244:245], v[244:245], v[12:13] op_sel_hi:[1,0]
  v_pk_mul_f32 v[246:247], v[246:247], v[12:13] op_sel_hi:[1,0]
  v_cvt_pk_bf16_f32 v40, v232, v236
  v_cvt_pk_bf16_f32 v41, v240, v244
  v_cvt_pk_bf16_f32 v42, v233, v237
  v_cvt_pk_bf16_f32 v43, v241, v245
  global_store_dwordx4 v4, v[40:43], s[48:49] offset:2048
  v_cvt_pk_bf16_f32 v44, v234, v238
  v_cvt_pk_bf16_f32 v45, v242, v246
  v_cvt_pk_bf16_f32 v46, v235, v239
  v_cvt_pk_bf16_f32 v47, v243, v247
  global_store_dwordx4 v4, v[44:47], s[48:49] offset:3072
  s_add_u32 s30, s30, 89141248
  v_mov_b32 v13, s30
  v_mov_b32 v14, 1
  s_waitcnt vmcnt(0)
  s_mov_b64 exec, 1
  global_store_dword v13, v14, s[26:27]
  s_mov_b64 exec, -1
  s_branch k_xe
k_xs:
  s_waitcnt vmcnt(16)
  v_mfma_f32_16x16x32_bf16 v[156:159], v[112:115], v[16:19], 0
  v_mfma_f32_16x16x32_bf16 v[160:163], v[112:115], v[20:23], 0
  s_waitcnt vmcnt(12)
  v_mfma_f32_16x16x32_bf16 v[156:159], v[116:119], v[24:27], v[156:159]
  v_mfma_f32_16x16x32_bf16 v[160:163], v[116:119], v[28:31], v[160:163]
  s_waitcnt vmcnt(8)
  v_mfma_f32_16x16x32_bf16 v[156:159], v[120:123], v[32:35], v[156:159]
  v_mfma_f32_16x16x32_bf16 v[160:163], v[120:123], v[36:39], v[160:163]
  s_waitcnt vmcnt(4)
  v_mfma_f32_16x16x32_bf16 v[156:159], v[124:127], v[40:43], v[156:159]
  v_mfma_f32_16x16x32_bf16 v[160:163], v[124:127], v[44:47], v[160:163]
  v_max3_f32 v10, v144, v145, v146
  v_max3_f32 v12, v148, v149, v150
  v_max3_f32 v13, v151, v152, v153
  v_max3_f32 v12, v12, v154, v155
  v_max_f32 v10, v10, v147
  v_max_f32 v12, v12, v13
  v_sub_f32 v136, 1.0, v136
  v_sub_f32 v137, 1.0, v137
  v_max3_f32 v10, v10, v156, v157
  v_max3_f32 v12, v12, v160, v161
  v_mov_b32 v11, v10
  v_mov_b32 v13, v12
  s_nop 0
  v_permlane16_swap_b32 v10, v11
  v_permlane16_swap_b32 v12, v13
  v_max_f32 v10, v10, v11
  v_max_f32 v12, v12, v13
  v_mov_b32 v11, v10
  v_mov_b32 v13, v12
  s_nop 0
  v_permlane32_swap_b32 v10, v11
  v_permlane32_swap_b32 v12, v13
  v_max_f32 v10, v10, v11
  v_max_f32 v12, v12, v13
  v_pk_add_f32 v[144:145], v[144:145], v[10:11] op_sel_hi:[1,0] neg_lo:[0,1] neg_hi:[0,1]
  v_pk_add_f32 v[146:147], v[146:147], v[10:11] op_sel_hi:[1,0] neg_lo:[0,1] neg_hi:[0,1]
  v_pk_add_f32 v[156:157], v[156:157], v[10:11] op_sel_hi:[1,0] neg_lo:[0,1] neg_hi:[0,1]
  v_pk_add_f32 v[148:149], v[148:149], v[12:13] op_sel_hi:[1,0] neg_lo:[0,1] neg_hi:[0,1]
  v_pk_add_f32 v[150:151], v[150:151], v[12:13] op_sel_hi:[1,0] neg_lo:[0,1] neg_hi:[0,1]
  v_pk_add_f32 v[152:153], v[152:153], v[12:13] op_sel_hi:[1,0] neg_lo:[0,1] neg_hi:[0,1]
  v_pk_add_f32 v[154:155], v[154:155], v[12:13] op_sel_hi:[1,0] neg_lo:[0,1] neg_hi:[0,1]
  v_pk_add_f32 v[160:161], v[160:161], v[12:13] op_sel_hi:[1,0] neg_lo:[0,1] neg_hi:[0,1]
  v_exp_f32 v144, v144
  v_exp_f32 v145, v145
  v_exp_f32 v146, v146
  v_exp_f32 v147, v147
  v_exp_f32 v156, v156
  v_exp_f32 v157, v157
  v_exp_f32 v148, v148
  v_exp_f32 v149, v149
  v_exp_f32 v150, v150
  v_exp_f32 v151, v151
  v_exp_f32 v152, v152
  v_exp_f32 v153, v153
  v_exp_f32 v154, v154
  v_exp_f32 v155, v155
  v_exp_f32 v160, v160
  v_exp_f32 v161, v161
  v_cvt_pk_bf16_f32 v164, v144, v145
  v_cvt_pk_bf16_f32 v165, v146, v147
  v_cvt_pk_bf16_f32 v172, v156, v157
  v_cvt_pk_bf16_f32 v175, v156, v157
  v_cvt_pk_bf16_f32 v168, v148, v149
  v_cvt_pk_bf16_f32 v169, v150, v151
  v_cvt_pk_bf16_f32 v170, v152, v153
  v_cvt_pk_bf16_f32 v171, v154, v155
  v_cvt_pk_bf16_f32 v176, v160, v161
  v_cvt_pk_bf16_f32 v179, v160, v161
  s_waitcnt vmcnt(0)
  v_mfma_f32_16x16x16bf16_1k v[248:251], v[180:181], v[164:165], 0
  v_mfma_f32_16x16x32_bf16 v[252:255], v[180:183], v[168:171], 0
  v_mfma_f32_16x16x16bf16_1k v[248:251], v[180:181], v[172:173], v[248:251]
  v_mfma_f32_16x16x16bf16_1k v[252:255], v[180:181], v[176:177], v[252:255]
  v_mfma_f32_16x16x16bf16_1k v[184:187], v[80:81], v[164:165], 0
  v_mfma_f32_16x16x16bf16_1k v[188:191], v[84:85], v[164:165], 0
  v_mfma_f32_16x16x16bf16_1k v[192:195], v[88:89], v[164:165], 0
  v_mfma_f32_16x16x16bf16_1k v[196:199], v[92:93], v[164:165], 0
  v_mfma_f32_16x16x16bf16_1k v[200:203], v[96:97], v[164:165], 0
  v_mfma_f32_16x16x16bf16_1k v[204:207], v[100:101], v[164:165], 0
  v_mfma_f32_16x16x16bf16_1k v[208:211], v[104:105], v[164:165], 0
  v_mfma_f32_16x16x16bf16_1k v[212:215], v[108:109], v[164:165], 0
  v_rcp_f32 v10, v248
  v_rcp_f32 v12, v252
  v_mfma_f32_16x16x16bf16_1k v[184:187], v[128:129], v[172:173], v[184:187]
  v_mfma_f32_16x16x16bf16_1k v[188:191], v[128:129], v[174:175], v[188:191]
  v_mfma_f32_16x16x16bf16_1k v[192:195], v[130:131], v[172:173], v[192:195]
  v_mfma_f32_16x16x16bf16_1k v[196:199], v[130:131], v[174:175], v[196:199]
  v_mfma_f32_16x16x16bf16_1k v[200:203], v[132:133], v[172:173], v[200:203]
  v_mfma_f32_16x16x16bf16_1k v[204:207], v[132:133], v[174:175], v[204:207]
  v_mfma_f32_16x16x16bf16_1k v[208:211], v[134:135], v[172:173], v[208:211]
  v_mfma_f32_16x16x16bf16_1k v[212:215], v[134:135], v[174:175], v[212:215]
  v_mul_f32 v10, v10, v136
  v_mul_f32 v12, v12, v137
  v_mfma_f32_16x16x32_bf16 v[216:219], v[80:83], v[168:171], 0
  v_mfma_f32_16x16x32_bf16 v[220:223], v[84:87], v[168:171], 0
  v_mfma_f32_16x16x32_bf16 v[224:227], v[88:91], v[168:171], 0
  v_pk_mul_f32 v[184:185], v[184:185], v[10:11] op_sel_hi:[1,0]
  v_pk_mul_f32 v[186:187], v[186:187], v[10:11] op_sel_hi:[1,0]
  v_mfma_f32_16x16x32_bf16 v[228:231], v[92:95], v[168:171], 0
  v_pk_mul_f32 v[188:189], v[188:189], v[10:11] op_sel_hi:[1,0]
  v_pk_mul_f32 v[190:191], v[190:191], v[10:11] op_sel_hi:[1,0]
  v_mfma_f32_16x16x32_bf16 v[232:235], v[96:99], v[168:171], 0
  v_pk_mul_f32 v[192:193], v[192:193], v[10:11] op_sel_hi:[1,0]
  v_pk_mul_f32 v[194:195], v[194:195], v[10:11] op_sel_hi:[1,0]
  v_mfma_f32_16x16x32_bf16 v[236:239], v[100:103], v[168:171], 0
  v_pk_mul_f32 v[196:197], v[196:197], v[10:11] op_sel_hi:[1,0]
  v_pk_mul_f32 v[198:199], v[198:199], v[10:11] op_sel_hi:[1,0]
  v_mfma_f32_16x16x32_bf16 v[240:243], v[104:107], v[168:171], 0
  v_cvt_pk_bf16_f32 v16, v184, v188
  v_cvt_pk_bf16_f32 v17, v192, v196
  v_mfma_f32_16x16x32_bf16 v[244:247], v[108:111], v[168:171], 0
  v_cvt_pk_bf16_f32 v18, v185, v189
  v_cvt_pk_bf16_f32 v19, v193, v197
  v_mfma_f32_16x16x16bf16_1k v[216:219], v[128:129], v[176:177], v[216:219]
  global_store_dwordx4 v4, v[16:19], s[46:47] offset:0 sc1
  v_cvt_pk_bf16_f32 v20, v186, v190
  v_mfma_f32_16x16x16bf16_1k v[220:223], v[128:129], v[178:179], v[220:223]
  v_cvt_pk_bf16_f32 v21, v194, v198
  v_cvt_pk_bf16_f32 v22, v187, v191
  v_mfma_f32_16x16x16bf16_1k v[224:227], v[130:131], v[176:177], v[224:227]
  v_cvt_pk_bf16_f32 v23, v195, v199
  global_store_dwordx4 v4, v[20:23], s[46:47] offset:1024 sc1
  v_mfma_f32_16x16x16bf16_1k v[228:231], v[130:131], v[178:179], v[228:231]
  v_pk_mul_f32 v[200:201], v[200:201], v[10:11] op_sel_hi:[1,0]
  v_pk_mul_f32 v[202:203], v[202:203], v[10:11] op_sel_hi:[1,0]
  v_mfma_f32_16x16x16bf16_1k v[232:235], v[132:133], v[176:177], v[232:235]
  v_pk_mul_f32 v[204:205], v[204:205], v[10:11] op_sel_hi:[1,0]
  v_pk_mul_f32 v[206:207], v[206:207], v[10:11] op_sel_hi:[1,0]
  v_mfma_f32_16x16x16bf16_1k v[236:239], v[132:133], v[178:179], v[236:239]
  v_pk_mul_f32 v[208:209], v[208:209], v[10:11] op_sel_hi:[1,0]
  v_pk_mul_f32 v[210:211], v[210:211], v[10:11] op_sel_hi:[1,0]
  v_mfma_f32_16x16x16bf16_1k v[240:243], v[134:135], v[176:177], v[240:243]
  v_pk_mul_f32 v[212:213], v[212:213], v[10:11] op_sel_hi:[1,0]
  v_pk_mul_f32 v[214:215], v[214:215], v[10:11] op_sel_hi:[1,0]
  v_mfma_f32_16x16x16bf16_1k v[244:247], v[134:135], v[178:179], v[244:247]
  v_cvt_pk_bf16_f32 v24, v200, v204
  v_cvt_pk_bf16_f32 v25, v208, v212
  v_cvt_pk_bf16_f32 v26, v201, v205
  v_cvt_pk_bf16_f32 v27, v209, v213
  global_store_dwordx4 v4, v[24:27], s[46:47] offset:2048 sc1
  v_cvt_pk_bf16_f32 v28, v202, v206
  v_cvt_pk_bf16_f32 v29, v210, v214
  v_cvt_pk_bf16_f32 v30, v203, v207
  v_cvt_pk_bf16_f32 v31, v211, v215
  global_store_dwordx4 v4, v[28:31], s[46:47] offset:3072 sc1
  v_pk_mul_f32 v[216:217], v[216:217], v[12:13] op_sel_hi:[1,0]
  v_pk_mul_f32 v[218:219], v[218:219], v[12:13] op_sel_hi:[1,0]
  v_pk_mul_f32 v[220:221], v[220:221], v[12:13] op_sel_hi:[1,0]
  v_pk_mul_f32 v[222:223], v[222:223], v[12:13] op_sel_hi:[1,0]
  v_pk_mul_f32 v[224:225], v[224:225], v[12:13] op_sel_hi:[1,0]
  v_pk_mul_f32 v[226:227], v[226:227], v[12:13] op_sel_hi:[1,0]
  v_pk_mul_f32 v[228:229], v[228:229], v[12:13] op_sel_hi:[1,0]
  v_pk_mul_f32 v[230:231], v[230:231], v[12:13] op_sel_hi:[1,0]
  v_cvt_pk_bf16_f32 v32, v216, v220
  v_cvt_pk_bf16_f32 v33, v224, v228
  v_cvt_pk_bf16_f32 v34, v217, v221
  v_cvt_pk_bf16_f32 v35, v225, v229
  global_store_dwordx4 v4, v[32:35], s[48:49] offset:0 sc1
  v_cvt_pk_bf16_f32 v36, v218, v222
  v_cvt_pk_bf16_f32 v37, v226, v230
  v_cvt_pk_bf16_f32 v38, v219, v223
  v_cvt_pk_bf16_f32 v39, v227, v231
  global_store_dwordx4 v4, v[36:39], s[48:49] offset:1024 sc1
  v_pk_mul_f32 v[232:233], v[232:233], v[12:13] op_sel_hi:[1,0]
  v_pk_mul_f32 v[234:235], v[234:235], v[12:13] op_sel_hi:[1,0]
  v_pk_mul_f32 v[236:237], v[236:237], v[12:13] op_sel_hi:[1,0]
  v_pk_mul_f32 v[238:239], v[238:239], v[12:13] op_sel_hi:[1,0]
  v_pk_mul_f32 v[240:241], v[240:241], v[12:13] op_sel_hi:[1,0]
  v_pk_mul_f32 v[242:243], v[242:243], v[12:13] op_sel_hi:[1,0]
  v_pk_mul_f32 v[244:245], v[244:245], v[12:13] op_sel_hi:[1,0]
  v_pk_mul_f32 v[246:247], v[246:247], v[12:13] op_sel_hi:[1,0]
  v_cvt_pk_bf16_f32 v40, v232, v236
  v_cvt_pk_bf16_f32 v41, v240, v244
  v_cvt_pk_bf16_f32 v42, v233, v237
  v_cvt_pk_bf16_f32 v43, v241, v245
  global_store_dwordx4 v4, v[40:43], s[48:49] offset:2048 sc1
  v_cvt_pk_bf16_f32 v44, v234, v238
  v_cvt_pk_bf16_f32 v45, v242, v246
  v_cvt_pk_bf16_f32 v46, v235, v239
  v_cvt_pk_bf16_f32 v47, v243, v247
  global_store_dwordx4 v4, v[44:47], s[48:49] offset:3072 sc1
  s_add_u32 s30, s30, 89153536
  v_mov_b32 v13, s30
  v_mov_b32 v14, 1
  s_waitcnt vmcnt(0)
  s_mov_b64 exec, 1
  global_store_dword v13, v14, s[26:27] sc1
  s_mov_b64 exec, -1
k_xe:
  s_add_u32 s50, s50, 7
  s_cmp_lt_u32 s50, 64
  s_cbranch_scc1 k_xl
  s_branch k_rdone
k_orole:
  s_sub_u32 s30, s29, 8
  s_lshl_b32 s31, s30, 6
  s_lshl_b32 s32, s28, 20
  s_add_u32 s32, s32, s31
  v_lshlrev_b32 v4, 14, v3
  v_lshl_add_u32 v4, v2, 2, v4
  v_add_u32 v4, s32, v4
  s_lshl_b32 s32, s28, 17
  s_add_u32 s32, s32, s31
  v_lshrrev_b32 v5, 1, v3
  v_lshlrev_b32 v5, 14, v5
  v_and_b32 v6, 1, v3
  v_lshl_add_u32 v5, v6, 10, v5
  v_lshl_add_u32 v5, v2, 2, v5
  v_add_u32 v5, s32, v5
  s_mov_b32 s56, 0x05040100
  s_mov_b32 s57, 0x07060302
  s_mov_b32 s36, s18
  s_mov_b32 s37, s19
  s_mov_b32 s38, 4194304
  s_mov_b32 s39, 0x20000
  s_mov_b32 s40, s8
  s_mov_b32 s41, s9
  s_mov_b32 s42, 524288
  s_mov_b32 s43, 0x20000
  s_mov_b32 s58, 0
  buffer_load_dword v64, v4, s[36:39], s58 offen offset:0
  buffer_load_dword v65, v4, s[36:39], s58 offen offset:1024
  buffer_load_dword v66, v4, s[36:39], s58 offen offset:2048
  buffer_load_dword v67, v4, s[36:39], s58 offen offset:3072
  s_mov_b32 s58, 4096
  buffer_load_dword v68, v4, s[36:39], s58 offen offset:0
  buffer_load_dword v69, v4, s[36:39], s58 offen offset:1024
  buffer_load_dword v70, v4, s[36:39], s58 offen offset:2048
  buffer_load_dword v71, v4, s[36:39], s58 offen offset:3072
  s_mov_b32 s58, 8192
  buffer_load_dword v72, v4, s[36:39], s58 offen offset:0
  buffer_load_dword v73, v4, s[36:39], s58 offen offset:1024
  buffer_load_dword v74, v4, s[36:39], s58 offen offset:2048
  buffer_load_dword v75, v4, s[36:39], s58 offen offset:3072
  s_mov_b32 s58, 12288
  buffer_load_dword v76, v4, s[36:39], s58 offen offset:0
  buffer_load_dword v77, v4, s[36:39], s58 offen offset:1024
  buffer_load_dword v78, v4, s[36:39], s58 offen offset:2048
  buffer_load_dword v79, v4, s[36:39], s58 offen offset:3072
  s_mov_b32 s58, 65536
  buffer_load_dword v80, v4, s[36:39], s58 offen offset:0
  buffer_load_dword v81, v4, s[36:39], s58 offen offset:1024
  buffer_load_dword v82, v4, s[36:39], s58 offen offset:2048
  buffer_load_dword v83, v4, s[36:39], s58 offen offset:3072
  s_mov_b32 s58, 69632
  buffer_load_dword v84, v4, s[36:39], s58 offen offset:0
  buffer_load_dword v85, v4, s[36:39], s58 offen offset:1024
  buffer_load_dword v86, v4, s[36:39], s58 offen offset:2048
  buffer_load_dword v87, v4, s[36:39], s58 offen offset:3072
  s_mov_b32 s58, 73728
  buffer_load_dword v88, v4, s[36:39], s58 offen offset:0
  buffer_load_dword v89, v4, s[36:39], s58 offen offset:1024
  buffer_load_dword v90, v4, s[36:39], s58 offen offset:2048
  buffer_load_dword v91, v4, s[36:39], s58 offen offset:3072
  s_mov_b32 s58, 77824
  buffer_load_dword v92, v4, s[36:39], s58 offen offset:0
  buffer_load_dword v93, v4, s[36:39], s58 offen offset:1024
  buffer_load_dword v94, v4, s[36:39], s58 offen offset:2048
  buffer_load_dword v95, v4, s[36:39], s58 offen offset:3072
  s_mov_b32 s58, 131072
  buffer_load_dword v96, v4, s[36:39], s58 offen offset:0
  buffer_load_dword v97, v4, s[36:39], s58 offen offset:1024
  buffer_load_dword v98, v4, s[36:39], s58 offen offset:2048
  buffer_load_dword v99, v4, s[36:39], s58 offen offset:3072
  s_mov_b32 s58, 135168
  buffer_load_dword v100, v4, s[36:39], s58 offen offset:0
  buffer_load_dword v101, v4, s[36:39], s58 offen offset:1024
  buffer_load_dword v102, v4, s[36:39], s58 offen offset:2048
  buffer_load_dword v103, v4, s[36:39], s58 offen offset:3072
  s_mov_b32 s58, 139264
  buffer_load_dword v104, v4, s[36:39], s58 offen offset:0
  buffer_load_dword v105, v4, s[36:39], s58 offen offset:1024
  buffer_load_dword v106, v4, s[36:39], s58 offen offset:2048
  buffer_load_dword v107, v4, s[36:39], s58 offen offset:3072
  s_mov_b32 s58, 143360
  buffer_load_dword v108, v4, s[36:39], s58 offen offset:0
  buffer_load_dword v109, v4, s[36:39], s58 offen offset:1024
  buffer_load_dword v110, v4, s[36:39], s58 offen offset:2048
  buffer_load_dword v111, v4, s[36:39], s58 offen offset:3072
  s_mov_b32 s58, 196608
  buffer_load_dword v112, v4, s[36:39], s58 offen offset:0
  buffer_load_dword v113, v4, s[36:39], s58 offen offset:1024
  buffer_load_dword v114, v4, s[36:39], s58 offen offset:2048
  buffer_load_dword v115, v4, s[36:39], s58 offen offset:3072
  s_mov_b32 s58, 200704
  buffer_load_dword v116, v4, s[36:39], s58 offen offset:0
  buffer_load_dword v117, v4, s[36:39], s58 offen offset:1024
  buffer_load_dword v118, v4, s[36:39], s58 offen offset:2048
  buffer_load_dword v119, v4, s[36:39], s58 offen offset:3072
  s_waitcnt vmcnt(48)
  v_perm_b32 v16, v65, v64, s56
  v_perm_b32 v17, v67, v66, s56
  v_perm_b32 v18, v69, v68, s56
  v_perm_b32 v19, v71, v70, s56
  v_perm_b32 v20, v65, v64, s57
  v_perm_b32 v21, v67, v66, s57
  v_perm_b32 v22, v69, v68, s57
  v_perm_b32 v23, v71, v70, s57
  v_accvgpr_write_b32 a0, v16
  v_accvgpr_write_b32 a1, v17
  v_accvgpr_write_b32 a2, v18
  v_accvgpr_write_b32 a3, v19
  v_accvgpr_write_b32 a4, v20
  v_accvgpr_write_b32 a5, v21
  v_accvgpr_write_b32 a6, v22
  v_accvgpr_write_b32 a7, v23
  s_mov_b32 s58, 204800
  buffer_load_dword v64, v4, s[36:39], s58 offen offset:0
  buffer_load_dword v65, v4, s[36:39], s58 offen offset:1024
  buffer_load_dword v66, v4, s[36:39], s58 offen offset:2048
  buffer_load_dword v67, v4, s[36:39], s58 offen offset:3072
  s_mov_b32 s58, 208896
  buffer_load_dword v68, v4, s[36:39], s58 offen offset:0
  buffer_load_dword v69, v4, s[36:39], s58 offen offset:1024
  buffer_load_dword v70, v4, s[36:39], s58 offen offset:2048
  buffer_load_dword v71, v4, s[36:39], s58 offen offset:3072
  s_waitcnt vmcnt(48)
  v_perm_b32 v16, v73, v72, s56
  v_perm_b32 v17, v75, v74, s56
  v_perm_b32 v18, v77, v76, s56
  v_perm_b32 v19, v79, v78, s56
  v_perm_b32 v20, v73, v72, s57
  v_perm_b32 v21, v75, v74, s57
  v_perm_b32 v22, v77, v76, s57
  v_perm_b32 v23, v79, v78, s57
  v_accvgpr_write_b32 a8, v16
  v_accvgpr_write_b32 a9, v17
  v_accvgpr_write_b32 a10, v18
  v_accvgpr_write_b32 a11, v19
  v_accvgpr_write_b32 a12, v20
  v_accvgpr_write_b32 a13, v21
  v_accvgpr_write_b32 a14, v22
  v_accvgpr_write_b32 a15, v23
  s_mov_b32 s58, 262144
  buffer_load_dword v72, v4, s[36:39], s58 offen offset:0
  buffer_load_dword v73, v4, s[36:39], s58 offen offset:1024
  buffer_load_dword v74, v4, s[36:39], s58 offen offset:2048
  buffer_load_dword v75, v4, s[36:39], s58 offen offset:3072
  s_mov_b32 s58, 266240
  buffer_load_dword v76, v4, s[36:39], s58 offen offset:0
  buffer_load_dword v77, v4, s[36:39], s58 offen offset:1024
  buffer_load_dword v78, v4, s[36:39], s58 offen offset:2048
  buffer_load_dword v79, v4, s[36:39], s58 offen offset:3072
  s_waitcnt vmcnt(48)
  v_perm_b32 v16, v81, v80, s56
  v_perm_b32 v17, v83, v82, s56
  v_perm_b32 v18, v85, v84, s56
  v_perm_b32 v19, v87, v86, s56
  v_perm_b32 v20, v81, v80, s57
  v_perm_b32 v21, v83, v82, s57
  v_perm_b32 v22, v85, v84, s57
  v_perm_b32 v23, v87, v86, s57
  v_accvgpr_write_b32 a16, v16
  v_accvgpr_write_b32 a17, v17
  v_accvgpr_write_b32 a18, v18
  v_accvgpr_write_b32 a19, v19
  v_accvgpr_write_b32 a20, v20
  v_accvgpr_write_b32 a21, v21
  v_accvgpr_write_b32 a22, v22
  v_accvgpr_write_b32 a23, v23
  s_mov_b32 s58, 270336
  buffer_load_dword v80, v4, s[36:39], s58 offen offset:0
  buffer_load_dword v81, v4, s[36:39], s58 offen offset:1024
  buffer_load_dword v82, v4, s[36:39], s58 offen offset:2048
  buffer_load_dword v83, v4, s[36:39], s58 offen offset:3072
  s_mov_b32 s58, 274432
  buffer_load_dword v84, v4, s[36:39], s58 offen offset:0
  buffer_load_dword v85, v4, s[36:39], s58 offen offset:1024
  buffer_load_dword v86, v4, s[36:39], s58 offen offset:2048
  buffer_load_dword v87, v4, s[36:39], s58 offen offset:3072
  s_waitcnt vmcnt(48)
  v_perm_b32 v16, v89, v88, s56
  v_perm_b32 v17, v91, v90, s56
  v_perm_b32 v18, v93, v92, s56
  v_perm_b32 v19, v95, v94, s56
  v_perm_b32 v20, v89, v88, s57
  v_perm_b32 v21, v91, v90, s57
  v_perm_b32 v22, v93, v92, s57
  v_perm_b32 v23, v95, v94, s57
  v_accvgpr_write_b32 a24, v16
  v_accvgpr_write_b32 a25, v17
  v_accvgpr_write_b32 a26, v18
  v_accvgpr_write_b32 a27, v19
  v_accvgpr_write_b32 a28, v20
  v_accvgpr_write_b32 a29, v21
  v_accvgpr_write_b32 a30, v22
  v_accvgpr_write_b32 a31, v23
  s_mov_b32 s58, 327680
  buffer_load_dword v88, v4, s[36:39], s58 offen offset:0
  buffer_load_dword v89, v4, s[36:39], s58 offen offset:1024
  buffer_load_dword v90, v4, s[36:39], s58 offen offset:2048
  buffer_load_dword v91, v4, s[36:39], s58 offen offset:3072
  s_mov_b32 s58, 331776
  buffer_load_dword v92, v4, s[36:39], s58 offen offset:0
  buffer_load_dword v93, v4, s[36:39], s58 offen offset:1024
  buffer_load_dword v94, v4, s[36:39], s58 offen offset:2048
  buffer_load_dword v95, v4, s[36:39], s58 offen offset:3072
  s_waitcnt vmcnt(48)
  v_perm_b32 v16, v97, v96, s56
  v_perm_b32 v17, v99, v98, s56
  v_perm_b32 v18, v101, v100, s56
  v_perm_b32 v19, v103, v102, s56
  v_perm_b32 v20, v97, v96, s57
  v_perm_b32 v21, v99, v98, s57
  v_perm_b32 v22, v101, v100, s57
  v_perm_b32 v23, v103, v102, s57
  v_accvgpr_write_b32 a32, v16
  v_accvgpr_write_b32 a33, v17
  v_accvgpr_write_b32 a34, v18
  v_accvgpr_write_b32 a35, v19
  v_accvgpr_write_b32 a36, v20
  v_accvgpr_write_b32 a37, v21
  v_accvgpr_write_b32 a38, v22
  v_accvgpr_write_b32 a39, v23
  s_mov_b32 s58, 335872
  buffer_load_dword v96, v4, s[36:39], s58 offen offset:0
  buffer_load_dword v97, v4, s[36:39], s58 offen offset:1024
  buffer_load_dword v98, v4, s[36:39], s58 offen offset:2048
  buffer_load_dword v99, v4, s[36:39], s58 offen offset:3072
  s_mov_b32 s58, 339968
  buffer_load_dword v100, v4, s[36:39], s58 offen offset:0
  buffer_load_dword v101, v4, s[36:39], s58 offen offset:1024
  buffer_load_dword v102, v4, s[36:39], s58 offen offset:2048
  buffer_load_dword v103, v4, s[36:39], s58 offen offset:3072
  s_waitcnt vmcnt(48)
  v_perm_b32 v16, v105, v104, s56
  v_perm_b32 v17, v107, v106, s56
  v_perm_b32 v18, v109, v108, s56
  v_perm_b32 v19, v111, v110, s56
  v_perm_b32 v20, v105, v104, s57
  v_perm_b32 v21, v107, v106, s57
  v_perm_b32 v22, v109, v108, s57
  v_perm_b32 v23, v111, v110, s57
  v_accvgpr_write_b32 a40, v16
  v_accvgpr_write_b32 a41, v17
  v_accvgpr_write_b32 a42, v18
  v_accvgpr_write_b32 a43, v19
  v_accvgpr_write_b32 a44, v20
  v_accvgpr_write_b32 a45, v21
  v_accvgpr_write_b32 a46, v22
  v_accvgpr_write_b32 a47, v23
  s_mov_b32 s58, 393216
  buffer_load_dword v104, v4, s[36:39], s58 offen offset:0
  buffer_load_dword v105, v4, s[36:39], s58 offen offset:1024
  buffer_load_dword v106, v4, s[36:39], s58 offen offset:2048
  buffer_load_dword v107, v4, s[36:39], s58 offen offset:3072
  s_mov_b32 s58, 397312
  buffer_load_dword v108, v4, s[36:39], s58 offen offset:0
  buffer_load_dword v109, v4, s[36:39], s58 offen offset:1024
  buffer_load_dword v110, v4, s[36:39], s58 offen offset:2048
  buffer_load_dword v111, v4, s[36:39], s58 offen offset:3072
  s_waitcnt vmcnt(48)
  v_perm_b32 v16, v113, v112, s56
  v_perm_b32 v17, v115, v114, s56
  v_perm_b32 v18, v117, v116, s56
  v_perm_b32 v19, v119, v118, s56
  v_perm_b32 v20, v113, v112, s57
  v_perm_b32 v21, v115, v114, s57
  v_perm_b32 v22, v117, v116, s57
  v_perm_b32 v23, v119, v118, s57
  v_accvgpr_write_b32 a48, v16
  v_accvgpr_write_b32 a49, v17
  v_accvgpr_write_b32 a50, v18
  v_accvgpr_write_b32 a51, v19
  v_accvgpr_write_b32 a52, v20
  v_accvgpr_write_b32 a53, v21
  v_accvgpr_write_b32 a54, v22
  v_accvgpr_write_b32 a55, v23
  s_mov_b32 s58, 401408
  buffer_load_dword v112, v4, s[36:39], s58 offen offset:0
  buffer_load_dword v113, v4, s[36:39], s58 offen offset:1024
  buffer_load_dword v114, v4, s[36:39], s58 offen offset:2048
  buffer_load_dword v115, v4, s[36:39], s58 offen offset:3072
  s_mov_b32 s58, 405504
  buffer_load_dword v116, v4, s[36:39], s58 offen offset:0
  buffer_load_dword v117, v4, s[36:39], s58 offen offset:1024
  buffer_load_dword v118, v4, s[36:39], s58 offen offset:2048
  buffer_load_dword v119, v4, s[36:39], s58 offen offset:3072
  s_waitcnt vmcnt(48)
  v_perm_b32 v16, v65, v64, s56
  v_perm_b32 v17, v67, v66, s56
  v_perm_b32 v18, v69, v68, s56
  v_perm_b32 v19, v71, v70, s56
  v_perm_b32 v20, v65, v64, s57
  v_perm_b32 v21, v67, v66, s57
  v_perm_b32 v22, v69, v68, s57
  v_perm_b32 v23, v71, v70, s57
  v_accvgpr_write_b32 a56, v16
  v_accvgpr_write_b32 a57, v17
  v_accvgpr_write_b32 a58, v18
  v_accvgpr_write_b32 a59, v19
  v_accvgpr_write_b32 a60, v20
  v_accvgpr_write_b32 a61, v21
  v_accvgpr_write_b32 a62, v22
  v_accvgpr_write_b32 a63, v23
  s_mov_b32 s58, 458752
  buffer_load_dword v64, v4, s[36:39], s58 offen offset:0
  buffer_load_dword v65, v4, s[36:39], s58 offen offset:1024
  buffer_load_dword v66, v4, s[36:39], s58 offen offset:2048
  buffer_load_dword v67, v4, s[36:39], s58 offen offset:3072
  s_mov_b32 s58, 462848
  buffer_load_dword v68, v4, s[36:39], s58 offen offset:0
  buffer_load_dword v69, v4, s[36:39], s58 offen offset:1024
  buffer_load_dword v70, v4, s[36:39], s58 offen offset:2048
  buffer_load_dword v71, v4, s[36:39], s58 offen offset:3072
  s_waitcnt vmcnt(48)
  v_perm_b32 v16, v73, v72, s56
  v_perm_b32 v17, v75, v74, s56
  v_perm_b32 v18, v77, v76, s56
  v_perm_b32 v19, v79, v78, s56
  v_perm_b32 v20, v73, v72, s57
  v_perm_b32 v21, v75, v74, s57
  v_perm_b32 v22, v77, v76, s57
  v_perm_b32 v23, v79, v78, s57
  v_accvgpr_write_b32 a64, v16
  v_accvgpr_write_b32 a65, v17
  v_accvgpr_write_b32 a66, v18
  v_accvgpr_write_b32 a67, v19
  v_accvgpr_write_b32 a68, v20
  v_accvgpr_write_b32 a69, v21
  v_accvgpr_write_b32 a70, v22
  v_accvgpr_write_b32 a71, v23
  s_mov_b32 s58, 466944
  buffer_load_dword v72, v4, s[36:39], s58 offen offset:0
  buffer_load_dword v73, v4, s[36:39], s58 offen offset:1024
  buffer_load_dword v74, v4, s[36:39], s58 offen offset:2048
  buffer_load_dword v75, v4, s[36:39], s58 offen offset:3072
  s_mov_b32 s58, 471040
  buffer_load_dword v76, v4, s[36:39], s58 offen offset:0
  buffer_load_dword v77, v4, s[36:39], s58 offen offset:1024
  buffer_load_dword v78, v4, s[36:39], s58 offen offset:2048
  buffer_load_dword v79, v4, s[36:39], s58 offen offset:3072
  s_waitcnt vmcnt(48)
  v_perm_b32 v16, v81, v80, s56
  v_perm_b32 v17, v83, v82, s56
  v_perm_b32 v18, v85, v84, s56
  v_perm_b32 v19, v87, v86, s56
  v_perm_b32 v20, v81, v80, s57
  v_perm_b32 v21, v83, v82, s57
  v_perm_b32 v22, v85, v84, s57
  v_perm_b32 v23, v87, v86, s57
  v_accvgpr_write_b32 a72, v16
  v_accvgpr_write_b32 a73, v17
  v_accvgpr_write_b32 a74, v18
  v_accvgpr_write_b32 a75, v19
  v_accvgpr_write_b32 a76, v20
  v_accvgpr_write_b32 a77, v21
  v_accvgpr_write_b32 a78, v22
  v_accvgpr_write_b32 a79, v23
  s_mov_b32 s58, 524288
  buffer_load_dword v80, v4, s[36:39], s58 offen offset:0
  buffer_load_dword v81, v4, s[36:39], s58 offen offset:1024
  buffer_load_dword v82, v4, s[36:39], s58 offen offset:2048
  buffer_load_dword v83, v4, s[36:39], s58 offen offset:3072
  s_mov_b32 s58, 528384
  buffer_load_dword v84, v4, s[36:39], s58 offen offset:0
  buffer_load_dword v85, v4, s[36:39], s58 offen offset:1024
  buffer_load_dword v86, v4, s[36:39], s58 offen offset:2048
  buffer_load_dword v87, v4, s[36:39], s58 offen offset:3072
  s_waitcnt vmcnt(48)
  v_perm_b32 v16, v89, v88, s56
  v_perm_b32 v17, v91, v90, s56
  v_perm_b32 v18, v93, v92, s56
  v_perm_b32 v19, v95, v94, s56
  v_perm_b32 v20, v89, v88, s57
  v_perm_b32 v21, v91, v90, s57
  v_perm_b32 v22, v93, v92, s57
  v_perm_b32 v23, v95, v94, s57
  v_accvgpr_write_b32 a80, v16
  v_accvgpr_write_b32 a81, v17
  v_accvgpr_write_b32 a82, v18
  v_accvgpr_write_b32 a83, v19
  v_accvgpr_write_b32 a84, v20
  v_accvgpr_write_b32 a85, v21
  v_accvgpr_write_b32 a86, v22
  v_accvgpr_write_b32 a87, v23
  s_mov_b32 s58, 532480
  buffer_load_dword v88, v4, s[36:39], s58 offen offset:0
  buffer_load_dword v89, v4, s[36:39], s58 offen offset:1024
  buffer_load_dword v90, v4, s[36:39], s58 offen offset:2048
  buffer_load_dword v91, v4, s[36:39], s58 offen offset:3072
  s_mov_b32 s58, 536576
  buffer_load_dword v92, v4, s[36:39], s58 offen offset:0
  buffer_load_dword v93, v4, s[36:39], s58 offen offset:1024
  buffer_load_dword v94, v4, s[36:39], s58 offen offset:2048
  buffer_load_dword v95, v4, s[36:39], s58 offen offset:3072
  s_waitcnt vmcnt(48)
  v_perm_b32 v16, v97, v96, s56
  v_perm_b32 v17, v99, v98, s56
  v_perm_b32 v18, v101, v100, s56
  v_perm_b32 v19, v103, v102, s56
  v_perm_b32 v20, v97, v96, s57
  v_perm_b32 v21, v99, v98, s57
  v_perm_b32 v22, v101, v100, s57
  v_perm_b32 v23, v103, v102, s57
  v_accvgpr_write_b32 a88, v16
  v_accvgpr_write_b32 a89, v17
  v_accvgpr_write_b32 a90, v18
  v_accvgpr_write_b32 a91, v19
  v_accvgpr_write_b32 a92, v20
  v_accvgpr_write_b32 a93, v21
  v_accvgpr_write_b32 a94, v22
  v_accvgpr_write_b32 a95, v23
  s_mov_b32 s58, 589824
  buffer_load_dword v96, v4, s[36:39], s58 offen offset:0
  buffer_load_dword v97, v4, s[36:39], s58 offen offset:1024
  buffer_load_dword v98, v4, s[36:39], s58 offen offset:2048
  buffer_load_dword v99, v4, s[36:39], s58 offen offset:3072
  s_mov_b32 s58, 593920
  buffer_load_dword v100, v4, s[36:39], s58 offen offset:0
  buffer_load_dword v101, v4, s[36:39], s58 offen offset:1024
  buffer_load_dword v102, v4, s[36:39], s58 offen offset:2048
  buffer_load_dword v103, v4, s[36:39], s58 offen offset:3072
  s_waitcnt vmcnt(48)
  v_perm_b32 v16, v105, v104, s56
  v_perm_b32 v17, v107, v106, s56
  v_perm_b32 v18, v109, v108, s56
  v_perm_b32 v19, v111, v110, s56
  v_perm_b32 v20, v105, v104, s57
  v_perm_b32 v21, v107, v106, s57
  v_perm_b32 v22, v109, v108, s57
  v_perm_b32 v23, v111, v110, s57
  v_accvgpr_write_b32 a96, v16
  v_accvgpr_write_b32 a97, v17
  v_accvgpr_write_b32 a98, v18
  v_accvgpr_write_b32 a99, v19
  v_accvgpr_write_b32 a100, v20
  v_accvgpr_write_b32 a101, v21
  v_accvgpr_write_b32 a102, v22
  v_accvgpr_write_b32 a103, v23
  s_mov_b32 s58, 598016
  buffer_load_dword v104, v4, s[36:39], s58 offen offset:0
  buffer_load_dword v105, v4, s[36:39], s58 offen offset:1024
  buffer_load_dword v106, v4, s[36:39], s58 offen offset:2048
  buffer_load_dword v107, v4, s[36:39], s58 offen offset:3072
  s_mov_b32 s58, 602112
  buffer_load_dword v108, v4, s[36:39], s58 offen offset:0
  buffer_load_dword v109, v4, s[36:39], s58 offen offset:1024
  buffer_load_dword v110, v4, s[36:39], s58 offen offset:2048
  buffer_load_dword v111, v4, s[36:39], s58 offen offset:3072
  s_waitcnt vmcnt(48)
  v_perm_b32 v16, v113, v112, s56
  v_perm_b32 v17, v115, v114, s56
  v_perm_b32 v18, v117, v116, s56
  v_perm_b32 v19, v119, v118, s56
  v_perm_b32 v20, v113, v112, s57
  v_perm_b32 v21, v115, v114, s57
  v_perm_b32 v22, v117, v116, s57
  v_perm_b32 v23, v119, v118, s57
  v_accvgpr_write_b32 a104, v16
  v_accvgpr_write_b32 a105, v17
  v_accvgpr_write_b32 a106, v18
  v_accvgpr_write_b32 a107, v19
  v_accvgpr_write_b32 a108, v20
  v_accvgpr_write_b32 a109, v21
  v_accvgpr_write_b32 a110, v22
  v_accvgpr_write_b32 a111, v23
  s_mov_b32 s58, 655360
  buffer_load_dword v112, v4, s[36:39], s58 offen offset:0
  buffer_load_dword v113, v4, s[36:39], s58 offen offset:1024
  buffer_load_dword v114, v4, s[36:39], s58 offen offset:2048
  buffer_load_dword v115, v4, s[36:39], s58 offen offset:3072
  s_mov_b32 s58, 659456
  buffer_load_dword v116, v4, s[36:39], s58 offen offset:0
  buffer_load_dword v117, v4, s[36:39], s58 offen offset:1024
  buffer_load_dword v118, v4, s[36:39], s58 offen offset:2048
  buffer_load_dword v119, v4, s[36:39], s58 offen offset:3072
  s_waitcnt vmcnt(48)
  v_perm_b32 v16, v65, v64, s56
  v_perm_b32 v17, v67, v66, s56
  v_perm_b32 v18, v69, v68, s56
  v_perm_b32 v19, v71, v70, s56
  v_perm_b32 v20, v65, v64, s57
  v_perm_b32 v21, v67, v66, s57
  v_perm_b32 v22, v69, v68, s57
  v_perm_b32 v23, v71, v70, s57
  v_accvgpr_write_b32 a112, v16
  v_accvgpr_write_b32 a113, v17
  v_accvgpr_write_b32 a114, v18
  v_accvgpr_write_b32 a115, v19
  v_accvgpr_write_b32 a116, v20
  v_accvgpr_write_b32 a117, v21
  v_accvgpr_write_b32 a118, v22
  v_accvgpr_write_b32 a119, v23
  s_mov_b32 s58, 663552
  buffer_load_dword v64, v4, s[36:39], s58 offen offset:0
  buffer_load_dword v65, v4, s[36:39], s58 offen offset:1024
  buffer_load_dword v66, v4, s[36:39], s58 offen offset:2048
  buffer_load_dword v67, v4, s[36:39], s58 offen offset:3072
  s_mov_b32 s58, 667648
  buffer_load_dword v68, v4, s[36:39], s58 offen offset:0
  buffer_load_dword v69, v4, s[36:39], s58 offen offset:1024
  buffer_load_dword v70, v4, s[36:39], s58 offen offset:2048
  buffer_load_dword v71, v4, s[36:39], s58 offen offset:3072
  s_waitcnt vmcnt(48)
  v_perm_b32 v16, v73, v72, s56
  v_perm_b32 v17, v75, v74, s56
  v_perm_b32 v18, v77, v76, s56
  v_perm_b32 v19, v79, v78, s56
  v_perm_b32 v20, v73, v72, s57
  v_perm_b32 v21, v75, v74, s57
  v_perm_b32 v22, v77, v76, s57
  v_perm_b32 v23, v79, v78, s57
  v_accvgpr_write_b32 a120, v16
  v_accvgpr_write_b32 a121, v17
  v_accvgpr_write_b32 a122, v18
  v_accvgpr_write_b32 a123, v19
  v_accvgpr_write_b32 a124, v20
  v_accvgpr_write_b32 a125, v21
  v_accvgpr_write_b32 a126, v22
  v_accvgpr_write_b32 a127, v23
  s_mov_b32 s58, 720896
  buffer_load_dword v72, v4, s[36:39], s58 offen offset:0
  buffer_load_dword v73, v4, s[36:39], s58 offen offset:1024
  buffer_load_dword v74, v4, s[36:39], s58 offen offset:2048
  buffer_load_dword v75, v4, s[36:39], s58 offen offset:3072
  s_mov_b32 s58, 724992
  buffer_load_dword v76, v4, s[36:39], s58 offen offset:0
  buffer_load_dword v77, v4, s[36:39], s58 offen offset:1024
  buffer_load_dword v78, v4, s[36:39], s58 offen offset:2048
  buffer_load_dword v79, v4, s[36:39], s58 offen offset:3072
  s_waitcnt vmcnt(48)
  v_perm_b32 v16, v81, v80, s56
  v_perm_b32 v17, v83, v82, s56
  v_perm_b32 v18, v85, v84, s56
  v_perm_b32 v19, v87, v86, s56
  v_perm_b32 v20, v81, v80, s57
  v_perm_b32 v21, v83, v82, s57
  v_perm_b32 v22, v85, v84, s57
  v_perm_b32 v23, v87, v86, s57
  v_accvgpr_write_b32 a128, v16
  v_accvgpr_write_b32 a129, v17
  v_accvgpr_write_b32 a130, v18
  v_accvgpr_write_b32 a131, v19
  v_accvgpr_write_b32 a132, v20
  v_accvgpr_write_b32 a133, v21
  v_accvgpr_write_b32 a134, v22
  v_accvgpr_write_b32 a135, v23
  s_mov_b32 s58, 729088
  buffer_load_dword v80, v4, s[36:39], s58 offen offset:0
  buffer_load_dword v81, v4, s[36:39], s58 offen offset:1024
  buffer_load_dword v82, v4, s[36:39], s58 offen offset:2048
  buffer_load_dword v83, v4, s[36:39], s58 offen offset:3072
  s_mov_b32 s58, 733184
  buffer_load_dword v84, v4, s[36:39], s58 offen offset:0
  buffer_load_dword v85, v4, s[36:39], s58 offen offset:1024
  buffer_load_dword v86, v4, s[36:39], s58 offen offset:2048
  buffer_load_dword v87, v4, s[36:39], s58 offen offset:3072
  s_waitcnt vmcnt(48)
  v_perm_b32 v16, v89, v88, s56
  v_perm_b32 v17, v91, v90, s56
  v_perm_b32 v18, v93, v92, s56
  v_perm_b32 v19, v95, v94, s56
  v_perm_b32 v20, v89, v88, s57
  v_perm_b32 v21, v91, v90, s57
  v_perm_b32 v22, v93, v92, s57
  v_perm_b32 v23, v95, v94, s57
  v_accvgpr_write_b32 a136, v16
  v_accvgpr_write_b32 a137, v17
  v_accvgpr_write_b32 a138, v18
  v_accvgpr_write_b32 a139, v19
  v_accvgpr_write_b32 a140, v20
  v_accvgpr_write_b32 a141, v21
  v_accvgpr_write_b32 a142, v22
  v_accvgpr_write_b32 a143, v23
  s_mov_b32 s58, 786432
  buffer_load_dword v88, v4, s[36:39], s58 offen offset:0
  buffer_load_dword v89, v4, s[36:39], s58 offen offset:1024
  buffer_load_dword v90, v4, s[36:39], s58 offen offset:2048
  buffer_load_dword v91, v4, s[36:39], s58 offen offset:3072
  s_mov_b32 s58, 790528
  buffer_load_dword v92, v4, s[36:39], s58 offen offset:0
  buffer_load_dword v93, v4, s[36:39], s58 offen offset:1024
  buffer_load_dword v94, v4, s[36:39], s58 offen offset:2048
  buffer_load_dword v95, v4, s[36:39], s58 offen offset:3072
  s_waitcnt vmcnt(48)
  v_perm_b32 v16, v97, v96, s56
  v_perm_b32 v17, v99, v98, s56
  v_perm_b32 v18, v101, v100, s56
  v_perm_b32 v19, v103, v102, s56
  v_perm_b32 v20, v97, v96, s57
  v_perm_b32 v21, v99, v98, s57
  v_perm_b32 v22, v101, v100, s57
  v_perm_b32 v23, v103, v102, s57
  v_accvgpr_write_b32 a144, v16
  v_accvgpr_write_b32 a145, v17
  v_accvgpr_write_b32 a146, v18
  v_accvgpr_write_b32 a147, v19
  v_accvgpr_write_b32 a148, v20
  v_accvgpr_write_b32 a149, v21
  v_accvgpr_write_b32 a150, v22
  v_accvgpr_write_b32 a151, v23
  s_mov_b32 s58, 794624
  buffer_load_dword v96, v4, s[36:39], s58 offen offset:0
  buffer_load_dword v97, v4, s[36:39], s58 offen offset:1024
  buffer_load_dword v98, v4, s[36:39], s58 offen offset:2048
  buffer_load_dword v99, v4, s[36:39], s58 offen offset:3072
  s_mov_b32 s58, 798720
  buffer_load_dword v100, v4, s[36:39], s58 offen offset:0
  buffer_load_dword v101, v4, s[36:39], s58 offen offset:1024
  buffer_load_dword v102, v4, s[36:39], s58 offen offset:2048
  buffer_load_dword v103, v4, s[36:39], s58 offen offset:3072
  s_waitcnt vmcnt(48)
  v_perm_b32 v16, v105, v104, s56
  v_perm_b32 v17, v107, v106, s56
  v_perm_b32 v18, v109, v108, s56
  v_perm_b32 v19, v111, v110, s56
  v_perm_b32 v20, v105, v104, s57
  v_perm_b32 v21, v107, v106, s57
  v_perm_b32 v22, v109, v108, s57
  v_perm_b32 v23, v111, v110, s57
  v_accvgpr_write_b32 a152, v16
  v_accvgpr_write_b32 a153, v17
  v_accvgpr_write_b32 a154, v18
  v_accvgpr_write_b32 a155, v19
  v_accvgpr_write_b32 a156, v20
  v_accvgpr_write_b32 a157, v21
  v_accvgpr_write_b32 a158, v22
  v_accvgpr_write_b32 a159, v23
  s_mov_b32 s58, 851968
  buffer_load_dword v104, v4, s[36:39], s58 offen offset:0
  buffer_load_dword v105, v4, s[36:39], s58 offen offset:1024
  buffer_load_dword v106, v4, s[36:39], s58 offen offset:2048
  buffer_load_dword v107, v4, s[36:39], s58 offen offset:3072
  s_mov_b32 s58, 856064
  buffer_load_dword v108, v4, s[36:39], s58 offen offset:0
  buffer_load_dword v109, v4, s[36:39], s58 offen offset:1024
  buffer_load_dword v110, v4, s[36:39], s58 offen offset:2048
  buffer_load_dword v111, v4, s[36:39], s58 offen offset:3072
  s_waitcnt vmcnt(48)
  v_perm_b32 v16, v113, v112, s56
  v_perm_b32 v17, v115, v114, s56
  v_perm_b32 v18, v117, v116, s56
  v_perm_b32 v19, v119, v118, s56
  v_perm_b32 v20, v113, v112, s57
  v_perm_b32 v21, v115, v114, s57
  v_perm_b32 v22, v117, v116, s57
  v_perm_b32 v23, v119, v118, s57
  v_accvgpr_write_b32 a160, v16
  v_accvgpr_write_b32 a161, v17
  v_accvgpr_write_b32 a162, v18
  v_accvgpr_write_b32 a163, v19
  v_accvgpr_write_b32 a164, v20
  v_accvgpr_write_b32 a165, v21
  v_accvgpr_write_b32 a166, v22
  v_accvgpr_write_b32 a167, v23
  s_mov_b32 s58, 860160
  buffer_load_dword v112, v4, s[36:39], s58 offen offset:0
  buffer_load_dword v113, v4, s[36:39], s58 offen offset:1024
  buffer_load_dword v114, v4, s[36:39], s58 offen offset:2048
  buffer_load_dword v115, v4, s[36:39], s58 offen offset:3072
  s_mov_b32 s58, 864256
  buffer_load_dword v116, v4, s[36:39], s58 offen offset:0
  buffer_load_dword v117, v4, s[36:39], s58 offen offset:1024
  buffer_load_dword v118, v4, s[36:39], s58 offen offset:2048
  buffer_load_dword v119, v4, s[36:39], s58 offen offset:3072
  s_waitcnt vmcnt(48)
  v_perm_b32 v16, v65, v64, s56
  v_perm_b32 v17, v67, v66, s56
  v_perm_b32 v18, v69, v68, s56
  v_perm_b32 v19, v71, v70, s56
  v_perm_b32 v20, v65, v64, s57
  v_perm_b32 v21, v67, v66, s57
  v_perm_b32 v22, v69, v68, s57
  v_perm_b32 v23, v71, v70, s57
  v_accvgpr_write_b32 a168, v16
  v_accvgpr_write_b32 a169, v17
  v_accvgpr_write_b32 a170, v18
  v_accvgpr_write_b32 a171, v19
  v_accvgpr_write_b32 a172, v20
  v_accvgpr_write_b32 a173, v21
  v_accvgpr_write_b32 a174, v22
  v_accvgpr_write_b32 a175, v23
  s_mov_b32 s58, 917504
  buffer_load_dword v64, v4, s[36:39], s58 offen offset:0
  buffer_load_dword v65, v4, s[36:39], s58 offen offset:1024
  buffer_load_dword v66, v4, s[36:39], s58 offen offset:2048
  buffer_load_dword v67, v4, s[36:39], s58 offen offset:3072
  s_mov_b32 s58, 921600
  buffer_load_dword v68, v4, s[36:39], s58 offen offset:0
  buffer_load_dword v69, v4, s[36:39], s58 offen offset:1024
  buffer_load_dword v70, v4, s[36:39], s58 offen offset:2048
  buffer_load_dword v71, v4, s[36:39], s58 offen offset:3072
  s_waitcnt vmcnt(48)
  v_perm_b32 v16, v73, v72, s56
  v_perm_b32 v17, v75, v74, s56
  v_perm_b32 v18, v77, v76, s56
  v_perm_b32 v19, v79, v78, s56
  v_perm_b32 v20, v73, v72, s57
  v_perm_b32 v21, v75, v74, s57
  v_perm_b32 v22, v77, v76, s57
  v_perm_b32 v23, v79, v78, s57
  v_accvgpr_write_b32 a176, v16
  v_accvgpr_write_b32 a177, v17
  v_accvgpr_write_b32 a178, v18
  v_accvgpr_write_b32 a179, v19
  v_accvgpr_write_b32 a180, v20
  v_accvgpr_write_b32 a181, v21
  v_accvgpr_write_b32 a182, v22
  v_accvgpr_write_b32 a183, v23
  s_mov_b32 s58, 925696
  buffer_load_dword v72, v4, s[36:39], s58 offen offset:0
  buffer_load_dword v73, v4, s[36:39], s58 offen offset:1024
  buffer_load_dword v74, v4, s[36:39], s58 offen offset:2048
  buffer_load_dword v75, v4, s[36:39], s58 offen offset:3072
  s_mov_b32 s58, 929792
  buffer_load_dword v76, v4, s[36:39], s58 offen offset:0
  buffer_load_dword v77, v4, s[36:39], s58 offen offset:1024
  buffer_load_dword v78, v4, s[36:39], s58 offen offset:2048
  buffer_load_dword v79, v4, s[36:39], s58 offen offset:3072
  s_waitcnt vmcnt(48)
  v_perm_b32 v16, v81, v80, s56
  v_perm_b32 v17, v83, v82, s56
  v_perm_b32 v18, v85, v84, s56
  v_perm_b32 v19, v87, v86, s56
  v_perm_b32 v20, v81, v80, s57
  v_perm_b32 v21, v83, v82, s57
  v_perm_b32 v22, v85, v84, s57
  v_perm_b32 v23, v87, v86, s57
  v_accvgpr_write_b32 a184, v16
  v_accvgpr_write_b32 a185, v17
  v_accvgpr_write_b32 a186, v18
  v_accvgpr_write_b32 a187, v19
  v_accvgpr_write_b32 a188, v20
  v_accvgpr_write_b32 a189, v21
  v_accvgpr_write_b32 a190, v22
  v_accvgpr_write_b32 a191, v23
  s_mov_b32 s58, 983040
  buffer_load_dword v80, v4, s[36:39], s58 offen offset:0
  buffer_load_dword v81, v4, s[36:39], s58 offen offset:1024
  buffer_load_dword v82, v4, s[36:39], s58 offen offset:2048
  buffer_load_dword v83, v4, s[36:39], s58 offen offset:3072
  s_mov_b32 s58, 987136
  buffer_load_dword v84, v4, s[36:39], s58 offen offset:0
  buffer_load_dword v85, v4, s[36:39], s58 offen offset:1024
  buffer_load_dword v86, v4, s[36:39], s58 offen offset:2048
  buffer_load_dword v87, v4, s[36:39], s58 offen offset:3072
  s_waitcnt vmcnt(48)
  v_perm_b32 v16, v89, v88, s56
  v_perm_b32 v17, v91, v90, s56
  v_perm_b32 v18, v93, v92, s56
  v_perm_b32 v19, v95, v94, s56
  v_perm_b32 v20, v89, v88, s57
  v_perm_b32 v21, v91, v90, s57
  v_perm_b32 v22, v93, v92, s57
  v_perm_b32 v23, v95, v94, s57
  v_accvgpr_write_b32 a192, v16
  v_accvgpr_write_b32 a193, v17
  v_accvgpr_write_b32 a194, v18
  v_accvgpr_write_b32 a195, v19
  v_accvgpr_write_b32 a196, v20
  v_accvgpr_write_b32 a197, v21
  v_accvgpr_write_b32 a198, v22
  v_accvgpr_write_b32 a199, v23
  s_mov_b32 s58, 991232
  buffer_load_dword v88, v4, s[36:39], s58 offen offset:0
  buffer_load_dword v89, v4, s[36:39], s58 offen offset:1024
  buffer_load_dword v90, v4, s[36:39], s58 offen offset:2048
  buffer_load_dword v91, v4, s[36:39], s58 offen offset:3072
  s_mov_b32 s58, 995328
  buffer_load_dword v92, v4, s[36:39], s58 offen offset:0
  buffer_load_dword v93, v4, s[36:39], s58 offen offset:1024
  buffer_load_dword v94, v4, s[36:39], s58 offen offset:2048
  buffer_load_dword v95, v4, s[36:39], s58 offen offset:3072
  s_waitcnt vmcnt(48)
  v_perm_b32 v16, v97, v96, s56
  v_perm_b32 v17, v99, v98, s56
  v_perm_b32 v18, v101, v100, s56
  v_perm_b32 v19, v103, v102, s56
  v_perm_b32 v20, v97, v96, s57
  v_perm_b32 v21, v99, v98, s57
  v_perm_b32 v22, v101, v100, s57
  v_perm_b32 v23, v103, v102, s57
  v_accvgpr_write_b32 a200, v16
  v_accvgpr_write_b32 a201, v17
  v_accvgpr_write_b32 a202, v18
  v_accvgpr_write_b32 a203, v19
  v_accvgpr_write_b32 a204, v20
  v_accvgpr_write_b32 a205, v21
  v_accvgpr_write_b32 a206, v22
  v_accvgpr_write_b32 a207, v23
  s_mov_b32 s58, 0
  buffer_load_dword v96, v5, s[40:43], s58 offen offset:0
  s_mov_b32 s58, 4096
  buffer_load_dword v97, v5, s[40:43], s58 offen offset:0
  s_mov_b32 s58, 8192
  buffer_load_dword v98, v5, s[40:43], s58 offen offset:0
  s_mov_b32 s58, 12288
  buffer_load_dword v99, v5, s[40:43], s58 offen offset:0
  s_mov_b32 s58, 0
  buffer_load_dword v100, v5, s[40:43], s58 offen offset:2048
  s_mov_b32 s58, 4096
  buffer_load_dword v101, v5, s[40:43], s58 offen offset:2048
  s_mov_b32 s58, 8192
  buffer_load_dword v102, v5, s[40:43], s58 offen offset:2048
  s_mov_b32 s58, 12288
  buffer_load_dword v103, v5, s[40:43], s58 offen offset:2048
  s_waitcnt vmcnt(48)
  v_perm_b32 v16, v105, v104, s56
  v_perm_b32 v17, v107, v106, s56
  v_perm_b32 v18, v109, v108, s56
  v_perm_b32 v19, v111, v110, s56
  v_perm_b32 v20, v105, v104, s57
  v_perm_b32 v21, v107, v106, s57
  v_perm_b32 v22, v109, v108, s57
  v_perm_b32 v23, v111, v110, s57
  v_accvgpr_write_b32 a208, v16
  v_accvgpr_write_b32 a209, v17
  v_accvgpr_write_b32 a210, v18
  v_accvgpr_write_b32 a211, v19
  v_accvgpr_write_b32 a212, v20
  v_accvgpr_write_b32 a213, v21
  v_accvgpr_write_b32 a214, v22
  v_accvgpr_write_b32 a215, v23
  s_mov_b32 s58, 32768
  buffer_load_dword v104, v5, s[40:43], s58 offen offset:0
  s_mov_b32 s58, 36864
  buffer_load_dword v105, v5, s[40:43], s58 offen offset:0
  s_mov_b32 s58, 40960
  buffer_load_dword v106, v5, s[40:43], s58 offen offset:0
  s_mov_b32 s58, 45056
  buffer_load_dword v107, v5, s[40:43], s58 offen offset:0
  s_mov_b32 s58, 32768
  buffer_load_dword v108, v5, s[40:43], s58 offen offset:2048
  s_mov_b32 s58, 36864
  buffer_load_dword v109, v5, s[40:43], s58 offen offset:2048
  s_mov_b32 s58, 40960
  buffer_load_dword v110, v5, s[40:43], s58 offen offset:2048
  s_mov_b32 s58, 45056
  buffer_load_dword v111, v5, s[40:43], s58 offen offset:2048
  s_waitcnt vmcnt(48)
  v_perm_b32 v16, v113, v112, s56
  v_perm_b32 v17, v115, v114, s56
  v_perm_b32 v18, v117, v116, s56
  v_perm_b32 v19, v119, v118, s56
  v_perm_b32 v20, v113, v112, s57
  v_perm_b32 v21, v115, v114, s57
  v_perm_b32 v22, v117, v116, s57
  v_perm_b32 v23, v119, v118, s57
  v_accvgpr_write_b32 a216, v16
  v_accvgpr_write_b32 a217, v17
  v_accvgpr_write_b32 a218, v18
  v_accvgpr_write_b32 a219, v19
  v_accvgpr_write_b32 a220, v20
  v_accvgpr_write_b32 a221, v21
  v_accvgpr_write_b32 a222, v22
  v_accvgpr_write_b32 a223, v23
  s_mov_b32 s58, 65536
  buffer_load_dword v112, v5, s[40:43], s58 offen offset:0
  s_mov_b32 s58, 69632
  buffer_load_dword v113, v5, s[40:43], s58 offen offset:0
  s_mov_b32 s58, 73728
  buffer_load_dword v114, v5, s[40:43], s58 offen offset:0
  s_mov_b32 s58, 77824
  buffer_load_dword v115, v5, s[40:43], s58 offen offset:0
  s_mov_b32 s58, 65536
  buffer_load_dword v116, v5, s[40:43], s58 offen offset:2048
  s_mov_b32 s58, 69632
  buffer_load_dword v117, v5, s[40:43], s58 offen offset:2048
  s_mov_b32 s58, 73728
  buffer_load_dword v118, v5, s[40:43], s58 offen offset:2048
  s_mov_b32 s58, 77824
  buffer_load_dword v119, v5, s[40:43], s58 offen offset:2048
  s_waitcnt vmcnt(48)
  v_perm_b32 v16, v65, v64, s56
  v_perm_b32 v17, v67, v66, s56
  v_perm_b32 v18, v69, v68, s56
  v_perm_b32 v19, v71, v70, s56
  v_perm_b32 v20, v65, v64, s57
  v_perm_b32 v21, v67, v66, s57
  v_perm_b32 v22, v69, v68, s57
  v_perm_b32 v23, v71, v70, s57
  v_accvgpr_write_b32 a224, v16
  v_accvgpr_write_b32 a225, v17
  v_accvgpr_write_b32 a226, v18
  v_accvgpr_write_b32 a227, v19
  v_accvgpr_write_b32 a228, v20
  v_accvgpr_write_b32 a229, v21
  v_accvgpr_write_b32 a230, v22
  v_accvgpr_write_b32 a231, v23
  s_mov_b32 s58, 98304
  buffer_load_dword v64, v5, s[40:43], s58 offen offset:0
  s_mov_b32 s58, 102400
  buffer_load_dword v65, v5, s[40:43], s58 offen offset:0
  s_mov_b32 s58, 106496
  buffer_load_dword v66, v5, s[40:43], s58 offen offset:0
  s_mov_b32 s58, 110592
  buffer_load_dword v67, v5, s[40:43], s58 offen offset:0
  s_mov_b32 s58, 98304
  buffer_load_dword v68, v5, s[40:43], s58 offen offset:2048
  s_mov_b32 s58, 102400
  buffer_load_dword v69, v5, s[40:43], s58 offen offset:2048
  s_mov_b32 s58, 106496
  buffer_load_dword v70, v5, s[40:43], s58 offen offset:2048
  s_mov_b32 s58, 110592
  buffer_load_dword v71, v5, s[40:43], s58 offen offset:2048
  s_waitcnt vmcnt(48)
  v_perm_b32 v16, v73, v72, s56
  v_perm_b32 v17, v75, v74, s56
  v_perm_b32 v18, v77, v76, s56
  v_perm_b32 v19, v79, v78, s56
  v_perm_b32 v20, v73, v72, s57
  v_perm_b32 v21, v75, v74, s57
  v_perm_b32 v22, v77, v76, s57
  v_perm_b32 v23, v79, v78, s57
  v_accvgpr_write_b32 a232, v16
  v_accvgpr_write_b32 a233, v17
  v_accvgpr_write_b32 a234, v18
  v_accvgpr_write_b32 a235, v19
  v_accvgpr_write_b32 a236, v20
  v_accvgpr_write_b32 a237, v21
  v_accvgpr_write_b32 a238, v22
  v_accvgpr_write_b32 a239, v23
  s_waitcnt vmcnt(40)
  v_perm_b32 v16, v81, v80, s56
  v_perm_b32 v17, v83, v82, s56
  v_perm_b32 v18, v85, v84, s56
  v_perm_b32 v19, v87, v86, s56
  v_perm_b32 v20, v81, v80, s57
  v_perm_b32 v21, v83, v82, s57
  v_perm_b32 v22, v85, v84, s57
  v_perm_b32 v23, v87, v86, s57
  v_accvgpr_write_b32 a240, v16
  v_accvgpr_write_b32 a241, v17
  v_accvgpr_write_b32 a242, v18
  v_accvgpr_write_b32 a243, v19
  v_accvgpr_write_b32 a244, v20
  v_accvgpr_write_b32 a245, v21
  v_accvgpr_write_b32 a246, v22
  v_accvgpr_write_b32 a247, v23
  s_waitcnt vmcnt(32)
  v_perm_b32 v16, v89, v88, s56
  v_perm_b32 v17, v91, v90, s56
  v_perm_b32 v18, v93, v92, s56
  v_perm_b32 v19, v95, v94, s56
  v_perm_b32 v20, v89, v88, s57
  v_perm_b32 v21, v91, v90, s57
  v_perm_b32 v22, v93, v92, s57
  v_perm_b32 v23, v95, v94, s57
  v_accvgpr_write_b32 a248, v16
  v_accvgpr_write_b32 a249, v17
  v_accvgpr_write_b32 a250, v18
  v_accvgpr_write_b32 a251, v19
  v_accvgpr_write_b32 a252, v20
  v_accvgpr_write_b32 a253, v21
  v_accvgpr_write_b32 a254, v22
  v_accvgpr_write_b32 a255, v23
  s_waitcnt vmcnt(24)
  v_perm_b32 v224, v97, v96, s56
  v_perm_b32 v225, v99, v98, s56
  v_perm_b32 v226, v101, v100, s56
  v_perm_b32 v227, v103, v102, s56
  v_perm_b32 v228, v97, v96, s57
  v_perm_b32 v229, v99, v98, s57
  v_perm_b32 v230, v101, v100, s57
  v_perm_b32 v231, v103, v102, s57
  s_waitcnt vmcnt(16)
  v_perm_b32 v232, v105, v104, s56
  v_perm_b32 v233, v107, v106, s56
  v_perm_b32 v234, v109, v108, s56
  v_perm_b32 v235, v111, v110, s56
  v_perm_b32 v236, v105, v104, s57
  v_perm_b32 v237, v107, v106, s57
  v_perm_b32 v238, v109, v108, s57
  v_perm_b32 v239, v111, v110, s57
  s_waitcnt vmcnt(8)
  v_perm_b32 v240, v113, v112, s56
  v_perm_b32 v241, v115, v114, s56
  v_perm_b32 v242, v117, v116, s56
  v_perm_b32 v243, v119, v118, s56
  v_perm_b32 v244, v113, v112, s57
  v_perm_b32 v245, v115, v114, s57
  v_perm_b32 v246, v117, v116, s57
  v_perm_b32 v247, v119, v118, s57
  s_waitcnt vmcnt(0)
  v_perm_b32 v248, v65, v64, s56
  v_perm_b32 v249, v67, v66, s56
  v_perm_b32 v250, v69, v68, s56
  v_perm_b32 v251, v71, v70, s56
  v_perm_b32 v252, v65, v64, s57
  v_perm_b32 v253, v67, v66, s57
  v_perm_b32 v254, v69, v68, s57
  v_perm_b32 v255, v71, v70, s57
  s_lshl_b32 s32, s28, 15
  s_add_u32 s32, s32, 4096
  v_lshl_add_u32 v4, v1, 4, s32
  v_add_u32 v5, 8192, v4
  v_add_u32 v6, 16384, v4
  v_add_u32 v7, 24576, v4
  s_lshl_b32 s32, s28, 12
  s_add_u32 s32, s32, 131072
  v_lshl_add_u32 v8, v1, 4, s32
  s_lshl_b32 s32, s28, 11
  v_lshl_add_u32 v10, v1, 4, s32
  v_lshlrev_b32 v11, 4, v1
  v_lshlrev_b32 v12, 10, v2
  v_lshl_add_u32 v12, v3, 4, v12
  v_add_u32 v12, s31, v12
  s_mov_b32 s59, 0
  v_subrev_u32 v14, 8, v2
  v_min_u32 v14, 6, v14
  v_add_u32 v14, 16, v14
  v_cmp_gt_u32 vcc, 8, v2
  v_mov_b32 v9, 24
  v_cndmask_b32 v14, v14, v2, vcc
  v_cndmask_b32_e64 v9, v9, 32, vcc
  v_lshlrev_b32 v14, 7, v14
  v_add_u32 v15, 89149440, v14
k_ol:
  s_lshr_b32 s35, s50, 3
  s_lshl_b32 s33, s50, 1
  s_add_u32 s48, s33, 1
  s_mul_i32 s32, s33, 147456
  s_add_u32 s32, s32, 50331648
  s_add_u32 s44, s26, s32
  s_addc_u32 s45, s27, 0
  s_add_u32 s52, s44, 147456
  s_addc_u32 s53, s45, 0
  s_mov_b32 s60, 0
sp_86:
  global_load_dword v14, v15, s[26:27] sc1
  s_add_u32 s60, s60, 1
  s_waitcnt vmcnt(0)
  v_and_b32 v13, 0xffff, v14
  v_cmp_ge_u32 vcc, v13, v9
  s_add_u32 s30, s63, 8
  v_readlane_b32 s55, v14, s30
  s_and_b32 s54, vcc_lo, 0xffff
  s_bitcmp1_b32 s54, s35
  s_cbranch_scc1 sp_87
  s_cmp_ge_u32 s60, 400000
  s_cbranch_scc1 k_end
  s_sleep 2
  s_branch sp_86
sp_87:
  global_load_dwordx4 v[64:67], v8, s[44:45] offset:0 sc1
  global_load_dwordx4 v[68:71], v8, s[44:45] offset:1024 sc1
  global_load_dwordx4 v[72:75], v8, s[44:45] offset:2048 sc1
  global_load_dwordx4 v[76:79], v8, s[44:45] offset:3072 sc1
  global_load_dwordx4 v[80:83], v8, s[52:53] offset:0 sc1
  global_load_dwordx4 v[84:87], v8, s[52:53] offset:1024 sc1
  global_load_dwordx4 v[88:91], v8, s[52:53] offset:2048 sc1
  global_load_dwordx4 v[92:95], v8, s[52:53] offset:3072 sc1
  s_waitcnt vmcnt(7)
  v_mfma_f32_16x16x32_bf16 v[16:19], v[224:227], v[64:67], 0
  v_mfma_f32_16x16x32_bf16 v[20:23], v[228:231], v[64:67], 0
  s_waitcnt vmcnt(6)
  v_mfma_f32_16x16x32_bf16 v[24:27], v[232:235], v[68:71], 0
  v_mfma_f32_16x16x32_bf16 v[28:31], v[236:239], v[68:71], 0
  s_waitcnt vmcnt(5)
  v_mfma_f32_16x16x32_bf16 v[16:19], v[240:243], v[72:75], v[16:19]
  v_mfma_f32_16x16x32_bf16 v[20:23], v[244:247], v[72:75], v[20:23]
  s_waitcnt vmcnt(4)
  v_mfma_f32_16x16x32_bf16 v[24:27], v[248:251], v[76:79], v[24:27]
  v_mfma_f32_16x16x32_bf16 v[28:31], v[252:255], v[76:79], v[28:31]
  s_waitcnt vmcnt(3)
  v_mfma_f32_16x16x32_bf16 v[208:211], v[224:227], v[80:83], 0
  v_mfma_f32_16x16x32_bf16 v[212:215], v[228:231], v[80:83], 0
  s_waitcnt vmcnt(2)
  v_mfma_f32_16x16x32_bf16 v[216:219], v[232:235], v[84:87], 0
  v_mfma_f32_16x16x32_bf16 v[220:223], v[236:239], v[84:87], 0
  s_waitcnt vmcnt(1)
  v_mfma_f32_16x16x32_bf16 v[208:211], v[240:243], v[88:91], v[208:211]
  v_mfma_f32_16x16x32_bf16 v[212:215], v[244:247], v[88:91], v[212:215]
  s_waitcnt vmcnt(0)
  v_mfma_f32_16x16x32_bf16 v[216:219], v[248:251], v[92:95], v[216:219]
  v_mfma_f32_16x16x32_bf16 v[220:223], v[252:255], v[92:95], v[220:223]
  s_lshl_b32 s30, s50, 7
  s_add_u32 s30, s30, 89141248
  v_lshrrev_b32 v14, 5, v1
  v_mul_u32_u24 v14, 12160, v14
  v_lshl_add_u32 v13, v1, 2, v14
  v_add_u32 v13, s30, v13
  s_mov_b32 s60, 0
sp_88:
  global_load_dword v14, v13, s[26:27] sc1
  s_add_u32 s60, s60, 1
  s_waitcnt vmcnt(0)
  v_cmp_ne_u32 vcc, 0, v14
  s_nop 1
  s_or_b32 s30, vcc_lo, vcc_hi
  s_cmp_eq_u32 s30, -1
  s_cbranch_scc1 sp_89
  s_cmp_ge_u32 s60, 400000
  s_cbranch_scc1 k_end
  s_sleep 1
  s_branch sp_88
sp_89:
  global_load_dwordx4 v[64:67], v4, s[44:45] offset:-4096 sc1
  global_load_dwordx4 v[68:71], v4, s[44:45] offset:-3072 sc1
  global_load_dwordx4 v[72:75], v4, s[44:45] offset:-2048 sc1
  global_load_dwordx4 v[76:79], v4, s[44:45] offset:-1024 sc1
  global_load_dwordx4 v[80:83], v4, s[44:45] offset:0 sc1
  global_load_dwordx4 v[84:87], v4, s[44:45] offset:1024 sc1
  global_load_dwordx4 v[88:91], v4, s[44:45] offset:2048 sc1
  global_load_dwordx4 v[92:95], v4, s[44:45] offset:3072 sc1
  global_load_dwordx4 v[96:99], v5, s[44:45] offset:-4096 sc1
  global_load_dwordx4 v[100:103], v5, s[44:45] offset:-3072 sc1
  global_load_dwordx4 v[104:107], v5, s[44:45] offset:-2048 sc1
  global_load_dwordx4 v[108:111], v5, s[44:45] offset:-1024 sc1
  global_load_dwordx4 v[112:115], v5, s[44:45] offset:0 sc1
  global_load_dwordx4 v[116:119], v5, s[44:45] offset:1024 sc1
  global_load_dwordx4 v[120:123], v5, s[44:45] offset:2048 sc1
  global_load_dwordx4 v[124:127], v5, s[44:45] offset:3072 sc1
  global_load_dwordx4 v[128:131], v6, s[44:45] offset:-4096 sc1
  global_load_dwordx4 v[132:135], v6, s[44:45] offset:-3072 sc1
  global_load_dwordx4 v[136:139], v6, s[44:45] offset:-2048 sc1
  global_load_dwordx4 v[140:143], v6, s[44:45] offset:-1024 sc1
  global_load_dwordx4 v[144:147], v6, s[44:45] offset:0 sc1
  global_load_dwordx4 v[148:151], v6, s[44:45] offset:1024 sc1
  global_load_dwordx4 v[152:155], v6, s[44:45] offset:2048 sc1
  global_load_dwordx4 v[156:159], v6, s[44:45] offset:3072 sc1
  global_load_dwordx4 v[160:163], v7, s[44:45] offset:-4096 sc1
  global_load_dwordx4 v[164:167], v7, s[44:45] offset:-3072 sc1
  global_load_dwordx4 v[168:171], v7, s[44:45] offset:-2048 sc1
  global_load_dwordx4 v[172:175], v7, s[44:45] offset:-1024 sc1
  global_load_dwordx4 v[176:179], v7, s[44:45] offset:0 sc1
  global_load_dwordx4 v[180:183], v7, s[44:45] offset:1024 sc1
  global_load_dwordx4 v[184:187], v7, s[44:45] offset:2048 sc1
  global_load_dwordx4 v[188:191], v7, s[44:45] offset:3072 sc1
  global_load_dwordx4 v[192:195], v4, s[52:53] offset:-4096 sc1
  global_load_dwordx4 v[196:199], v4, s[52:53] offset:-3072 sc1
  global_load_dwordx4 v[200:203], v4, s[52:53] offset:-2048 sc1
  global_load_dwordx4 v[204:207], v4, s[52:53] offset:-1024 sc1
  s_waitcnt vmcnt(35)
  v_mfma_f32_16x16x32_bf16 v[16:19], a[0:3], v[64:67], v[16:19]
  v_mfma_f32_16x16x32_bf16 v[20:23], a[4:7], v[64:67], v[20:23]
  global_load_dwordx4 v[64:67], v4, s[52:53] offset:0 sc1
  s_waitcnt vmcnt(35)
  v_mfma_f32_16x16x32_bf16 v[24:27], a[8:11], v[68:71], v[24:27]
  v_mfma_f32_16x16x32_bf16 v[28:31], a[12:15], v[68:71], v[28:31]
  global_load_dwordx4 v[68:71], v4, s[52:53] offset:1024 sc1
  s_waitcnt vmcnt(35)
  v_mfma_f32_16x16x32_bf16 v[16:19], a[16:19], v[72:75], v[16:19]
  v_mfma_f32_16x16x32_bf16 v[20:23], a[20:23], v[72:75], v[20:23]
  global_load_dwordx4 v[72:75], v4, s[52:53] offset:2048 sc1
  s_waitcnt vmcnt(35)
  v_mfma_f32_16x16x32_bf16 v[24:27], a[24:27], v[76:79], v[24:27]
  v_mfma_f32_16x16x32_bf16 v[28:31], a[28:31], v[76:79], v[28:31]
  global_load_dwordx4 v[76:79], v4, s[52:53] offset:3072 sc1
  s_waitcnt vmcnt(35)
  v_mfma_f32_16x16x32_bf16 v[16:19], a[32:35], v[80:83], v[16:19]
  v_mfma_f32_16x16x32_bf16 v[20:23], a[36:39], v[80:83], v[20:23]
  global_load_dwordx4 v[80:83], v5, s[52:53] offset:-4096 sc1
  s_waitcnt vmcnt(35)
  v_mfma_f32_16x16x32_bf16 v[24:27], a[40:43], v[84:87], v[24:27]
  v_mfma_f32_16x16x32_bf16 v[28:31], a[44:47], v[84:87], v[28:31]
  global_load_dwordx4 v[84:87], v5, s[52:53] offset:-3072 sc1
  s_waitcnt vmcnt(35)
  v_mfma_f32_16x16x32_bf16 v[16:19], a[48:51], v[88:91], v[16:19]
  v_mfma_f32_16x16x32_bf16 v[20:23], a[52:55], v[88:91], v[20:23]
  global_load_dwordx4 v[88:91], v5, s[52:53] offset:-2048 sc1
  s_waitcnt vmcnt(35)
  v_mfma_f32_16x16x32_bf16 v[24:27], a[56:59], v[92:95], v[24:27]
  v_mfma_f32_16x16x32_bf16 v[28:31], a[60:63], v[92:95], v[28:31]
  global_load_dwordx4 v[92:95], v5, s[52:53] offset:-1024 sc1
  s_waitcnt vmcnt(35)
  v_mfma_f32_16x16x32_bf16 v[16:19], a[64:67], v[96:99], v[16:19]
  v_mfma_f32_16x16x32_bf16 v[20:23], a[68:71], v[96:99], v[20:23]
  global_load_dwordx4 v[96:99], v5, s[52:53] offset:0 sc1
  s_waitcnt vmcnt(35)
  v_mfma_f32_16x16x32_bf16 v[24:27], a[72:75], v[100:103], v[24:27]
  v_mfma_f32_16x16x32_bf16 v[28:31], a[76:79], v[100:103], v[28:31]
  global_load_dwordx4 v[100:103], v5, s[52:53] offset:1024 sc1
  s_waitcnt vmcnt(35)
  v_mfma_f32_16x16x32_bf16 v[16:19], a[80:83], v[104:107], v[16:19]
  v_mfma_f32_16x16x32_bf16 v[20:23], a[84:87], v[104:107], v[20:23]
  global_load_dwordx4 v[104:107], v5, s[52:53] offset:2048 sc1
  s_waitcnt vmcnt(35)
  v_mfma_f32_16x16x32_bf16 v[24:27], a[88:91], v[108:111], v[24:27]
  v_mfma_f32_16x16x32_bf16 v[28:31], a[92:95], v[108:111], v[28:31]
  global_load_dwordx4 v[108:111], v5, s[52:53] offset:3072 sc1
  s_waitcnt vmcnt(35)
  v_mfma_f32_16x16x32_bf16 v[16:19], a[96:99], v[112:115], v[16:19]
  v_mfma_f32_16x16x32_bf16 v[20:23], a[100:103], v[112:115], v[20:23]
  global_load_dwordx4 v[112:115], v6, s[52:53] offset:-4096 sc1
  s_waitcnt vmcnt(35)
  v_mfma_f32_16x16x32_bf16 v[24:27], a[104:107], v[116:119], v[24:27]
  v_mfma_f32_16x16x32_bf16 v[28:31], a[108:111], v[116:119], v[28:31]
  global_load_dwordx4 v[116:119], v6, s[52:53] offset:-3072 sc1
  s_waitcnt vmcnt(35)
  v_mfma_f32_16x16x32_bf16 v[16:19], a[112:115], v[120:123], v[16:19]
  v_mfma_f32_16x16x32_bf16 v[20:23], a[116:119], v[120:123], v[20:23]
  global_load_dwordx4 v[120:123], v6, s[52:53] offset:-2048 sc1
  s_waitcnt vmcnt(35)
  v_mfma_f32_16x16x32_bf16 v[24:27], a[120:123], v[124:127], v[24:27]
  v_mfma_f32_16x16x32_bf16 v[28:31], a[124:127], v[124:127], v[28:31]
  global_load_dwordx4 v[124:127], v6, s[52:53] offset:-1024 sc1
  s_waitcnt vmcnt(35)
  v_mfma_f32_16x16x32_bf16 v[16:19], a[128:131], v[128:131], v[16:19]
  v_mfma_f32_16x16x32_bf16 v[20:23], a[132:135], v[128:131], v[20:23]
  global_load_dwordx4 v[128:131], v6, s[52:53] offset:0 sc1
  s_waitcnt vmcnt(35)
  v_mfma_f32_16x16x32_bf16 v[24:27], a[136:139], v[132:135], v[24:27]
  v_mfma_f32_16x16x32_bf16 v[28:31], a[140:143], v[132:135], v[28:31]
  global_load_dwordx4 v[132:135], v6, s[52:53] offset:1024 sc1
  s_waitcnt vmcnt(35)
  v_mfma_f32_16x16x32_bf16 v[16:19], a[144:147], v[136:139], v[16:19]
  v_mfma_f32_16x16x32_bf16 v[20:23], a[148:151], v[136:139], v[20:23]
  global_load_dwordx4 v[136:139], v6, s[52:53] offset:2048 sc1
  s_waitcnt vmcnt(35)
  v_mfma_f32_16x16x32_bf16 v[24:27], a[152:155], v[140:143], v[24:27]
  v_mfma_f32_16x16x32_bf16 v[28:31], a[156:159], v[140:143], v[28:31]
  global_load_dwordx4 v[140:143], v6, s[52:53] offset:3072 sc1
  s_waitcnt vmcnt(35)
  v_mfma_f32_16x16x32_bf16 v[16:19], a[160:163], v[144:147], v[16:19]
  v_mfma_f32_16x16x32_bf16 v[20:23], a[164:167], v[144:147], v[20:23]
  global_load_dwordx4 v[144:147], v7, s[52:53] offset:-4096 sc1
  s_waitcnt vmcnt(35)
  v_mfma_f32_16x16x32_bf16 v[24:27], a[168:171], v[148:151], v[24:27]
  v_mfma_f32_16x16x32_bf16 v[28:31], a[172:175], v[148:151], v[28:31]
  global_load_dwordx4 v[148:151], v7, s[52:53] offset:-3072 sc1
  s_waitcnt vmcnt(35)
  v_mfma_f32_16x16x32_bf16 v[16:19], a[176:179], v[152:155], v[16:19]
  v_mfma_f32_16x16x32_bf16 v[20:23], a[180:183], v[152:155], v[20:23]
  global_load_dwordx4 v[152:155], v7, s[52:53] offset:-2048 sc1
  s_waitcnt vmcnt(35)
  v_mfma_f32_16x16x32_bf16 v[24:27], a[184:187], v[156:159], v[24:27]
  v_mfma_f32_16x16x32_bf16 v[28:31], a[188:191], v[156:159], v[28:31]
  global_load_dwordx4 v[156:159], v7, s[52:53] offset:-1024 sc1
  s_waitcnt vmcnt(35)
  v_mfma_f32_16x16x32_bf16 v[16:19], a[192:195], v[160:163], v[16:19]
  v_mfma_f32_16x16x32_bf16 v[20:23], a[196:199], v[160:163], v[20:23]
  global_load_dwordx4 v[160:163], v7, s[52:53] offset:0 sc1
  s_waitcnt vmcnt(35)
  v_mfma_f32_16x16x32_bf16 v[24:27], a[200:203], v[164:167], v[24:27]
  v_mfma_f32_16x16x32_bf16 v[28:31], a[204:207], v[164:167], v[28:31]
  global_load_dwordx4 v[164:167], v7, s[52:53] offset:1024 sc1
  s_waitcnt vmcnt(35)
  v_mfma_f32_16x16x32_bf16 v[16:19], a[208:211], v[168:171], v[16:19]
  v_mfma_f32_16x16x32_bf16 v[20:23], a[212:215], v[168:171], v[20:23]
  global_load_dwordx4 v[168:171], v7, s[52:53] offset:2048 sc1
  s_waitcnt vmcnt(35)
  v_mfma_f32_16x16x32_bf16 v[24:27], a[216:219], v[172:175], v[24:27]
  v_mfma_f32_16x16x32_bf16 v[28:31], a[220:223], v[172:175], v[28:31]
  global_load_dwordx4 v[172:175], v7, s[52:53] offset:3072 sc1
  s_waitcnt vmcnt(35)
  v_mfma_f32_16x16x32_bf16 v[16:19], a[224:227], v[176:179], v[16:19]
  v_mfma_f32_16x16x32_bf16 v[20:23], a[228:231], v[176:179], v[20:23]
  s_waitcnt vmcnt(34)
  v_mfma_f32_16x16x32_bf16 v[24:27], a[232:235], v[180:183], v[24:27]
  v_mfma_f32_16x16x32_bf16 v[28:31], a[236:239], v[180:183], v[28:31]
  s_waitcnt vmcnt(33)
  v_mfma_f32_16x16x32_bf16 v[16:19], a[240:243], v[184:187], v[16:19]
  v_mfma_f32_16x16x32_bf16 v[20:23], a[244:247], v[184:187], v[20:23]
  s_waitcnt vmcnt(32)
  v_mfma_f32_16x16x32_bf16 v[24:27], a[248:251], v[188:191], v[24:27]
  v_mfma_f32_16x16x32_bf16 v[28:31], a[252:255], v[188:191], v[28:31]
  s_lshl_b32 s34, s33, 14
  s_add_u32 s46, s22, s34
  s_addc_u32 s47, s23, 0
  s_and_b32 s34, s59, 3
  s_add_u32 s59, s59, 1
  s_nop 3
  v_pk_add_f32 v[16:17], v[16:17], v[24:25]
  v_pk_add_f32 v[18:19], v[18:19], v[26:27]
  v_pk_add_f32 v[20:21], v[20:21], v[28:29]
  v_pk_add_f32 v[22:23], v[22:23], v[30:31]
  ds_write_b128 v10, v[16:19]
  ds_write_b128 v10, v[20:23] offset:1024
  v_xor_b32 v10, 8192, v10
  s_cmp_lg_u32 s34, s28
  s_waitcnt lgkmcnt(0)
  s_barrier
  s_cbranch_scc1 osk_90
  ds_read_b128 v[32:35], v11 offset:0
  ds_read_b128 v[36:39], v11 offset:1024
  ds_read_b128 v[40:43], v11 offset:2048
  ds_read_b128 v[44:47], v11 offset:3072
  ds_read_b128 v[48:51], v11 offset:4096
  ds_read_b128 v[52:55], v11 offset:5120
  ds_read_b128 v[56:59], v11 offset:6144
  ds_read_b128 v[60:63], v11 offset:7168
  s_waitcnt lgkmcnt(0)
  v_pk_add_f32 v[32:33], v[32:33], v[40:41]
  v_pk_add_f32 v[34:35], v[34:35], v[42:43]
  v_pk_add_f32 v[36:37], v[36:37], v[44:45]
  v_pk_add_f32 v[38:39], v[38:39], v[46:47]
  v_pk_add_f32 v[48:49], v[48:49], v[56:57]
  v_pk_add_f32 v[50:51], v[50:51], v[58:59]
  v_pk_add_f32 v[52:53], v[52:53], v[60:61]
  v_pk_add_f32 v[54:55], v[54:55], v[62:63]
  v_pk_add_f32 v[32:33], v[32:33], v[48:49]
  v_pk_add_f32 v[34:35], v[34:35], v[50:51]
  v_pk_add_f32 v[36:37], v[36:37], v[52:53]
  v_pk_add_f32 v[38:39], v[38:39], v[54:55]
  v_cvt_pk_bf16_f32 v40, v32, v36
  v_cvt_pk_bf16_f32 v41, v33, v37
  v_cvt_pk_bf16_f32 v42, v34, v38
  v_cvt_pk_bf16_f32 v43, v35, v39
  global_store_dwordx4 v12, v[40:43], s[46:47]
osk_90:
  v_xor_b32 v11, 8192, v11
  s_waitcnt vmcnt(31)
  v_mfma_f32_16x16x32_bf16 v[208:211], a[0:3], v[192:195], v[208:211]
  v_mfma_f32_16x16x32_bf16 v[212:215], a[4:7], v[192:195], v[212:215]
  s_waitcnt vmcnt(30)
  v_mfma_f32_16x16x32_bf16 v[216:219], a[8:11], v[196:199], v[216:219]
  v_mfma_f32_16x16x32_bf16 v[220:223], a[12:15], v[196:199], v[220:223]
  s_waitcnt vmcnt(29)
  v_mfma_f32_16x16x32_bf16 v[208:211], a[16:19], v[200:203], v[208:211]
  v_mfma_f32_16x16x32_bf16 v[212:215], a[20:23], v[200:203], v[212:215]
  s_waitcnt vmcnt(28)
  v_mfma_f32_16x16x32_bf16 v[216:219], a[24:27], v[204:207], v[216:219]
  v_mfma_f32_16x16x32_bf16 v[220:223], a[28:31], v[204:207], v[220:223]
  s_waitcnt vmcnt(27)
  v_mfma_f32_16x16x32_bf16 v[208:211], a[32:35], v[64:67], v[208:211]
  v_mfma_f32_16x16x32_bf16 v[212:215], a[36:39], v[64:67], v[212:215]
  s_waitcnt vmcnt(26)
  v_mfma_f32_16x16x32_bf16 v[216:219], a[40:43], v[68:71], v[216:219]
  v_mfma_f32_16x16x32_bf16 v[220:223], a[44:47], v[68:71], v[220:223]
  s_waitcnt vmcnt(25)
  v_mfma_f32_16x16x32_bf16 v[208:211], a[48:51], v[72:75], v[208:211]
  v_mfma_f32_16x16x32_bf16 v[212:215], a[52:55], v[72:75], v[212:215]
  s_waitcnt vmcnt(24)
  v_mfma_f32_16x16x32_bf16 v[216:219], a[56:59], v[76:79], v[216:219]
  v_mfma_f32_16x16x32_bf16 v[220:223], a[60:63], v[76:79], v[220:223]
  s_waitcnt vmcnt(23)
  v_mfma_f32_16x16x32_bf16 v[208:211], a[64:67], v[80:83], v[208:211]
  v_mfma_f32_16x16x32_bf16 v[212:215], a[68:71], v[80:83], v[212:215]
  s_waitcnt vmcnt(22)
  v_mfma_f32_16x16x32_bf16 v[216:219], a[72:75], v[84:87], v[216:219]
  v_mfma_f32_16x16x32_bf16 v[220:223], a[76:79], v[84:87], v[220:223]
  s_waitcnt vmcnt(21)
  v_mfma_f32_16x16x32_bf16 v[208:211], a[80:83], v[88:91], v[208:211]
  v_mfma_f32_16x16x32_bf16 v[212:215], a[84:87], v[88:91], v[212:215]
  s_waitcnt vmcnt(20)
  v_mfma_f32_16x16x32_bf16 v[216:219], a[88:91], v[92:95], v[216:219]
  v_mfma_f32_16x16x32_bf16 v[220:223], a[92:95], v[92:95], v[220:223]
  s_waitcnt vmcnt(19)
  v_mfma_f32_16x16x32_bf16 v[208:211], a[96:99], v[96:99], v[208:211]
  v_mfma_f32_16x16x32_bf16 v[212:215], a[100:103], v[96:99], v[212:215]
  s_waitcnt vmcnt(18)
  v_mfma_f32_16x16x32_bf16 v[216:219], a[104:107], v[100:103], v[216:219]
  v_mfma_f32_16x16x32_bf16 v[220:223], a[108:111], v[100:103], v[220:223]
  s_waitcnt vmcnt(17)
  v_mfma_f32_16x16x32_bf16 v[208:211], a[112:115], v[104:107], v[208:211]
  v_mfma_f32_16x16x32_bf16 v[212:215], a[116:119], v[104:107], v[212:215]
  s_waitcnt vmcnt(16)
  v_mfma_f32_16x16x32_bf16 v[216:219], a[120:123], v[108:111], v[216:219]
  v_mfma_f32_16x16x32_bf16 v[220:223], a[124:127], v[108:111], v[220:223]
  s_waitcnt vmcnt(15)
  v_mfma_f32_16x16x32_bf16 v[208:211], a[128:131], v[112:115], v[208:211]
  v_mfma_f32_16x16x32_bf16 v[212:215], a[132:135], v[112:115], v[212:215]
  s_waitcnt vmcnt(14)
  v_mfma_f32_16x16x32_bf16 v[216:219], a[136:139], v[116:119], v[216:219]
  v_mfma_f32_16x16x32_bf16 v[220:223], a[140:143], v[116:119], v[220:223]
  s_waitcnt vmcnt(13)
  v_mfma_f32_16x16x32_bf16 v[208:211], a[144:147], v[120:123], v[208:211]
  v_mfma_f32_16x16x32_bf16 v[212:215], a[148:151], v[120:123], v[212:215]
  s_waitcnt vmcnt(12)
  v_mfma_f32_16x16x32_bf16 v[216:219], a[152:155], v[124:127], v[216:219]
  v_mfma_f32_16x16x32_bf16 v[220:223], a[156:159], v[124:127], v[220:223]
  s_waitcnt vmcnt(11)
  v_mfma_f32_16x16x32_bf16 v[208:211], a[160:163], v[128:131], v[208:211]
  v_mfma_f32_16x16x32_bf16 v[212:215], a[164:167], v[128:131], v[212:215]
  s_waitcnt vmcnt(10)
  v_mfma_f32_16x16x32_bf16 v[216:219], a[168:171], v[132:135], v[216:219]
  v_mfma_f32_16x16x32_bf16 v[220:223], a[172:175], v[132:135], v[220:223]
  s_waitcnt vmcnt(9)
  v_mfma_f32_16x16x32_bf16 v[208:211], a[176:179], v[136:139], v[208:211]
  v_mfma_f32_16x16x32_bf16 v[212:215], a[180:183], v[136:139], v[212:215]
  s_waitcnt vmcnt(8)
  v_mfma_f32_16x16x32_bf16 v[216:219], a[184:187], v[140:143], v[216:219]
  v_mfma_f32_16x16x32_bf16 v[220:223], a[188:191], v[140:143], v[220:223]
  s_waitcnt vmcnt(7)
  v_mfma_f32_16x16x32_bf16 v[208:211], a[192:195], v[144:147], v[208:211]
  v_mfma_f32_16x16x32_bf16 v[212:215], a[196:199], v[144:147], v[212:215]
  s_waitcnt vmcnt(6)
  v_mfma_f32_16x16x32_bf16 v[216:219], a[200:203], v[148:151], v[216:219]
  v_mfma_f32_16x16x32_bf16 v[220:223], a[204:207], v[148:151], v[220:223]
  s_waitcnt vmcnt(5)
  v_mfma_f32_16x16x32_bf16 v[208:211], a[208:211], v[152:155], v[208:211]
  v_mfma_f32_16x16x32_bf16 v[212:215], a[212:215], v[152:155], v[212:215]
  s_waitcnt vmcnt(4)
  v_mfma_f32_16x16x32_bf16 v[216:219], a[216:219], v[156:159], v[216:219]
  v_mfma_f32_16x16x32_bf16 v[220:223], a[220:223], v[156:159], v[220:223]
  s_waitcnt vmcnt(3)
  v_mfma_f32_16x16x32_bf16 v[208:211], a[224:227], v[160:163], v[208:211]
  v_mfma_f32_16x16x32_bf16 v[212:215], a[228:231], v[160:163], v[212:215]
  s_waitcnt vmcnt(2)
  v_mfma_f32_16x16x32_bf16 v[216:219], a[232:235], v[164:167], v[216:219]
  v_mfma_f32_16x16x32_bf16 v[220:223], a[236:239], v[164:167], v[220:223]
  s_waitcnt vmcnt(1)
  v_mfma_f32_16x16x32_bf16 v[208:211], a[240:243], v[168:171], v[208:211]
  v_mfma_f32_16x16x32_bf16 v[212:215], a[244:247], v[168:171], v[212:215]
  s_waitcnt vmcnt(0)
  v_mfma_f32_16x16x32_bf16 v[216:219], a[248:251], v[172:175], v[216:219]
  v_mfma_f32_16x16x32_bf16 v[220:223], a[252:255], v[172:175], v[220:223]
  s_lshl_b32 s34, s48, 14
  s_add_u32 s46, s22, s34
  s_addc_u32 s47, s23, 0
  s_and_b32 s34, s59, 3
  s_add_u32 s59, s59, 1
  s_nop 3
  v_pk_add_f32 v[208:209], v[208:209], v[216:217]
  v_pk_add_f32 v[210:211], v[210:211], v[218:219]
  v_pk_add_f32 v[212:213], v[212:213], v[220:221]
  v_pk_add_f32 v[214:215], v[214:215], v[222:223]
  ds_write_b128 v10, v[208:211]
  ds_write_b128 v10, v[212:215] offset:1024
  v_xor_b32 v10, 8192, v10
  s_cmp_lg_u32 s34, s28
  s_waitcnt lgkmcnt(0)
  s_barrier
  s_cbranch_scc1 osk_91
  ds_read_b128 v[32:35], v11 offset:0
  ds_read_b128 v[36:39], v11 offset:1024
  ds_read_b128 v[40:43], v11 offset:2048
  ds_read_b128 v[44:47], v11 offset:3072
  ds_read_b128 v[48:51], v11 offset:4096
  ds_read_b128 v[52:55], v11 offset:5120
  ds_read_b128 v[56:59], v11 offset:6144
  ds_read_b128 v[60:63], v11 offset:7168
  s_waitcnt lgkmcnt(0)
  v_pk_add_f32 v[32:33], v[32:33], v[40:41]
  v_pk_add_f32 v[34:35], v[34:35], v[42:43]
  v_pk_add_f32 v[36:37], v[36:37], v[44:45]
  v_pk_add_f32 v[38:39], v[38:39], v[46:47]
  v_pk_add_f32 v[48:49], v[48:49], v[56:57]
  v_pk_add_f32 v[50:51], v[50:51], v[58:59]
  v_pk_add_f32 v[52:53], v[52:53], v[60:61]
  v_pk_add_f32 v[54:55], v[54:55], v[62:63]
  v_pk_add_f32 v[32:33], v[32:33], v[48:49]
  v_pk_add_f32 v[34:35], v[34:35], v[50:51]
  v_pk_add_f32 v[36:37], v[36:37], v[52:53]
  v_pk_add_f32 v[38:39], v[38:39], v[54:55]
  v_cvt_pk_bf16_f32 v40, v32, v36
  v_cvt_pk_bf16_f32 v41, v33, v37
  v_cvt_pk_bf16_f32 v42, v34, v38
  v_cvt_pk_bf16_f32 v43, v35, v39
  global_store_dwordx4 v12, v[40:43], s[46:47]
osk_91:
  v_xor_b32 v11, 8192, v11
  s_add_u32 s50, s50, 7
  s_cmp_lt_u32 s50, 64
  s_cbranch_scc1 k_ol
k_rdone:
  v_mov_b32 v6, 163824
  s_cmp_lg_u32 s28, 0
  s_cbranch_scc1 bc_92
  s_mov_b64 exec, 1
  v_mov_b32 v4, s54
  ds_write_b64 v6, v[4:5]
  s_mov_b64 exec, -1
  s_waitcnt lgkmcnt(0)
bc_92:
  s_barrier
  ds_read_b64 v[4:5], v6
  s_waitcnt lgkmcnt(0)
  v_readfirstlane_b32 s29, v4
  v_readfirstlane_b32 s62, v5
  s_barrier
  s_cmp_lg_u32 s29, 0xffff
  s_cbranch_scc1 k_worker
k_end:
  s_endpgm

.section .rodata,"a"
.p2align 6
.amdhsa_kernel gated_mix__mha_block__memory_aug_recurrent_mem_tr__prompt_kernel
  .amdhsa_next_free_vgpr 512
  .amdhsa_next_free_sgpr 102
  .amdhsa_accum_offset 256
  .amdhsa_group_segment_fixed_size 0
  .amdhsa_kernarg_size 112
  .amdhsa_user_sgpr_count 2
  .amdhsa_user_sgpr_kernarg_segment_ptr 1
  .amdhsa_system_sgpr_workgroup_id_x 1
.end_amdhsa_kernel
```
